```python
import torch

def _softmax(x, axis=-1):
    return torch.softmax(x, dim=axis)
def _gelu(x):
    return torch.nn.functional.gelu(x, approximate="tanh")
def _silu(x):
    return torch.nn.functional.silu(x)
def _sigmoid(x):
    return torch.sigmoid(x)
def _layernorm(x, axis=-1, eps=1e-5):
    m = x.mean(dim=axis, keepdim=True)
    v = x.var(dim=axis, keepdim=True, unbiased=False)
    return (x - m) / torch.sqrt(v + eps)
def _scatter_add(tgt, idx, src, axis=0):
    return tgt.clone().index_add_(axis, idx, src)
def _segment_sum(src, seg, n):
    out = torch.zeros((n,) + src.shape[1:], dtype=src.dtype)
    return out.index_add_(0, seg, src)
def _pad(x, pw):
    flat = tuple(v for pair in reversed(pw) for v in pair)
    return torch.nn.functional.pad(x, flat)

kernel_name = 'standalone__fft_conv__vision'

def setup_inputs():

    _w = (lambda a: (lambda t: t.to(torch.bfloat16) if t.is_floating_point() else t)(torch.as_tensor(a)))
    H = W = 224
    C = 96
    K = 5
    return {
        "x": _w((lambda *s: torch.randn(*s, dtype=torch.bfloat16) * 0.05)(1, H, W, C)),
        "w": _w((lambda *s: torch.randn(*s, dtype=torch.bfloat16) * 0.05)(K, K, C, C)),
    }

def reference(x, w):
    B, H, W, C = x.shape
    K = w.shape[0]
    wp = _pad(w, ((0, H - K), (0, W - K), (0, 0), (0, 0)))
    Xf = (lambda x, axes=(-2,-1): torch.fft.rfft2(x.float(), dim=axes))(x, axes=(1, 2))
    Wf = (lambda x, axes=(-2,-1): torch.fft.rfft2(x.float(), dim=axes))(wp, axes=(0, 1))
    Yf = torch.einsum('bhwi,hwio->bhwo', Xf, Wf)
    y = (lambda x, s, axes=(-2,-1): torch.fft.irfft2(x, s=s, dim=axes).to(torch.bfloat16))(Yf, (H, W), axes=(1, 2))
    return y
```

```asm
; @launch grid=(252,1,1) block=(512,1,1) lds=161280
.amdgcn_target "amdgcn-amd-amdhsa--gfx950"
.text
.globl standalone__fft_conv__vision_kernel
.p2align 8
.type standalone__fft_conv__vision_kernel,@function
standalone__fft_conv__vision_kernel:
    s_cmp_ge_u32 s2, 252
    s_cbranch_scc1 L_exit0
    s_load_dwordx4 s[4:7], s[0:1], 0
    s_load_dwordx2 s[8:9], s[0:1], 16
    s_getpc_b64 s[72:73]
L_pfbase:
    s_cmp_ge_u32 s2, 16
    s_cbranch_scc1 L_nopf
    v_cmp_gt_u32 vcc, (L_exit-L_pfbase)/128, v0
    s_and_saveexec_b64 s[74:75], vcc
    s_cbranch_execz L_nopf2
    v_lshlrev_b32 v50, 7, v0
    global_load_dword v52, v50, s[72:73]
L_nopf2:
    s_mov_b64 exec, s[74:75]
L_nopf:
    v_readfirstlane_b32 s16, v0
    s_and_b32 s10, s2, 7
    s_lshr_b32 s11, s2, 3
    s_lshr_b32 s16, s16, 6
    v_and_b32 v1, 63, v0
    s_cmp_ge_u32 s11, 28
    s_cbranch_scc1 L_small
    s_mul_i32 s10, s10, 28
    s_add_u32 s10, s10, s11
    s_mul_i32 s11, s10, 4682
    s_lshr_b32 s11, s11, 16
    s_mul_i32 s12, s11, 14
    s_sub_u32 s12, s10, s12
    s_add_u32 s11, s11, 2
    s_mul_i32 s13, s11, 21846
    s_lshr_b32 s13, s13, 16
    s_mul_i32 s14, s13, 3
    s_sub_u32 s14, s11, s14
    s_mul_i32 s15, s14, 25
    s_lshr_b32 s15, s15, 1
    s_mul_i32 s13, s13, 38
    s_add_u32 s15, s15, s13
    s_sub_u32 s15, s15, 4
L_decoded:
    s_lshl_b32 s12, s12, 4
    s_cmp_lt_u32 s16, 4
    s_cbranch_scc1 L_compute
L_loader:
    s_setprio 3
    s_sub_u32 s17, s16, 4
    s_and_b32 s18, s17, 1
    v_lshrrev_b32 v4, 2, v1
    v_and_b32 v5, 3, v1
    s_add_u32 s35, s12, 220
    s_lshl_b32 s19, s18, 3
    v_add_u32 v6, s19, v4
    v_lshrrev_b32 v7, 1, v6
    v_and_b32 v7, 2, v7
    v_xor_b32 v7, v7, v5
    v_add_u32 v8, s35, v6
    v_subrev_u32 v9, 224, v8
    v_min_u32 v8, v8, v9
    v_mul_u32_u24 v8, 192, v8
    v_lshl_add_u32 v41, v7, 4, v8
    s_mov_b32 s21, 6
    s_cmp_eq_u32 s14, 1
    s_cselect_b32 s21, 7, s21
    s_cmp_eq_u32 s14, 3
    s_cselect_b32 s21, 5, s21
    s_lshr_b32 s19, s17, 1
    s_mul_i32 s22, s19, s21
    s_add_u32 s34, s15, 220
    s_lshl_b32 s23, s18, 9
    s_mov_b32 s66, 9633792
    s_mov_b32 s67, 0x20000
    s_add_u32 s3, s34, s22
    s_sub_u32 s38, s3, 224
    s_min_u32 s3, s3, s38
    s_sub_u32 s38, s3, 224
    s_min_u32 s3, s3, s38
    s_mul_i32 s80, s3, 43008
    s_and_b32 s38, s22, 1
    s_lshl_b32 s38, s38, 5
    v_xor_b32 v44, s38, v41
    v_xor_b32 v45, 32, v44
    s_mul_i32 s90, s22, 1280
    s_add_u32 s90, s90, s23
    s_waitcnt lgkmcnt(0)
    s_mov_b32 s64, s4
    s_mov_b32 s65, s5
    s_mov_b32 exec_lo, -1
    s_mov_b32 exec_hi, 0
    s_add_u32 m0, s90, 0
    s_nop 0
    buffer_load_dwordx4 v44, s[64:67], s80 offen lds
    s_mov_b32 exec_lo, -1
    s_mov_b32 exec_hi, 65535
    v_mul_u32_u24 v2, 43, v1
    v_lshrrev_b32 v2, 9, v2
    v_mul_u32_u24 v3, 12, v2
    v_sub_u32 v3, v1, v3
    s_lshl_b32 s19, s18, 1
    v_xor_b32 v3, s19, v3
    s_lshl_b32 s19, s17, 3
    v_add_u32 v2, s19, v2
    v_mul_u32_u24 v2, 192, v2
    v_lshl_add_u32 v40, v3, 4, v2
    s_mul_i32 s29, s17, 1536
    s_add_u32 s29, s29, 69120
    s_mov_b32 s68, s6
    s_mov_b32 s69, s7
    s_mov_b32 s70, 460800
    s_mov_b32 s71, 0x20000
    s_mov_b32 exec_lo, -1
    s_mov_b32 exec_hi, 65535
    s_mov_b32 s3, 442368
    s_add_u32 m0, s29, 0
    s_nop 0
    buffer_load_dwordx4 v40, s[68:71], s3 offen lds
    buffer_load_dwordx4 v40, s[68:71], s3 offen offset:768 lds
    s_add_u32 s81, s80, 43008
    s_cmp_eq_u32 s81, 9633792
    s_cselect_b32 s81, 0, s81
    s_mov_b32 exec_lo, -1
    s_mov_b32 exec_hi, 0
    s_add_u32 m0, s90, 1280
    s_nop 0
    buffer_load_dwordx4 v45, s[64:67], s81 offen lds
    s_mov_b32 exec_lo, -1
    s_mov_b32 exec_hi, 65535
    s_mov_b32 s3, 350208
    s_add_u32 m0, s29, 6144
    s_nop 0
    buffer_load_dwordx4 v40, s[68:71], s3 offen lds
    buffer_load_dwordx4 v40, s[68:71], s3 offen offset:768 lds
    s_add_u32 s82, s81, 43008
    s_cmp_eq_u32 s82, 9633792
    s_cselect_b32 s82, 0, s82
    s_mov_b32 exec_lo, -1
    s_mov_b32 exec_hi, 0
    s_add_u32 m0, s90, 2560
    s_nop 0
    buffer_load_dwordx4 v44, s[64:67], s82 offen lds
    s_mov_b32 exec_lo, -1
    s_mov_b32 exec_hi, 65535
    s_mov_b32 s3, 258048
    s_add_u32 m0, s29, 12288
    s_nop 0
    buffer_load_dwordx4 v40, s[68:71], s3 offen lds
    buffer_load_dwordx4 v40, s[68:71], s3 offen offset:768 lds
    s_add_u32 s83, s82, 43008
    s_cmp_eq_u32 s83, 9633792
    s_cselect_b32 s83, 0, s83
    s_mov_b32 exec_lo, -1
    s_mov_b32 exec_hi, 0
    s_add_u32 m0, s90, 3840
    s_nop 0
    buffer_load_dwordx4 v45, s[64:67], s83 offen lds
    s_mov_b32 exec_lo, -1
    s_mov_b32 exec_hi, 65535
    s_mov_b32 s3, 165888
    s_add_u32 m0, s29, 18432
    s_nop 0
    buffer_load_dwordx4 v40, s[68:71], s3 offen lds
    buffer_load_dwordx4 v40, s[68:71], s3 offen offset:768 lds
    s_add_u32 s84, s83, 43008
    s_cmp_eq_u32 s84, 9633792
    s_cselect_b32 s84, 0, s84
    s_mov_b32 exec_lo, -1
    s_mov_b32 exec_hi, 0
    s_add_u32 m0, s90, 5120
    s_nop 0
    buffer_load_dwordx4 v44, s[64:67], s84 offen lds
    s_mov_b32 exec_lo, -1
    s_mov_b32 exec_hi, 65535
    s_mov_b32 s3, 73728
    s_add_u32 m0, s29, 24576
    s_nop 0
    buffer_load_dwordx4 v40, s[68:71], s3 offen lds
    buffer_load_dwordx4 v40, s[68:71], s3 offen offset:768 lds
    s_add_u32 s30, s29, 30720
    s_mov_b64 exec, -1
    s_lshr_b32 s19, s17, 1
    s_add_u32 s39, s21, s19
    s_add_u32 s39, s39, 6
    s_add_u32 s3, s34, s39
    s_sub_u32 s38, s3, 224
    s_min_u32 s3, s3, s38
    s_sub_u32 s38, s3, 224
    s_min_u32 s3, s3, s38
    s_mul_i32 s86, s3, 43008
    s_mul_i32 s91, s39, 1280
    s_add_u32 s91, s91, s23
    s_and_b32 s38, s39, 1
    s_lshl_b32 s38, s38, 5
    v_xor_b32 v46, s38, v41
    s_add_u32 s39, s21, s19
    s_add_u32 s39, s39, 8
    s_add_u32 s3, s34, s39
    s_sub_u32 s38, s3, 224
    s_min_u32 s3, s3, s38
    s_sub_u32 s38, s3, 224
    s_min_u32 s3, s3, s38
    s_mul_i32 s87, s3, 43008
    s_mul_i32 s92, s39, 1280
    s_add_u32 s92, s92, s23
    s_and_b32 s38, s39, 1
    s_lshl_b32 s38, s38, 5
    v_xor_b32 v47, s38, v41
    s_add_u32 s39, s21, s19
    s_add_u32 s39, s39, 10
    s_cmp_eq_u32 s39, 18
    s_cselect_b32 s39, 6, s39
    s_add_u32 s3, s34, s39
    s_sub_u32 s38, s3, 224
    s_min_u32 s3, s3, s38
    s_sub_u32 s38, s3, 224
    s_min_u32 s3, s3, s38
    s_mul_i32 s88, s3, 43008
    s_mul_i32 s93, s39, 1280
    s_add_u32 s93, s93, s23
    s_and_b32 s38, s39, 1
    s_lshl_b32 s38, s38, 5
    v_xor_b32 v48, s38, v41
    s_waitcnt vmcnt(12)
    s_barrier
    s_add_u32 s85, s84, 43008
    s_cmp_eq_u32 s85, 9633792
    s_cselect_b32 s85, 0, s85
    s_mov_b32 exec_lo, -1
    s_mov_b32 exec_hi, 0
    s_add_u32 m0, s90, 6400
    s_nop 0
    buffer_load_dwordx4 v45, s[64:67], s85 offen lds
    s_mov_b32 exec_lo, -1
    s_mov_b32 exec_hi, 0
    s_mov_b32 m0, s91
    s_nop 0
    buffer_load_dwordx4 v46, s[64:67], s86 offen lds
    s_mov_b64 exec, -1
    s_mov_b32 s19, 16
    v_add_u32 v6, s19, v4
    v_lshrrev_b32 v7, 1, v6
    v_and_b32 v7, 2, v7
    v_xor_b32 v7, v7, v5
    v_add_u32 v8, s35, v6
    v_subrev_u32 v9, 224, v8
    v_min_u32 v8, v8, v9
    v_mul_u32_u24 v8, 192, v8
    v_lshl_add_u32 v43, v7, 4, v8
    s_and_b32 s38, s17, 1
    s_lshl_b32 s38, s38, 5
    v_xor_b32 v49, s38, v43
    s_add_u32 s3, s34, s17
    s_sub_u32 s38, s3, 224
    s_min_u32 s3, s3, s38
    s_sub_u32 s38, s3, 224
    s_min_u32 s3, s3, s38
    s_mul_i32 s72, s3, 43008
    s_add_u32 s73, s72, 172032
    s_sub_u32 s38, s73, 9633792
    s_min_u32 s73, s73, s38
    s_add_u32 s74, s73, 172032
    s_sub_u32 s38, s74, 9633792
    s_min_u32 s74, s74, s38
    s_add_u32 s75, s74, 172032
    s_sub_u32 s38, s75, 9633792
    s_min_u32 s75, s75, s38
    s_and_b32 s39, s17, 1
    s_add_u32 s39, s39, 16
    s_add_u32 s3, s34, s39
    s_sub_u32 s38, s3, 224
    s_min_u32 s3, s3, s38
    s_sub_u32 s38, s3, 224
    s_min_u32 s3, s3, s38
    s_mul_i32 s76, s3, 43008
    s_mul_i32 s77, s17, 1280
    s_add_u32 s77, s77, 1024
    s_mul_i32 s78, s39, 1280
    s_add_u32 s78, s78, 1024
    s_waitcnt vmcnt(11)
    s_barrier
    s_mov_b32 exec_lo, -1
    s_mov_b32 exec_hi, 0
    s_mov_b32 m0, s92
    s_nop 0
    buffer_load_dwordx4 v47, s[64:67], s87 offen lds
    s_mov_b32 exec_lo, -1
    s_mov_b32 exec_hi, 0
    s_mov_b32 m0, s93
    s_nop 0
    buffer_load_dwordx4 v48, s[64:67], s88 offen lds
    s_mov_b32 exec_lo, -1
    s_mov_b32 exec_hi, 65535
    s_mov_b32 s3, 423936
    s_add_u32 m0, s30, 0
    s_nop 0
    buffer_load_dwordx4 v40, s[68:71], s3 offen lds
    buffer_load_dwordx4 v40, s[68:71], s3 offen offset:768 lds
    s_waitcnt vmcnt(12)
    s_barrier
    s_mov_b32 exec_lo, -1
    s_mov_b32 exec_hi, 65535
    s_mov_b32 s3, 331776
    s_add_u32 m0, s30, 6144
    s_nop 0
    buffer_load_dwordx4 v40, s[68:71], s3 offen lds
    buffer_load_dwordx4 v40, s[68:71], s3 offen offset:768 lds
    s_mov_b32 exec_lo, 65535
    s_mov_b32 exec_hi, 0
    s_add_u32 m0, s77, 0
    s_nop 0
    buffer_load_dwordx4 v49, s[64:67], s72 offen lds
    s_mov_b32 exec_lo, 65535
    s_mov_b32 exec_hi, 0
    s_add_u32 m0, s77, 5120
    s_nop 0
    buffer_load_dwordx4 v49, s[64:67], s73 offen lds
    s_waitcnt vmcnt(13)
    s_barrier
    s_mov_b32 exec_lo, -1
    s_mov_b32 exec_hi, 65535
    s_mov_b32 s3, 239616
    s_add_u32 m0, s30, 12288
    s_nop 0
    buffer_load_dwordx4 v40, s[68:71], s3 offen lds
    buffer_load_dwordx4 v40, s[68:71], s3 offen offset:768 lds
    s_mov_b32 exec_lo, 65535
    s_mov_b32 exec_hi, 0
    s_add_u32 m0, s77, 10240
    s_nop 0
    buffer_load_dwordx4 v49, s[64:67], s74 offen lds
    s_mov_b32 exec_lo, 65535
    s_mov_b32 exec_hi, 0
    s_add_u32 m0, s77, 15360
    s_nop 0
    buffer_load_dwordx4 v49, s[64:67], s75 offen lds
    s_waitcnt vmcnt(14)
    s_barrier
    s_mov_b32 exec_lo, -1
    s_mov_b32 exec_hi, 65535
    s_mov_b32 s3, 147456
    s_add_u32 m0, s30, 18432
    s_nop 0
    buffer_load_dwordx4 v40, s[68:71], s3 offen lds
    buffer_load_dwordx4 v40, s[68:71], s3 offen offset:768 lds
    s_mov_b32 exec_lo, 65535
    s_mov_b32 exec_hi, 0
    s_mov_b32 m0, s78
    s_nop 0
    buffer_load_dwordx4 v49, s[64:67], s76 offen lds
    s_waitcnt vmcnt(16)
    s_barrier
    s_mov_b32 exec_lo, -1
    s_mov_b32 exec_hi, 65535
    s_mov_b32 s3, 55296
    s_add_u32 m0, s30, 24576
    s_nop 0
    buffer_load_dwordx4 v40, s[68:71], s3 offen lds
    buffer_load_dwordx4 v40, s[68:71], s3 offen offset:768 lds
    s_waitcnt vmcnt(15)
    s_barrier
    s_waitcnt vmcnt(0)
    s_barrier
    s_setprio 0
    s_add_u32 s30, s29, 61440
    s_mov_b32 exec_lo, -1
    s_mov_b32 exec_hi, 65535
    s_mov_b32 s3, 405504
    s_add_u32 m0, s30, 0
    s_nop 0
    buffer_load_dwordx4 v40, s[68:71], s3 offen lds
    buffer_load_dwordx4 v40, s[68:71], s3 offen offset:768 lds
    s_mov_b32 s3, 313344
    s_add_u32 m0, s30, 6144
    s_nop 0
    buffer_load_dwordx4 v40, s[68:71], s3 offen lds
    buffer_load_dwordx4 v40, s[68:71], s3 offen offset:768 lds
    s_mov_b32 s3, 221184
    s_add_u32 m0, s30, 12288
    s_nop 0
    buffer_load_dwordx4 v40, s[68:71], s3 offen lds
    buffer_load_dwordx4 v40, s[68:71], s3 offen offset:768 lds
    s_mov_b32 s3, 129024
    s_add_u32 m0, s30, 18432
    s_nop 0
    buffer_load_dwordx4 v40, s[68:71], s3 offen lds
    buffer_load_dwordx4 v40, s[68:71], s3 offen offset:768 lds
    s_mov_b32 s3, 36864
    s_add_u32 m0, s30, 24576
    s_nop 0
    buffer_load_dwordx4 v40, s[68:71], s3 offen lds
    buffer_load_dwordx4 v40, s[68:71], s3 offen offset:768 lds
    s_mov_b64 exec, -1
    s_add_u32 s35, s12, 220
    v_lshrrev_b32 v7, 1, v4
    v_and_b32 v7, 2, v7
    v_xor_b32 v7, v7, v5
    v_add_u32 v8, s35, v4
    v_subrev_u32 v9, 224, v8
    v_min_u32 v8, v8, v9
    v_mul_u32_u24 v8, 192, v8
    v_lshl_add_u32 v42, v7, 4, v8
    s_mov_b32 s32, 0
    s_mov_b32 s30, s29
    s_mov_b32 s31, 18432
    s_mov_b32 s33, 3
    s_add_u32 s35, s29, 92160
    s_branch L_afterbar
L_ldloop:
    s_sub_u32 s3, s32, 2
    s_cmp_lt_u32 s3, 3
    s_cbranch_scc1 L_w18
    s_cmp_lt_u32 s32, 12
    s_cbranch_scc1 L_w10
    s_waitcnt vmcnt(0)
    s_branch L_wd
L_w18:
    s_waitcnt vmcnt(18)
    s_branch L_wd
L_w10:
    s_waitcnt vmcnt(10)
L_wd:
    s_barrier
L_afterbar:
    s_cmp_lt_u32 s32, 12
    s_cbranch_scc0 L_skip
    s_mov_b32 exec_lo, -1
    s_mov_b32 exec_hi, 65535
    s_add_u32 s3, s31, 368640
    s_add_u32 m0, s30, 0
    s_nop 0
    buffer_load_dwordx4 v40, s[68:71], s3 offen lds
    buffer_load_dwordx4 v40, s[68:71], s3 offen offset:768 lds
    s_add_u32 s3, s31, 276480
    s_add_u32 m0, s30, 6144
    s_nop 0
    buffer_load_dwordx4 v40, s[68:71], s3 offen lds
    buffer_load_dwordx4 v40, s[68:71], s3 offen offset:768 lds
    s_add_u32 s3, s31, 184320
    s_add_u32 m0, s30, 12288
    s_nop 0
    buffer_load_dwordx4 v40, s[68:71], s3 offen lds
    buffer_load_dwordx4 v40, s[68:71], s3 offen offset:768 lds
    s_add_u32 s3, s31, 92160
    s_add_u32 m0, s30, 18432
    s_nop 0
    buffer_load_dwordx4 v40, s[68:71], s3 offen lds
    buffer_load_dwordx4 v40, s[68:71], s3 offen offset:768 lds
    s_add_u32 s3, s31, 0
    s_add_u32 m0, s30, 24576
    s_nop 0
    buffer_load_dwordx4 v40, s[68:71], s3 offen lds
    buffer_load_dwordx4 v40, s[68:71], s3 offen offset:768 lds
    s_add_u32 s30, s30, 30720
    s_cmp_eq_u32 s30, s35
    s_cselect_b32 s30, s29, s30
    s_sub_u32 s31, s31, 18432
    s_add_u32 s33, s33, 1
    s_cmp_eq_u32 s33, 5
    s_cselect_b32 s3, 98304, 0
    s_cselect_b32 s33, 0, s33
    s_add_u32 s31, s31, s3
    s_cmp_eq_u32 s32, 1
    s_cbranch_scc0 L_nx1
    s_add_u32 s39, s17, 0
    s_mov_b64 exec, -1
    s_add_u32 s3, s34, s39
    s_sub_u32 s38, s3, 224
    s_min_u32 s3, s3, s38
    s_sub_u32 s38, s3, 224
    s_min_u32 s3, s3, s38
    s_mul_i32 s3, s3, 43008
    s_add_u32 s3, s3, 64
    s_and_b32 s38, s39, 1
    s_lshl_b32 s38, s38, 5
    v_xor_b32 v10, s38, v42
    s_mul_i32 s38, s39, 1280
    s_add_u32 m0, s38, 23040
    s_nop 0
    buffer_load_dwordx4 v10, s[64:67], s3 offen lds
    s_mov_b32 exec_lo, 65535
    s_mov_b32 exec_hi, 0
    s_add_u32 s3, s34, s39
    s_sub_u32 s38, s3, 224
    s_min_u32 s3, s3, s38
    s_sub_u32 s38, s3, 224
    s_min_u32 s3, s3, s38
    s_mul_i32 s3, s3, 43008
    s_add_u32 s3, s3, 64
    s_and_b32 s38, s39, 1
    s_lshl_b32 s38, s38, 5
    v_xor_b32 v10, s38, v43
    s_mul_i32 s38, s39, 1280
    s_add_u32 m0, s38, 24064
    s_nop 0
    buffer_load_dwordx4 v10, s[64:67], s3 offen lds
    s_add_u32 s39, s17, 4
    s_mov_b64 exec, -1
    s_add_u32 s3, s34, s39
    s_sub_u32 s38, s3, 224
    s_min_u32 s3, s3, s38
    s_sub_u32 s38, s3, 224
    s_min_u32 s3, s3, s38
    s_mul_i32 s3, s3, 43008
    s_add_u32 s3, s3, 64
    s_and_b32 s38, s39, 1
    s_lshl_b32 s38, s38, 5
    v_xor_b32 v10, s38, v42
    s_mul_i32 s38, s39, 1280
    s_add_u32 m0, s38, 23040
    s_nop 0
    buffer_load_dwordx4 v10, s[64:67], s3 offen lds
    s_mov_b32 exec_lo, 65535
    s_mov_b32 exec_hi, 0
    s_add_u32 s3, s34, s39
    s_sub_u32 s38, s3, 224
    s_min_u32 s3, s3, s38
    s_sub_u32 s38, s3, 224
    s_min_u32 s3, s3, s38
    s_mul_i32 s3, s3, 43008
    s_add_u32 s3, s3, 64
    s_and_b32 s38, s39, 1
    s_lshl_b32 s38, s38, 5
    v_xor_b32 v10, s38, v43
    s_mul_i32 s38, s39, 1280
    s_add_u32 m0, s38, 24064
    s_nop 0
    buffer_load_dwordx4 v10, s[64:67], s3 offen lds
    s_add_u32 s39, s17, 8
    s_mov_b64 exec, -1
    s_add_u32 s3, s34, s39
    s_sub_u32 s38, s3, 224
    s_min_u32 s3, s3, s38
    s_sub_u32 s38, s3, 224
    s_min_u32 s3, s3, s38
    s_mul_i32 s3, s3, 43008
    s_add_u32 s3, s3, 64
    s_and_b32 s38, s39, 1
    s_lshl_b32 s38, s38, 5
    v_xor_b32 v10, s38, v42
    s_mul_i32 s38, s39, 1280
    s_add_u32 m0, s38, 23040
    s_nop 0
    buffer_load_dwordx4 v10, s[64:67], s3 offen lds
    s_mov_b32 exec_lo, 65535
    s_mov_b32 exec_hi, 0
    s_add_u32 s3, s34, s39
    s_sub_u32 s38, s3, 224
    s_min_u32 s3, s3, s38
    s_sub_u32 s38, s3, 224
    s_min_u32 s3, s3, s38
    s_mul_i32 s3, s3, 43008
    s_add_u32 s3, s3, 64
    s_and_b32 s38, s39, 1
    s_lshl_b32 s38, s38, 5
    v_xor_b32 v10, s38, v43
    s_mul_i32 s38, s39, 1280
    s_add_u32 m0, s38, 24064
    s_nop 0
    buffer_load_dwordx4 v10, s[64:67], s3 offen lds
    s_add_u32 s39, s17, 12
    s_mov_b64 exec, -1
    s_add_u32 s3, s34, s39
    s_sub_u32 s38, s3, 224
    s_min_u32 s3, s3, s38
    s_sub_u32 s38, s3, 224
    s_min_u32 s3, s3, s38
    s_mul_i32 s3, s3, 43008
    s_add_u32 s3, s3, 64
    s_and_b32 s38, s39, 1
    s_lshl_b32 s38, s38, 5
    v_xor_b32 v10, s38, v42
    s_mul_i32 s38, s39, 1280
    s_add_u32 m0, s38, 23040
    s_nop 0
    buffer_load_dwordx4 v10, s[64:67], s3 offen lds
    s_mov_b32 exec_lo, 65535
    s_mov_b32 exec_hi, 0
    s_add_u32 s3, s34, s39
    s_sub_u32 s38, s3, 224
    s_min_u32 s3, s3, s38
    s_sub_u32 s38, s3, 224
    s_min_u32 s3, s3, s38
    s_mul_i32 s3, s3, 43008
    s_add_u32 s3, s3, 64
    s_and_b32 s38, s39, 1
    s_lshl_b32 s38, s38, 5
    v_xor_b32 v10, s38, v43
    s_mul_i32 s38, s39, 1280
    s_add_u32 m0, s38, 24064
    s_nop 0
    buffer_load_dwordx4 v10, s[64:67], s3 offen lds
    s_cmp_ge_u32 s17, 2
    s_cbranch_scc1 L_xskip1
    s_add_u32 s39, s17, 16
    s_mov_b64 exec, -1
    s_add_u32 s3, s34, s39
    s_sub_u32 s38, s3, 224
    s_min_u32 s3, s3, s38
    s_sub_u32 s38, s3, 224
    s_min_u32 s3, s3, s38
    s_mul_i32 s3, s3, 43008
    s_add_u32 s3, s3, 64
    s_and_b32 s38, s39, 1
    s_lshl_b32 s38, s38, 5
    v_xor_b32 v10, s38, v42
    s_mul_i32 s38, s39, 1280
    s_add_u32 m0, s38, 23040
    s_nop 0
    buffer_load_dwordx4 v10, s[64:67], s3 offen lds
    s_mov_b32 exec_lo, 65535
    s_mov_b32 exec_hi, 0
    s_add_u32 s3, s34, s39
    s_sub_u32 s38, s3, 224
    s_min_u32 s3, s3, s38
    s_sub_u32 s38, s3, 224
    s_min_u32 s3, s3, s38
    s_mul_i32 s3, s3, 43008
    s_add_u32 s3, s3, 64
    s_and_b32 s38, s39, 1
    s_lshl_b32 s38, s38, 5
    v_xor_b32 v10, s38, v43
    s_mul_i32 s38, s39, 1280
    s_add_u32 m0, s38, 24064
    s_nop 0
    buffer_load_dwordx4 v10, s[64:67], s3 offen lds
L_xskip1:
L_nx1:
    s_cmp_eq_u32 s32, 2
    s_cbranch_scc0 L_skip
    s_add_u32 s39, s17, 0
    s_mov_b64 exec, -1
    s_add_u32 s3, s34, s39
    s_sub_u32 s38, s3, 224
    s_min_u32 s3, s3, s38
    s_sub_u32 s38, s3, 224
    s_min_u32 s3, s3, s38
    s_mul_i32 s3, s3, 43008
    s_add_u32 s3, s3, 128
    s_and_b32 s38, s39, 1
    s_lshl_b32 s38, s38, 5
    v_xor_b32 v10, s38, v42
    s_mul_i32 s38, s39, 1280
    s_add_u32 m0, s38, 46080
    s_nop 0
    buffer_load_dwordx4 v10, s[64:67], s3 offen lds
    s_mov_b32 exec_lo, 65535
    s_mov_b32 exec_hi, 0
    s_add_u32 s3, s34, s39
    s_sub_u32 s38, s3, 224
    s_min_u32 s3, s3, s38
    s_sub_u32 s38, s3, 224
    s_min_u32 s3, s3, s38
    s_mul_i32 s3, s3, 43008
    s_add_u32 s3, s3, 128
    s_and_b32 s38, s39, 1
    s_lshl_b32 s38, s38, 5
    v_xor_b32 v10, s38, v43
    s_mul_i32 s38, s39, 1280
    s_add_u32 m0, s38, 47104
    s_nop 0
    buffer_load_dwordx4 v10, s[64:67], s3 offen lds
    s_add_u32 s39, s17, 4
    s_mov_b64 exec, -1
    s_add_u32 s3, s34, s39
    s_sub_u32 s38, s3, 224
    s_min_u32 s3, s3, s38
    s_sub_u32 s38, s3, 224
    s_min_u32 s3, s3, s38
    s_mul_i32 s3, s3, 43008
    s_add_u32 s3, s3, 128
    s_and_b32 s38, s39, 1
    s_lshl_b32 s38, s38, 5
    v_xor_b32 v10, s38, v42
    s_mul_i32 s38, s39, 1280
    s_add_u32 m0, s38, 46080
    s_nop 0
    buffer_load_dwordx4 v10, s[64:67], s3 offen lds
    s_mov_b32 exec_lo, 65535
    s_mov_b32 exec_hi, 0
    s_add_u32 s3, s34, s39
    s_sub_u32 s38, s3, 224
    s_min_u32 s3, s3, s38
    s_sub_u32 s38, s3, 224
    s_min_u32 s3, s3, s38
    s_mul_i32 s3, s3, 43008
    s_add_u32 s3, s3, 128
    s_and_b32 s38, s39, 1
    s_lshl_b32 s38, s38, 5
    v_xor_b32 v10, s38, v43
    s_mul_i32 s38, s39, 1280
    s_add_u32 m0, s38, 47104
    s_nop 0
    buffer_load_dwordx4 v10, s[64:67], s3 offen lds
    s_add_u32 s39, s17, 8
    s_mov_b64 exec, -1
    s_add_u32 s3, s34, s39
    s_sub_u32 s38, s3, 224
    s_min_u32 s3, s3, s38
    s_sub_u32 s38, s3, 224
    s_min_u32 s3, s3, s38
    s_mul_i32 s3, s3, 43008
    s_add_u32 s3, s3, 128
    s_and_b32 s38, s39, 1
    s_lshl_b32 s38, s38, 5
    v_xor_b32 v10, s38, v42
    s_mul_i32 s38, s39, 1280
    s_add_u32 m0, s38, 46080
    s_nop 0
    buffer_load_dwordx4 v10, s[64:67], s3 offen lds
    s_mov_b32 exec_lo, 65535
    s_mov_b32 exec_hi, 0
    s_add_u32 s3, s34, s39
    s_sub_u32 s38, s3, 224
    s_min_u32 s3, s3, s38
    s_sub_u32 s38, s3, 224
    s_min_u32 s3, s3, s38
    s_mul_i32 s3, s3, 43008
    s_add_u32 s3, s3, 128
    s_and_b32 s38, s39, 1
    s_lshl_b32 s38, s38, 5
    v_xor_b32 v10, s38, v43
    s_mul_i32 s38, s39, 1280
    s_add_u32 m0, s38, 47104
    s_nop 0
    buffer_load_dwordx4 v10, s[64:67], s3 offen lds
    s_add_u32 s39, s17, 12
    s_mov_b64 exec, -1
    s_add_u32 s3, s34, s39
    s_sub_u32 s38, s3, 224
    s_min_u32 s3, s3, s38
    s_sub_u32 s38, s3, 224
    s_min_u32 s3, s3, s38
    s_mul_i32 s3, s3, 43008
    s_add_u32 s3, s3, 128
    s_and_b32 s38, s39, 1
    s_lshl_b32 s38, s38, 5
    v_xor_b32 v10, s38, v42
    s_mul_i32 s38, s39, 1280
    s_add_u32 m0, s38, 46080
    s_nop 0
    buffer_load_dwordx4 v10, s[64:67], s3 offen lds
    s_mov_b32 exec_lo, 65535
    s_mov_b32 exec_hi, 0
    s_add_u32 s3, s34, s39
    s_sub_u32 s38, s3, 224
    s_min_u32 s3, s3, s38
    s_sub_u32 s38, s3, 224
    s_min_u32 s3, s3, s38
    s_mul_i32 s3, s3, 43008
    s_add_u32 s3, s3, 128
    s_and_b32 s38, s39, 1
    s_lshl_b32 s38, s38, 5
    v_xor_b32 v10, s38, v43
    s_mul_i32 s38, s39, 1280
    s_add_u32 m0, s38, 47104
    s_nop 0
    buffer_load_dwordx4 v10, s[64:67], s3 offen lds
    s_cmp_ge_u32 s17, 2
    s_cbranch_scc1 L_xskip2
    s_add_u32 s39, s17, 16
    s_mov_b64 exec, -1
    s_add_u32 s3, s34, s39
    s_sub_u32 s38, s3, 224
    s_min_u32 s3, s3, s38
    s_sub_u32 s38, s3, 224
    s_min_u32 s3, s3, s38
    s_mul_i32 s3, s3, 43008
    s_add_u32 s3, s3, 128
    s_and_b32 s38, s39, 1
    s_lshl_b32 s38, s38, 5
    v_xor_b32 v10, s38, v42
    s_mul_i32 s38, s39, 1280
    s_add_u32 m0, s38, 46080
    s_nop 0
    buffer_load_dwordx4 v10, s[64:67], s3 offen lds
    s_mov_b32 exec_lo, 65535
    s_mov_b32 exec_hi, 0
    s_add_u32 s3, s34, s39
    s_sub_u32 s38, s3, 224
    s_min_u32 s3, s3, s38
    s_sub_u32 s38, s3, 224
    s_min_u32 s3, s3, s38
    s_mul_i32 s3, s3, 43008
    s_add_u32 s3, s3, 128
    s_and_b32 s38, s39, 1
    s_lshl_b32 s38, s38, 5
    v_xor_b32 v10, s38, v43
    s_mul_i32 s38, s39, 1280
    s_add_u32 m0, s38, 47104
    s_nop 0
    buffer_load_dwordx4 v10, s[64:67], s3 offen lds
L_xskip2:
L_skip:
    s_add_u32 s32, s32, 1
    s_cmp_lt_u32 s32, 13
    s_cbranch_scc1 L_ldloop
    s_mov_b64 exec, -1
    v_lshlrev_b32 v46, 4, v1
    v_add_u32 v47, 0, v1
    v_mul_u32_u24 v48, 5462, v47
    v_lshrrev_b32 v48, 16, v48
    v_mul_u32_u24 v49, 12, v48
    v_sub_u32 v49, v47, v49
    v_lshrrev_b32 v43, 2, v49
    v_bfe_u32 v50, v48, 1, 2
    v_xor_b32 v50, v50, v49
    v_and_b32 v50, 3, v50
    v_and_b32 v49, 12, v49
    v_or_b32 v49, v49, v50
    v_mul_u32_u24 v48, 192, v48
    v_lshl_add_u32 v40, v49, 4, v48
    v_add_u32 v47, 64, v1
    v_mul_u32_u24 v48, 5462, v47
    v_lshrrev_b32 v48, 16, v48
    v_mul_u32_u24 v49, 12, v48
    v_sub_u32 v49, v47, v49
    v_lshrrev_b32 v44, 2, v49
    v_bfe_u32 v50, v48, 1, 2
    v_xor_b32 v50, v50, v49
    v_and_b32 v50, 3, v50
    v_and_b32 v49, 12, v49
    v_or_b32 v49, v49, v50
    v_mul_u32_u24 v48, 192, v48
    v_lshl_add_u32 v41, v49, 4, v48
    v_add_u32 v47, 128, v1
    v_mul_u32_u24 v48, 5462, v47
    v_lshrrev_b32 v48, 16, v48
    v_mul_u32_u24 v49, 12, v48
    v_sub_u32 v49, v47, v49
    v_lshrrev_b32 v45, 2, v49
    v_bfe_u32 v50, v48, 1, 2
    v_xor_b32 v50, v50, v49
    v_and_b32 v50, 3, v50
    v_and_b32 v49, 12, v49
    v_or_b32 v49, v49, v50
    v_mul_u32_u24 v48, 192, v48
    v_lshl_add_u32 v42, v49, 4, v48
    s_mov_b32 s76, s8
    s_mov_b32 s77, s9
    s_mov_b32 s78, 9633792
    s_mov_b32 s79, 0x20000
    s_mov_b32 s85, 3088
    s_cmp_eq_u32 s14, 1
    s_cselect_b32 s85, 3330, s85
    s_cmp_eq_u32 s14, 2
    s_cselect_b32 s85, 25377, s85
    s_cmp_eq_u32 s14, 3
    s_cselect_b32 s85, 2576, s85
    s_cmp_eq_u32 s14, 4
    s_cselect_b32 s85, 2818, s85
    s_and_b32 s84, s85, 15
    s_bfe_u32 s86, s85, 0x40004
    s_lshr_b32 s85, s85, 8
    s_barrier
    s_mov_b32 s72, 4294936336
    s_cmp_eq_u32 s14, 1
    s_cselect_b32 s72, 4294930960, s72
    s_cmp_eq_u32 s14, 2
    s_cselect_b32 s72, 4294930960, s72
    s_cmp_eq_u32 s14, 3
    s_cselect_b32 s72, 4294931984, s72
    s_cmp_eq_u32 s14, 4
    s_cselect_b32 s72, 4294926864, s72
    s_lshl_b32 s87, s17, 2
    s_lshr_b32 s87, s72, s87
    s_and_b32 s87, s87, 15
    s_cmp_eq_u32 s87, 15
    s_cbranch_scc1 L_bskip0_0
    s_add_u32 s80, s15, s87
    s_cmp_ge_u32 s80, 224
    s_cbranch_scc1 L_rskipb0_0
    s_mul_i32 s80, s80, 43008
    s_mul_i32 s3, s12, 192
    s_add_u32 s80, s80, s3
    s_mul_i32 s81, s87, 3072
    v_add_u32 v47, s81, v40
    v_add_u32 v48, s81, v41
    v_add_u32 v49, s81, v42
    ds_read_b128 v[52:55], v47
    ds_read_b128 v[56:59], v48
    ds_read_b128 v[60:63], v49
    s_mov_b32 s82, 0
    s_mov_b32 s83, 2
    s_cmp_eq_u32 s87, 0
    s_cselect_b32 s82, s84, 0
    s_cmp_eq_u32 s87, s85
    s_cselect_b32 s83, s86, 2
    v_cmp_le_u32 vcc, s82, v43
    v_cmp_ge_u32 s[88:89], s83, v43
    s_and_b64 exec, vcc, s[88:89]
    s_waitcnt lgkmcnt(2)
    buffer_store_dwordx4 v[52:55], v46, s[76:79], s80 offen offset:0 sc1
    s_mov_b64 exec, -1
    v_cmp_le_u32 vcc, s82, v44
    v_cmp_ge_u32 s[88:89], s83, v44
    s_and_b64 exec, vcc, s[88:89]
    s_waitcnt lgkmcnt(1)
    buffer_store_dwordx4 v[56:59], v46, s[76:79], s80 offen offset:1024 sc1
    s_mov_b64 exec, -1
    v_cmp_le_u32 vcc, s82, v45
    v_cmp_ge_u32 s[88:89], s83, v45
    s_and_b64 exec, vcc, s[88:89]
    s_waitcnt lgkmcnt(0)
    buffer_store_dwordx4 v[60:63], v46, s[76:79], s80 offen offset:2048 sc1
    s_mov_b64 exec, -1
L_rskipb0_0:
L_bskip0_0:
    s_barrier
    s_mov_b32 s72, 4294945074
    s_cmp_eq_u32 s14, 1
    s_cselect_b32 s72, 4294939704, s72
    s_cmp_eq_u32 s14, 2
    s_cselect_b32 s72, 4294939704, s72
    s_cmp_eq_u32 s14, 3
    s_cselect_b32 s72, 4294965298, s72
    s_cmp_eq_u32 s14, 4
    s_cselect_b32 s72, 4294940727, s72
    s_lshl_b32 s87, s17, 2
    s_lshr_b32 s87, s72, s87
    s_and_b32 s87, s87, 15
    s_cmp_eq_u32 s87, 15
    s_cbranch_scc1 L_bskip1_0
    s_add_u32 s80, s15, s87
    s_cmp_ge_u32 s80, 224
    s_cbranch_scc1 L_rskipb1_0
    s_mul_i32 s80, s80, 43008
    s_mul_i32 s3, s12, 192
    s_add_u32 s80, s80, s3
    s_mul_i32 s81, s87, 3072
    v_add_u32 v47, s81, v40
    v_add_u32 v48, s81, v41
    v_add_u32 v49, s81, v42
    ds_read_b128 v[52:55], v47
    ds_read_b128 v[56:59], v48
    ds_read_b128 v[60:63], v49
    s_mov_b32 s82, 0
    s_mov_b32 s83, 2
    s_cmp_eq_u32 s87, 0
    s_cselect_b32 s82, s84, 0
    s_cmp_eq_u32 s87, s85
    s_cselect_b32 s83, s86, 2
    v_cmp_le_u32 vcc, s82, v43
    v_cmp_ge_u32 s[88:89], s83, v43
    s_and_b64 exec, vcc, s[88:89]
    s_waitcnt lgkmcnt(2)
    buffer_store_dwordx4 v[52:55], v46, s[76:79], s80 offen offset:0 sc1
    s_mov_b64 exec, -1
    v_cmp_le_u32 vcc, s82, v44
    v_cmp_ge_u32 s[88:89], s83, v44
    s_and_b64 exec, vcc, s[88:89]
    s_waitcnt lgkmcnt(1)
    buffer_store_dwordx4 v[56:59], v46, s[76:79], s80 offen offset:1024 sc1
    s_mov_b64 exec, -1
    v_cmp_le_u32 vcc, s82, v45
    v_cmp_ge_u32 s[88:89], s83, v45
    s_and_b64 exec, vcc, s[88:89]
    s_waitcnt lgkmcnt(0)
    buffer_store_dwordx4 v[60:63], v46, s[76:79], s80 offen offset:2048 sc1
    s_mov_b64 exec, -1
L_rskipb1_0:
L_bskip1_0:
    s_mov_b32 s87, 4294751828
    s_cmp_eq_u32 s14, 1
    s_cselect_b32 s87, 4292654682, s87
    s_cmp_eq_u32 s14, 2
    s_cselect_b32 s87, 4294751834, s87
    s_cmp_eq_u32 s14, 3
    s_cselect_b32 s87, 4294945108, s87
    s_cmp_eq_u32 s14, 4
    s_cselect_b32 s87, 4294949460, s87
    s_lshl_b32 s3, s16, 2
    s_lshr_b32 s87, s87, s3
    s_and_b32 s87, s87, 15
    s_add_u32 s80, s15, s87
    s_mul_i32 s80, s80, 43008
    s_mul_i32 s3, s12, 192
    s_add_u32 s80, s80, s3
    s_mul_i32 s81, s87, 3072
    v_add_u32 v47, s81, v40
    v_add_u32 v48, s81, v41
    v_add_u32 v49, s81, v42
    s_cmp_eq_u32 s87, 0
    s_cselect_b32 s82, s84, 0
    s_cmp_eq_u32 s87, s85
    s_cselect_b32 s83, s86, 2
    v_cmp_le_u32 vcc, s82, v43
    v_cmp_ge_u32 s[64:65], s83, v43
    s_nop 0
    s_and_b64 s[64:65], s[64:65], vcc
    v_cmp_le_u32 vcc, s82, v44
    v_cmp_ge_u32 s[66:67], s83, v44
    s_nop 0
    s_and_b64 s[66:67], s[66:67], vcc
    v_cmp_le_u32 vcc, s82, v45
    v_cmp_ge_u32 s[68:69], s83, v45
    s_nop 0
    s_and_b64 s[68:69], s[68:69], vcc
    s_barrier
    s_branch L_store
L_small:
    s_sub_u32 s11, s2, 224
    s_cmp_ge_u32 s11, 14
    s_cselect_b32 s14, 4, 3
    s_cselect_b32 s15, 10, 0
    s_cselect_b32 s12, 14, 0
    s_sub_u32 s12, s11, s12
    s_branch L_decoded
L_exit0:
    s_endpgm
L_compute:
    s_and_b32 s17, s16, 1
    s_lshr_b32 s18, s16, 1
    s_mov_b32 s3, 1552
    s_cmp_eq_u32 s14, 1
    s_cselect_b32 s3, 1794, s3
    s_cmp_eq_u32 s14, 2
    s_cselect_b32 s3, 1569, s3
    s_cmp_eq_u32 s14, 3
    s_cselect_b32 s3, 1347, s3
    s_cmp_eq_u32 s14, 4
    s_cselect_b32 s3, 1589, s3
    s_lshl_b32 s19, s18, 2
    s_lshr_b32 s19, s3, s19
    s_and_b32 s19, s19, 15
    s_lshr_b32 s3, s3, 8
    s_mul_i32 s18, s18, s3
    s_cmp_eq_u32 s19, 1
    s_cbranch_scc1 L_cls1
    s_cmp_eq_u32 s19, 2
    s_cbranch_scc1 L_cls2
    s_cmp_eq_u32 s19, 3
    s_cbranch_scc1 L_cls3
    s_cmp_eq_u32 s19, 4
    s_cbranch_scc1 L_cls4
    s_cmp_eq_u32 s19, 5
    s_cbranch_scc1 L_cls5
    s_branch L_cls0
L_cls0:
    s_waitcnt lgkmcnt(0)
    v_and_b32 v15, 15, v1
    v_lshrrev_b32 v17, 4, v1
    v_bfe_u32 v18, v1, 2, 2
    v_lshl_add_u32 v18, v17, 3, v18
    v_mul_u32_u24 v18, 192, v18
    v_and_b32 v19, 3, v1
    v_lshl_add_u32 v18, v19, 3, v18
    v_add_u32 v18, 69120, v18
    v_and_b32 v19, 1, v17
    v_lshlrev_b32 v19, 5, v19
    s_lshl_b32 s20, s17, 5
    s_add_u32 s21, s20, 64
    s_add_u32 s22, s20, 128
    v_xor_b32 v6, s20, v19
    v_add_u32 v6, v6, v18
    v_xor_b32 v7, s21, v19
    v_add_u32 v7, v7, v18
    v_xor_b32 v8, s22, v19
    v_add_u32 v8, v8, v18
    s_and_b32 s3, s18, 1
    s_lshl_b32 s3, s3, 1
    v_xor_b32 v16, s3, v17
    s_mul_i32 s25, s18, 1280
    v_lshrrev_b32 v18, 1, v15
    v_and_b32 v18, 2, v18
    v_xor_b32 v18, v18, v16
    v_lshlrev_b32 v18, 4, v18
    v_lshl_add_u32 v18, v15, 6, v18
    v_add_u32 v4, s25, v18
    v_xor_b32 v5, 32, v4
    s_barrier
    ds_read_b64_tr_b16 v[192:193], v6 offset:0
    ds_read_b64_tr_b16 v[194:195], v6 offset:768
    ds_read_b128 v[148:151], v4 offset:0
    ds_read_b64_tr_b16 v[196:197], v7 offset:0
    ds_read_b64_tr_b16 v[198:199], v7 offset:768
    ds_read_b64_tr_b16 v[200:201], v8 offset:0
    ds_read_b64_tr_b16 v[202:203], v8 offset:768
    s_waitcnt lgkmcnt(4)
    v_mfma_f32_16x16x32_bf16 v[64:67], v[192:195], v[148:151], 0
    s_waitcnt lgkmcnt(2)
    v_mfma_f32_16x16x32_bf16 v[68:71], v[196:199], v[148:151], 0
    s_waitcnt lgkmcnt(0)
    v_mfma_f32_16x16x32_bf16 v[72:75], v[200:203], v[148:151], 0
    v_add_u32 v19, 1, v15
    v_lshrrev_b32 v18, 1, v19
    v_and_b32 v18, 2, v18
    v_xor_b32 v18, v18, v16
    v_lshlrev_b32 v18, 4, v18
    v_lshl_add_u32 v18, v19, 6, v18
    v_add_u32 v2, s25, v18
    v_xor_b32 v3, 32, v2
    v_lshrrev_b32 v18, 1, v17
    s_lshl_b32 s3, s17, 1
    v_add_u32 v18, s3, v18
    v_bfe_u32 v19, v15, 1, 2
    s_barrier
    ds_read_b128 v[152:155], v5 offset:1280
    ds_read_b64_tr_b16 v[204:205], v6 offset:6144
    ds_read_b64_tr_b16 v[206:207], v6 offset:6912
    ds_read_b64_tr_b16 v[208:209], v7 offset:6144
    ds_read_b64_tr_b16 v[210:211], v7 offset:6912
    ds_read_b64_tr_b16 v[212:213], v8 offset:6144
    ds_read_b64_tr_b16 v[214:215], v8 offset:6912
    s_waitcnt lgkmcnt(6)
    v_mfma_f32_16x16x32_bf16 v[76:79], v[192:195], v[152:155], 0
    v_mfma_f32_16x16x32_bf16 v[80:83], v[196:199], v[152:155], 0
    v_mfma_f32_16x16x32_bf16 v[84:87], v[200:203], v[152:155], 0
    s_waitcnt lgkmcnt(4)
    v_mfma_f32_16x16x32_bf16 v[64:67], v[204:207], v[152:155], v[64:67]
    s_waitcnt lgkmcnt(2)
    v_mfma_f32_16x16x32_bf16 v[68:71], v[208:211], v[152:155], v[68:71]
    s_waitcnt lgkmcnt(0)
    v_mfma_f32_16x16x32_bf16 v[72:75], v[212:215], v[152:155], v[72:75]
    v_xor_b32 v18, v18, v19
    v_mul_u32_u24 v20, 192, v15
    v_lshl_add_u32 v20, v18, 4, v20
    v_and_b32 v19, 1, v17
    v_lshl_add_u32 v20, v19, 3, v20
    s_mul_i32 s3, s18, 3072
    v_add_u32 v20, s3, v20
    s_mov_b32 s24, 1
    s_mov_b32 s26, 30720
    s_mov_b32 s27, 1
    s_add_u32 s23, s25, 46080
    v_add_u32 v19, 4, v15
    s_barrier
    ds_read_b128 v[156:159], v4 offset:2560
    ds_read_b64_tr_b16 v[216:217], v6 offset:12288
    ds_read_b64_tr_b16 v[218:219], v6 offset:13056
    ds_read_b64_tr_b16 v[220:221], v7 offset:12288
    ds_read_b64_tr_b16 v[222:223], v7 offset:13056
    s_waitcnt lgkmcnt(4)
    v_mfma_f32_16x16x32_bf16 v[88:91], v[192:195], v[156:159], 0
    ds_read_b64_tr_b16 v[224:225], v8 offset:12288
    ds_read_b64_tr_b16 v[226:227], v8 offset:13056
    v_mfma_f32_16x16x32_bf16 v[92:95], v[196:199], v[156:159], 0
    v_mfma_f32_16x16x32_bf16 v[96:99], v[200:203], v[156:159], 0
    v_mfma_f32_16x16x32_bf16 v[76:79], v[204:207], v[156:159], v[76:79]
    v_mfma_f32_16x16x32_bf16 v[80:83], v[208:211], v[156:159], v[80:83]
    v_mfma_f32_16x16x32_bf16 v[84:87], v[212:215], v[156:159], v[84:87]
    s_waitcnt lgkmcnt(4)
    v_mfma_f32_16x16x32_bf16 v[64:67], v[216:219], v[156:159], v[64:67]
    s_waitcnt lgkmcnt(2)
    v_mfma_f32_16x16x32_bf16 v[68:71], v[220:223], v[156:159], v[68:71]
    s_waitcnt lgkmcnt(0)
    v_mfma_f32_16x16x32_bf16 v[72:75], v[224:227], v[156:159], v[72:75]
    v_lshrrev_b32 v18, 1, v19
    v_and_b32 v18, 2, v18
    v_xor_b32 v18, v18, v16
    v_lshlrev_b32 v18, 4, v18
    v_lshl_add_u32 v18, v19, 6, v18
    v_add_u32 v26, s23, v18
    v_xor_b32 v27, 32, v26
    v_lshlrev_b32 v46, 4, v1
    v_add_u32 v47, 0, v1
    v_mul_u32_u24 v48, 5462, v47
    v_lshrrev_b32 v48, 16, v48
    v_mul_u32_u24 v49, 12, v48
    s_barrier
    ds_read_b128 v[160:163], v5 offset:3840
    ds_read_b64_tr_b16 v[228:229], v6 offset:18432
    s_waitcnt lgkmcnt(1)
    v_mfma_f32_16x16x32_bf16 v[100:103], v[192:195], v[160:163], 0
    ds_read_b64_tr_b16 v[230:231], v6 offset:19200
    ds_read_b64_tr_b16 v[232:233], v7 offset:18432
    ds_read_b64_tr_b16 v[234:235], v7 offset:19200
    v_mfma_f32_16x16x32_bf16 v[104:107], v[196:199], v[160:163], 0
    ds_read_b64_tr_b16 v[236:237], v8 offset:18432
    ds_read_b64_tr_b16 v[238:239], v8 offset:19200
    v_mfma_f32_16x16x32_bf16 v[108:111], v[200:203], v[160:163], 0
    v_mfma_f32_16x16x32_bf16 v[88:91], v[204:207], v[160:163], v[88:91]
    v_mfma_f32_16x16x32_bf16 v[92:95], v[208:211], v[160:163], v[92:95]
    v_sub_u32 v49, v47, v49
    v_lshrrev_b32 v43, 2, v49
    v_bfe_u32 v50, v48, 1, 2
    v_xor_b32 v50, v50, v49
    v_and_b32 v50, 3, v50
    v_and_b32 v49, 12, v49
    v_or_b32 v49, v49, v50
    v_mul_u32_u24 v48, 192, v48
    v_lshl_add_u32 v40, v49, 4, v48
    v_add_u32 v47, 64, v1
    v_mul_u32_u24 v48, 5462, v47
    v_lshrrev_b32 v48, 16, v48
    s_barrier
    ds_read_b128 v[164:167], v4 offset:5120
    v_mfma_f32_16x16x32_bf16 v[96:99], v[212:215], v[160:163], v[96:99]
    ds_read_b64_tr_b16 v[240:241], v6 offset:24576
    ds_read_b64_tr_b16 v[242:243], v6 offset:25344
    v_mfma_f32_16x16x32_bf16 v[76:79], v[216:219], v[160:163], v[76:79]
    ds_read_b64_tr_b16 v[244:245], v7 offset:24576
    ds_read_b64_tr_b16 v[246:247], v7 offset:25344
    v_mfma_f32_16x16x32_bf16 v[80:83], v[220:223], v[160:163], v[80:83]
    ds_read_b64_tr_b16 v[248:249], v8 offset:24576
    ds_read_b64_tr_b16 v[250:251], v8 offset:25344
    v_mfma_f32_16x16x32_bf16 v[84:87], v[224:227], v[160:163], v[84:87]
    s_waitcnt lgkmcnt(9)
    v_mfma_f32_16x16x32_bf16 v[64:67], v[228:231], v[160:163], v[64:67]
    v_mfma_f32_16x16x32_bf16 v[68:71], v[232:235], v[160:163], v[68:71]
    s_waitcnt lgkmcnt(7)
    v_mfma_f32_16x16x32_bf16 v[72:75], v[236:239], v[160:163], v[72:75]
    s_waitcnt lgkmcnt(6)
    v_mfma_f32_16x16x32_bf16 v[112:115], v[192:195], v[164:167], 0
    v_mfma_f32_16x16x32_bf16 v[116:119], v[196:199], v[164:167], 0
    v_mfma_f32_16x16x32_bf16 v[120:123], v[200:203], v[164:167], 0
    v_mfma_f32_16x16x32_bf16 v[100:103], v[204:207], v[164:167], v[100:103]
    v_mfma_f32_16x16x32_bf16 v[104:107], v[208:211], v[164:167], v[104:107]
    v_mfma_f32_16x16x32_bf16 v[108:111], v[212:215], v[164:167], v[108:111]
    v_mfma_f32_16x16x32_bf16 v[88:91], v[216:219], v[164:167], v[88:91]
    v_mfma_f32_16x16x32_bf16 v[92:95], v[220:223], v[164:167], v[92:95]
    v_mul_u32_u24 v49, 12, v48
    v_sub_u32 v49, v47, v49
    v_lshrrev_b32 v44, 2, v49
    v_bfe_u32 v50, v48, 1, 2
    v_xor_b32 v50, v50, v49
    v_and_b32 v50, 3, v50
    v_and_b32 v49, 12, v49
    v_or_b32 v49, v49, v50
    v_mul_u32_u24 v48, 192, v48
    v_lshl_add_u32 v41, v49, 4, v48
    v_add_u32 v47, 128, v1
    v_mul_u32_u24 v48, 5462, v47
    s_barrier
    ds_read_b128 v[168:171], v5 offset:6400
    v_mfma_f32_16x16x32_bf16 v[96:99], v[224:227], v[164:167], v[96:99]
    v_mfma_f32_16x16x32_bf16 v[76:79], v[228:231], v[164:167], v[76:79]
    v_mfma_f32_16x16x32_bf16 v[80:83], v[232:235], v[164:167], v[80:83]
    v_mfma_f32_16x16x32_bf16 v[84:87], v[236:239], v[164:167], v[84:87]
    s_waitcnt lgkmcnt(1)
    v_mfma_f32_16x16x32_bf16 v[64:67], v[240:243], v[164:167], v[64:67]
    v_mfma_f32_16x16x32_bf16 v[68:71], v[244:247], v[164:167], v[68:71]
    v_mfma_f32_16x16x32_bf16 v[72:75], v[248:251], v[164:167], v[72:75]
    s_waitcnt lgkmcnt(0)
    v_mfma_f32_16x16x32_bf16 v[124:127], v[192:195], v[168:171], 0
    v_mfma_f32_16x16x32_bf16 v[128:131], v[196:199], v[168:171], 0
    v_mfma_f32_16x16x32_bf16 v[132:135], v[200:203], v[168:171], 0
    v_mfma_f32_16x16x32_bf16 v[112:115], v[204:207], v[168:171], v[112:115]
    v_mfma_f32_16x16x32_bf16 v[116:119], v[208:211], v[168:171], v[116:119]
    v_mfma_f32_16x16x32_bf16 v[120:123], v[212:215], v[168:171], v[120:123]
    v_mfma_f32_16x16x32_bf16 v[100:103], v[216:219], v[168:171], v[100:103]
    v_mfma_f32_16x16x32_bf16 v[104:107], v[220:223], v[168:171], v[104:107]
    v_lshrrev_b32 v48, 16, v48
    v_mul_u32_u24 v49, 12, v48
    v_sub_u32 v49, v47, v49
    v_lshrrev_b32 v45, 2, v49
    v_bfe_u32 v50, v48, 1, 2
    v_xor_b32 v50, v50, v49
    v_and_b32 v50, 3, v50
    v_and_b32 v49, 12, v49
    v_or_b32 v49, v49, v50
    v_mul_u32_u24 v48, 192, v48
    v_lshl_add_u32 v42, v49, 4, v48
    s_mov_b32 s76, s8
    s_barrier
    ds_read_b128 v[172:175], v4 offset:7680
    v_mfma_f32_16x16x32_bf16 v[108:111], v[224:227], v[168:171], v[108:111]
    s_mov_b32 s77, s9
    s_mov_b32 s78, 9633792
    v_mfma_f32_16x16x32_bf16 v[88:91], v[228:231], v[168:171], v[88:91]
    s_mov_b32 s79, 0x20000
    s_mov_b32 s85, 3088
    v_mfma_f32_16x16x32_bf16 v[92:95], v[232:235], v[168:171], v[92:95]
    s_cmp_eq_u32 s14, 1
    s_cselect_b32 s85, 3330, s85
    v_mfma_f32_16x16x32_bf16 v[96:99], v[236:239], v[168:171], v[96:99]
    s_cmp_eq_u32 s14, 2
    ds_read_b128 v[176:179], v5 offset:8960
    v_mfma_f32_16x16x32_bf16 v[76:79], v[240:243], v[168:171], v[76:79]
    s_cselect_b32 s85, 25377, s85
    s_cmp_eq_u32 s14, 3
    v_mfma_f32_16x16x32_bf16 v[80:83], v[244:247], v[168:171], v[80:83]
    s_cselect_b32 s85, 2576, s85
    s_cmp_eq_u32 s14, 4
    v_mfma_f32_16x16x32_bf16 v[84:87], v[248:251], v[168:171], v[84:87]
    s_cselect_b32 s85, 2818, s85
    s_and_b32 s84, s85, 15
    s_waitcnt lgkmcnt(1)
    v_mfma_f32_16x16x32_bf16 v[136:139], v[192:195], v[172:175], 0
    s_bfe_u32 s86, s85, 0x40004
    s_lshr_b32 s85, s85, 8
    v_mfma_f32_16x16x32_bf16 v[124:127], v[204:207], v[172:175], v[124:127]
    s_mov_b32 s87, 4294751828
    s_cmp_eq_u32 s14, 1
    v_mfma_f32_16x16x32_bf16 v[128:131], v[208:211], v[172:175], v[128:131]
    s_cselect_b32 s87, 4292654682, s87
    s_cmp_eq_u32 s14, 2
    v_mfma_f32_16x16x32_bf16 v[132:135], v[212:215], v[172:175], v[132:135]
    s_cselect_b32 s87, 4294751834, s87
    ds_read_b128 v[180:183], v4 offset:10240
    v_mfma_f32_16x16x32_bf16 v[112:115], v[216:219], v[172:175], v[112:115]
    s_cmp_eq_u32 s14, 3
    s_cselect_b32 s87, 4294945108, s87
    v_mfma_f32_16x16x32_bf16 v[116:119], v[220:223], v[172:175], v[116:119]
    s_cmp_eq_u32 s14, 4
    s_cselect_b32 s87, 4294949460, s87
    v_mfma_f32_16x16x32_bf16 v[120:123], v[224:227], v[172:175], v[120:123]
    s_lshl_b32 s3, s16, 2
    s_lshr_b32 s87, s87, s3
    v_mfma_f32_16x16x32_bf16 v[100:103], v[228:231], v[172:175], v[100:103]
    s_and_b32 s87, s87, 15
    s_add_u32 s80, s15, s87
    v_mfma_f32_16x16x32_bf16 v[104:107], v[232:235], v[172:175], v[104:107]
    s_barrier
    s_mul_i32 s80, s80, 43008
    v_mfma_f32_16x16x32_bf16 v[108:111], v[236:239], v[172:175], v[108:111]
    s_mul_i32 s3, s12, 192
    ds_read_b128 v[184:187], v5 offset:11520
    v_mfma_f32_16x16x32_bf16 v[88:91], v[240:243], v[172:175], v[88:91]
    s_add_u32 s80, s80, s3
    s_mul_i32 s81, s87, 3072
    v_mfma_f32_16x16x32_bf16 v[92:95], v[244:247], v[172:175], v[92:95]
    v_add_u32 v47, s81, v40
    ds_read_b128 v[148:151], v2 offset:0
    v_mfma_f32_16x16x32_bf16 v[96:99], v[248:251], v[172:175], v[96:99]
    ds_read_b128 v[152:155], v3 offset:1280
    ds_read_b128 v[156:159], v2 offset:2560
    s_waitcnt lgkmcnt(4)
    v_mfma_f32_16x16x32_bf16 v[136:139], v[204:207], v[176:179], v[136:139]
    ds_read_b64_tr_b16 v[192:193], v6 offset:30720
    ds_read_b64_tr_b16 v[194:195], v6 offset:31488
    v_mfma_f32_16x16x32_bf16 v[124:127], v[216:219], v[176:179], v[124:127]
    ds_read_b128 v[160:163], v3 offset:3840
    ds_read_b64_tr_b16 v[196:197], v7 offset:30720
    v_mfma_f32_16x16x32_bf16 v[128:131], v[220:223], v[176:179], v[128:131]
    ds_read_b64_tr_b16 v[198:199], v7 offset:31488
    ds_read_b128 v[164:167], v2 offset:5120
    v_mfma_f32_16x16x32_bf16 v[132:135], v[224:227], v[176:179], v[132:135]
    ds_read_b128 v[168:171], v3 offset:6400
    ds_read_b128 v[172:175], v2 offset:7680
    v_mfma_f32_16x16x32_bf16 v[112:115], v[228:231], v[176:179], v[112:115]
    ds_read_b64_tr_b16 v[200:201], v8 offset:30720
    ds_read_b64_tr_b16 v[202:203], v8 offset:31488
    v_mfma_f32_16x16x32_bf16 v[116:119], v[232:235], v[176:179], v[116:119]
    v_add_u32 v48, s81, v41
    v_add_u32 v49, s81, v42
    v_mfma_f32_16x16x32_bf16 v[120:123], v[236:239], v[176:179], v[120:123]
    ds_read_b128 v[188:191], v4 offset:12800
    s_cmp_eq_u32 s87, 0
    v_mfma_f32_16x16x32_bf16 v[100:103], v[240:243], v[176:179], v[100:103]
    s_cselect_b32 s82, s84, 0
    s_cmp_eq_u32 s87, s85
    v_mfma_f32_16x16x32_bf16 v[104:107], v[244:247], v[176:179], v[104:107]
    s_cselect_b32 s83, s86, 2
    v_cmp_le_u32 vcc, s82, v43
    v_mfma_f32_16x16x32_bf16 v[108:111], v[248:251], v[176:179], v[108:111]
    v_cmp_ge_u32 s[64:65], s83, v43
    s_nop 0
    v_mfma_f32_16x16x32_bf16 v[136:139], v[216:219], v[180:183], v[136:139]
    s_and_b64 s[64:65], s[64:65], vcc
    v_cmp_le_u32 vcc, s82, v44
    v_mfma_f32_16x16x32_bf16 v[124:127], v[228:231], v[180:183], v[124:127]
    v_cmp_ge_u32 s[66:67], s83, v44
    v_mfma_f32_16x16x32_bf16 v[128:131], v[232:235], v[180:183], v[128:131]
    s_nop 0
    v_mfma_f32_16x16x32_bf16 v[132:135], v[236:239], v[180:183], v[132:135]
    s_and_b64 s[66:67], s[66:67], vcc
    v_cmp_le_u32 vcc, s82, v45
    v_mfma_f32_16x16x32_bf16 v[112:115], v[240:243], v[180:183], v[112:115]
    v_cmp_ge_u32 s[68:69], s83, v45
    s_nop 0
    v_mfma_f32_16x16x32_bf16 v[116:119], v[244:247], v[180:183], v[116:119]
    s_and_b64 s[68:69], s[68:69], vcc
    v_add_u32 v6, 30720, v6
    v_mfma_f32_16x16x32_bf16 v[120:123], v[248:251], v[180:183], v[120:123]
    v_add_u32 v7, 30720, v7
    v_add_u32 v8, 30720, v8
    s_waitcnt lgkmcnt(0)
    v_mfma_f32_16x16x32_bf16 v[136:139], v[228:231], v[184:187], v[136:139]
    v_mfma_f32_16x16x32_bf16 v[124:127], v[240:243], v[184:187], v[124:127]
    v_mfma_f32_16x16x32_bf16 v[128:131], v[244:247], v[184:187], v[128:131]
    v_mfma_f32_16x16x32_bf16 v[132:135], v[248:251], v[184:187], v[132:135]
    v_mfma_f32_16x16x32_bf16 v[136:139], v[240:243], v[188:191], v[136:139]
    s_waitcnt lgkmcnt(0)
    s_waitcnt vmcnt(0)
L_loop0:
    ds_read_b64_tr_b16 v[204:205], v6 offset:6144
    s_waitcnt lgkmcnt(3)
    v_mfma_f32_16x16x32_bf16 v[64:67], v[192:195], v[148:151], v[64:67]
    ds_read_b64_tr_b16 v[206:207], v6 offset:6912
    v_mfma_f32_16x16x32_bf16 v[76:79], v[192:195], v[152:155], v[76:79]
    ds_read_b128 v[176:179], v3 offset:8960
    v_mfma_f32_16x16x32_bf16 v[88:91], v[192:195], v[156:159], v[88:91]
    ds_read_b64_tr_b16 v[208:209], v7 offset:6144
    v_mfma_f32_16x16x32_bf16 v[100:103], v[192:195], v[160:163], v[100:103]
    ds_read_b64_tr_b16 v[210:211], v7 offset:6912
    v_mfma_f32_16x16x32_bf16 v[68:71], v[196:199], v[148:151], v[68:71]
    ds_read_b128 v[180:183], v2 offset:10240
    v_mfma_f32_16x16x32_bf16 v[80:83], v[196:199], v[152:155], v[80:83]
    ds_read_b128 v[184:187], v3 offset:11520
    v_mfma_f32_16x16x32_bf16 v[92:95], v[196:199], v[156:159], v[92:95]
    ds_read_b128 v[188:191], v2 offset:12800
    v_mfma_f32_16x16x32_bf16 v[104:107], v[196:199], v[160:163], v[104:107]
    s_add_u32 s24, s24, 1
    s_waitcnt lgkmcnt(7)
    v_mfma_f32_16x16x32_bf16 v[72:75], v[200:203], v[148:151], v[72:75]
    s_cmp_eq_u32 s24, 5
    v_mfma_f32_16x16x32_bf16 v[84:87], v[200:203], v[152:155], v[84:87]
    s_cselect_b32 s3, 23040, 0
    v_mfma_f32_16x16x32_bf16 v[96:99], v[200:203], v[156:159], v[96:99]
    s_cselect_b32 s24, 0, s24
    v_mfma_f32_16x16x32_bf16 v[108:111], v[200:203], v[160:163], v[108:111]
    s_add_u32 s25, s25, s3
    v_mfma_f32_16x16x32_bf16 v[112:115], v[192:195], v[164:167], v[112:115]
    v_add_u32 v17, s24, v15
    v_mfma_f32_16x16x32_bf16 v[124:127], v[192:195], v[168:171], v[124:127]
    v_lshrrev_b32 v18, 1, v17
    v_mfma_f32_16x16x32_bf16 v[136:139], v[192:195], v[172:175], v[136:139]
    ds_read_b64_tr_b16 v[192:193], v8 offset:6144
    v_mfma_f32_16x16x32_bf16 v[116:119], v[196:199], v[164:167], v[116:119]
    ds_read_b64_tr_b16 v[194:195], v8 offset:6912
    v_mfma_f32_16x16x32_bf16 v[128:131], v[196:199], v[168:171], v[128:131]
    ds_read_b64_tr_b16 v[196:197], v6 offset:12288
    v_mfma_f32_16x16x32_bf16 v[120:123], v[200:203], v[164:167], v[120:123]
    ds_read_b64_tr_b16 v[198:199], v6 offset:13056
    v_mfma_f32_16x16x32_bf16 v[132:135], v[200:203], v[168:171], v[132:135]
    ds_read_b64_tr_b16 v[200:201], v7 offset:12288
    s_waitcnt lgkmcnt(5)
    v_mfma_f32_16x16x32_bf16 v[64:67], v[204:207], v[152:155], v[64:67]
    ds_read_b64_tr_b16 v[202:203], v7 offset:13056
    v_mfma_f32_16x16x32_bf16 v[76:79], v[204:207], v[156:159], v[76:79]
    v_and_b32 v18, 2, v18
    v_mfma_f32_16x16x32_bf16 v[88:91], v[204:207], v[160:163], v[88:91]
    v_xor_b32 v18, v18, v16
    v_mfma_f32_16x16x32_bf16 v[100:103], v[204:207], v[164:167], v[100:103]
    v_lshlrev_b32 v18, 4, v18
    v_mfma_f32_16x16x32_bf16 v[112:115], v[204:207], v[168:171], v[112:115]
    v_lshl_add_u32 v18, v17, 6, v18
    v_mfma_f32_16x16x32_bf16 v[124:127], v[204:207], v[172:175], v[124:127]
    v_add_u32 v2, s25, v18
    v_mfma_f32_16x16x32_bf16 v[136:139], v[204:207], v[176:179], v[136:139]
    ds_read_b64_tr_b16 v[204:205], v8 offset:12288
    v_mfma_f32_16x16x32_bf16 v[68:71], v[208:211], v[152:155], v[68:71]
    ds_read_b64_tr_b16 v[206:207], v8 offset:13056
    v_mfma_f32_16x16x32_bf16 v[80:83], v[208:211], v[156:159], v[80:83]
    v_xor_b32 v3, 32, v2
    v_mfma_f32_16x16x32_bf16 v[92:95], v[208:211], v[160:163], v[92:95]
    ds_read_b128 v[148:151], v2 offset:0
    v_mfma_f32_16x16x32_bf16 v[104:107], v[208:211], v[164:167], v[104:107]
    v_mfma_f32_16x16x32_bf16 v[116:119], v[208:211], v[168:171], v[116:119]
    v_mfma_f32_16x16x32_bf16 v[128:131], v[208:211], v[172:175], v[128:131]
    ds_read_b64_tr_b16 v[208:209], v6 offset:18432
    s_waitcnt lgkmcnt(4)
    v_mfma_f32_16x16x32_bf16 v[72:75], v[192:195], v[152:155], v[72:75]
    ds_read_b64_tr_b16 v[210:211], v6 offset:19200
    v_mfma_f32_16x16x32_bf16 v[84:87], v[192:195], v[156:159], v[84:87]
    ds_read_b128 v[152:155], v3 offset:1280
    v_mfma_f32_16x16x32_bf16 v[96:99], v[192:195], v[160:163], v[96:99]
    v_mfma_f32_16x16x32_bf16 v[108:111], v[192:195], v[164:167], v[108:111]
    v_mfma_f32_16x16x32_bf16 v[120:123], v[192:195], v[168:171], v[120:123]
    v_mfma_f32_16x16x32_bf16 v[132:135], v[192:195], v[172:175], v[132:135]
    ds_read_b64_tr_b16 v[192:193], v7 offset:18432
    v_mfma_f32_16x16x32_bf16 v[64:67], v[196:199], v[156:159], v[64:67]
    ds_read_b64_tr_b16 v[194:195], v7 offset:19200
    v_mfma_f32_16x16x32_bf16 v[76:79], v[196:199], v[160:163], v[76:79]
    v_mfma_f32_16x16x32_bf16 v[88:91], v[196:199], v[164:167], v[88:91]
    v_mfma_f32_16x16x32_bf16 v[100:103], v[196:199], v[168:171], v[100:103]
    v_mfma_f32_16x16x32_bf16 v[112:115], v[196:199], v[172:175], v[112:115]
    v_mfma_f32_16x16x32_bf16 v[124:127], v[196:199], v[176:179], v[124:127]
    v_mfma_f32_16x16x32_bf16 v[136:139], v[196:199], v[180:183], v[136:139]
    ds_read_b64_tr_b16 v[196:197], v8 offset:18432
    v_mfma_f32_16x16x32_bf16 v[68:71], v[200:203], v[156:159], v[68:71]
    ds_read_b64_tr_b16 v[198:199], v8 offset:19200
    v_mfma_f32_16x16x32_bf16 v[80:83], v[200:203], v[160:163], v[80:83]
    v_mfma_f32_16x16x32_bf16 v[92:95], v[200:203], v[164:167], v[92:95]
    v_mfma_f32_16x16x32_bf16 v[104:107], v[200:203], v[168:171], v[104:107]
    v_mfma_f32_16x16x32_bf16 v[116:119], v[200:203], v[172:175], v[116:119]
    v_mfma_f32_16x16x32_bf16 v[128:131], v[200:203], v[176:179], v[128:131]
    ds_read_b64_tr_b16 v[200:201], v6 offset:24576
    s_waitcnt lgkmcnt(3)
    v_mfma_f32_16x16x32_bf16 v[72:75], v[204:207], v[156:159], v[72:75]
    ds_read_b64_tr_b16 v[202:203], v6 offset:25344
    v_mfma_f32_16x16x32_bf16 v[84:87], v[204:207], v[160:163], v[84:87]
    s_add_u32 s26, s26, 30720
    v_mfma_f32_16x16x32_bf16 v[96:99], v[204:207], v[164:167], v[96:99]
    s_cmp_eq_u32 s26, 92160
    v_mfma_f32_16x16x32_bf16 v[108:111], v[204:207], v[168:171], v[108:111]
    s_cselect_b32 s33, 4294875136, 0
    v_mfma_f32_16x16x32_bf16 v[120:123], v[204:207], v[172:175], v[120:123]
    s_cselect_b32 s26, 0, s26
    v_mfma_f32_16x16x32_bf16 v[132:135], v[204:207], v[176:179], v[132:135]
    ds_read_b64_tr_b16 v[204:205], v7 offset:24576
    v_mfma_f32_16x16x32_bf16 v[64:67], v[208:211], v[160:163], v[64:67]
    ds_read_b64_tr_b16 v[206:207], v7 offset:25344
    v_mfma_f32_16x16x32_bf16 v[76:79], v[208:211], v[164:167], v[76:79]
    s_add_u32 s33, s33, 30720
    v_mfma_f32_16x16x32_bf16 v[88:91], v[208:211], v[168:171], v[88:91]
    ds_read_b128 v[156:159], v2 offset:2560
    v_mfma_f32_16x16x32_bf16 v[100:103], v[208:211], v[172:175], v[100:103]
    v_mfma_f32_16x16x32_bf16 v[112:115], v[208:211], v[176:179], v[112:115]
    v_mfma_f32_16x16x32_bf16 v[124:127], v[208:211], v[180:183], v[124:127]
    v_mfma_f32_16x16x32_bf16 v[136:139], v[208:211], v[184:187], v[136:139]
    ds_read_b64_tr_b16 v[208:209], v8 offset:24576
    v_mfma_f32_16x16x32_bf16 v[68:71], v[192:195], v[160:163], v[68:71]
    ds_read_b64_tr_b16 v[210:211], v8 offset:25344
    v_mfma_f32_16x16x32_bf16 v[80:83], v[192:195], v[164:167], v[80:83]
    v_add_u32 v6, s33, v6
    v_mfma_f32_16x16x32_bf16 v[92:95], v[192:195], v[168:171], v[92:95]
    v_add_u32 v7, s33, v7
    v_mfma_f32_16x16x32_bf16 v[104:107], v[192:195], v[172:175], v[104:107]
    v_add_u32 v8, s33, v8
    v_mfma_f32_16x16x32_bf16 v[116:119], v[192:195], v[176:179], v[116:119]
    v_mfma_f32_16x16x32_bf16 v[128:131], v[192:195], v[180:183], v[128:131]
    s_waitcnt lgkmcnt(2)
    v_mfma_f32_16x16x32_bf16 v[72:75], v[196:199], v[160:163], v[72:75]
    s_waitcnt lgkmcnt(0)
    s_barrier
    v_mfma_f32_16x16x32_bf16 v[84:87], v[196:199], v[164:167], v[84:87]
    ds_read_b64_tr_b16 v[192:193], v6 offset:0
    v_mfma_f32_16x16x32_bf16 v[96:99], v[196:199], v[168:171], v[96:99]
    ds_read_b64_tr_b16 v[194:195], v6 offset:768
    v_mfma_f32_16x16x32_bf16 v[108:111], v[196:199], v[172:175], v[108:111]
    ds_read_b128 v[160:163], v3 offset:3840
    v_mfma_f32_16x16x32_bf16 v[120:123], v[196:199], v[176:179], v[120:123]
    v_mfma_f32_16x16x32_bf16 v[132:135], v[196:199], v[180:183], v[132:135]
    ds_read_b64_tr_b16 v[196:197], v7 offset:0
    v_mfma_f32_16x16x32_bf16 v[64:67], v[200:203], v[164:167], v[64:67]
    ds_read_b64_tr_b16 v[198:199], v7 offset:768
    v_mfma_f32_16x16x32_bf16 v[76:79], v[200:203], v[168:171], v[76:79]
    v_mfma_f32_16x16x32_bf16 v[88:91], v[200:203], v[172:175], v[88:91]
    v_mfma_f32_16x16x32_bf16 v[68:71], v[204:207], v[164:167], v[68:71]
    v_mfma_f32_16x16x32_bf16 v[80:83], v[204:207], v[168:171], v[80:83]
    v_mfma_f32_16x16x32_bf16 v[92:95], v[204:207], v[172:175], v[92:95]
    v_mfma_f32_16x16x32_bf16 v[72:75], v[208:211], v[164:167], v[72:75]
    ds_read_b128 v[164:167], v2 offset:5120
    v_mfma_f32_16x16x32_bf16 v[84:87], v[208:211], v[168:171], v[84:87]
    ds_read_b128 v[168:171], v3 offset:6400
    v_mfma_f32_16x16x32_bf16 v[96:99], v[208:211], v[172:175], v[96:99]
    ds_read_b128 v[172:175], v2 offset:7680
    v_mfma_f32_16x16x32_bf16 v[100:103], v[200:203], v[176:179], v[100:103]
    v_mfma_f32_16x16x32_bf16 v[112:115], v[200:203], v[180:183], v[112:115]
    v_mfma_f32_16x16x32_bf16 v[124:127], v[200:203], v[184:187], v[124:127]
    v_mfma_f32_16x16x32_bf16 v[136:139], v[200:203], v[188:191], v[136:139]
    ds_read_b64_tr_b16 v[200:201], v8 offset:0
    v_mfma_f32_16x16x32_bf16 v[104:107], v[204:207], v[176:179], v[104:107]
    ds_read_b64_tr_b16 v[202:203], v8 offset:768
    v_mfma_f32_16x16x32_bf16 v[116:119], v[204:207], v[180:183], v[116:119]
    v_mfma_f32_16x16x32_bf16 v[128:131], v[204:207], v[184:187], v[128:131]
    v_mfma_f32_16x16x32_bf16 v[108:111], v[208:211], v[176:179], v[108:111]
    v_mfma_f32_16x16x32_bf16 v[120:123], v[208:211], v[180:183], v[120:123]
    v_mfma_f32_16x16x32_bf16 v[132:135], v[208:211], v[184:187], v[132:135]
    ds_read_b64_tr_b16 v[204:205], v6 offset:6144
    s_waitcnt lgkmcnt(3)
    v_mfma_f32_16x16x32_bf16 v[64:67], v[192:195], v[148:151], v[64:67]
    ds_read_b64_tr_b16 v[206:207], v6 offset:6912
    v_mfma_f32_16x16x32_bf16 v[76:79], v[192:195], v[152:155], v[76:79]
    ds_read_b128 v[176:179], v3 offset:8960
    v_mfma_f32_16x16x32_bf16 v[88:91], v[192:195], v[156:159], v[88:91]
    ds_read_b64_tr_b16 v[208:209], v7 offset:6144
    v_mfma_f32_16x16x32_bf16 v[100:103], v[192:195], v[160:163], v[100:103]
    ds_read_b64_tr_b16 v[210:211], v7 offset:6912
    v_mfma_f32_16x16x32_bf16 v[68:71], v[196:199], v[148:151], v[68:71]
    ds_read_b128 v[180:183], v2 offset:10240
    v_mfma_f32_16x16x32_bf16 v[80:83], v[196:199], v[152:155], v[80:83]
    ds_read_b128 v[184:187], v3 offset:11520
    v_mfma_f32_16x16x32_bf16 v[92:95], v[196:199], v[156:159], v[92:95]
    ds_read_b128 v[188:191], v2 offset:12800
    v_mfma_f32_16x16x32_bf16 v[104:107], v[196:199], v[160:163], v[104:107]
    s_add_u32 s24, s24, 1
    s_waitcnt lgkmcnt(7)
    v_mfma_f32_16x16x32_bf16 v[72:75], v[200:203], v[148:151], v[72:75]
    s_cmp_eq_u32 s24, 5
    v_mfma_f32_16x16x32_bf16 v[84:87], v[200:203], v[152:155], v[84:87]
    s_cselect_b32 s3, 23040, 0
    v_mfma_f32_16x16x32_bf16 v[96:99], v[200:203], v[156:159], v[96:99]
    s_cselect_b32 s24, 0, s24
    v_mfma_f32_16x16x32_bf16 v[108:111], v[200:203], v[160:163], v[108:111]
    s_add_u32 s25, s25, s3
    v_mfma_f32_16x16x32_bf16 v[112:115], v[192:195], v[164:167], v[112:115]
    v_add_u32 v17, s24, v15
    v_mfma_f32_16x16x32_bf16 v[124:127], v[192:195], v[168:171], v[124:127]
    v_lshrrev_b32 v18, 1, v17
    v_mfma_f32_16x16x32_bf16 v[136:139], v[192:195], v[172:175], v[136:139]
    ds_read_b64_tr_b16 v[192:193], v8 offset:6144
    v_mfma_f32_16x16x32_bf16 v[116:119], v[196:199], v[164:167], v[116:119]
    ds_read_b64_tr_b16 v[194:195], v8 offset:6912
    v_mfma_f32_16x16x32_bf16 v[128:131], v[196:199], v[168:171], v[128:131]
    ds_read_b64_tr_b16 v[196:197], v6 offset:12288
    v_mfma_f32_16x16x32_bf16 v[120:123], v[200:203], v[164:167], v[120:123]
    ds_read_b64_tr_b16 v[198:199], v6 offset:13056
    v_mfma_f32_16x16x32_bf16 v[132:135], v[200:203], v[168:171], v[132:135]
    ds_read_b64_tr_b16 v[200:201], v7 offset:12288
    s_waitcnt lgkmcnt(5)
    v_mfma_f32_16x16x32_bf16 v[64:67], v[204:207], v[152:155], v[64:67]
    ds_read_b64_tr_b16 v[202:203], v7 offset:13056
    v_mfma_f32_16x16x32_bf16 v[76:79], v[204:207], v[156:159], v[76:79]
    v_and_b32 v18, 2, v18
    v_mfma_f32_16x16x32_bf16 v[88:91], v[204:207], v[160:163], v[88:91]
    v_xor_b32 v18, v18, v16
    v_mfma_f32_16x16x32_bf16 v[100:103], v[204:207], v[164:167], v[100:103]
    v_lshlrev_b32 v18, 4, v18
    v_mfma_f32_16x16x32_bf16 v[112:115], v[204:207], v[168:171], v[112:115]
    v_lshl_add_u32 v18, v17, 6, v18
    v_mfma_f32_16x16x32_bf16 v[124:127], v[204:207], v[172:175], v[124:127]
    v_add_u32 v2, s25, v18
    v_mfma_f32_16x16x32_bf16 v[136:139], v[204:207], v[176:179], v[136:139]
    ds_read_b64_tr_b16 v[204:205], v8 offset:12288
    v_mfma_f32_16x16x32_bf16 v[68:71], v[208:211], v[152:155], v[68:71]
    ds_read_b64_tr_b16 v[206:207], v8 offset:13056
    v_mfma_f32_16x16x32_bf16 v[80:83], v[208:211], v[156:159], v[80:83]
    v_xor_b32 v3, 32, v2
    v_mfma_f32_16x16x32_bf16 v[92:95], v[208:211], v[160:163], v[92:95]
    ds_read_b128 v[148:151], v2 offset:0
    v_mfma_f32_16x16x32_bf16 v[104:107], v[208:211], v[164:167], v[104:107]
    v_mfma_f32_16x16x32_bf16 v[116:119], v[208:211], v[168:171], v[116:119]
    v_mfma_f32_16x16x32_bf16 v[128:131], v[208:211], v[172:175], v[128:131]
    ds_read_b64_tr_b16 v[208:209], v6 offset:18432
    s_waitcnt lgkmcnt(4)
    v_mfma_f32_16x16x32_bf16 v[72:75], v[192:195], v[152:155], v[72:75]
    ds_read_b64_tr_b16 v[210:211], v6 offset:19200
    v_mfma_f32_16x16x32_bf16 v[84:87], v[192:195], v[156:159], v[84:87]
    ds_read_b128 v[152:155], v3 offset:1280
    v_mfma_f32_16x16x32_bf16 v[96:99], v[192:195], v[160:163], v[96:99]
    v_mfma_f32_16x16x32_bf16 v[108:111], v[192:195], v[164:167], v[108:111]
    v_mfma_f32_16x16x32_bf16 v[120:123], v[192:195], v[168:171], v[120:123]
    v_mfma_f32_16x16x32_bf16 v[132:135], v[192:195], v[172:175], v[132:135]
    ds_read_b64_tr_b16 v[192:193], v7 offset:18432
    v_mfma_f32_16x16x32_bf16 v[64:67], v[196:199], v[156:159], v[64:67]
    ds_read_b64_tr_b16 v[194:195], v7 offset:19200
    v_mfma_f32_16x16x32_bf16 v[76:79], v[196:199], v[160:163], v[76:79]
    v_mfma_f32_16x16x32_bf16 v[88:91], v[196:199], v[164:167], v[88:91]
    v_mfma_f32_16x16x32_bf16 v[100:103], v[196:199], v[168:171], v[100:103]
    v_mfma_f32_16x16x32_bf16 v[112:115], v[196:199], v[172:175], v[112:115]
    v_mfma_f32_16x16x32_bf16 v[124:127], v[196:199], v[176:179], v[124:127]
    v_mfma_f32_16x16x32_bf16 v[136:139], v[196:199], v[180:183], v[136:139]
    ds_read_b64_tr_b16 v[196:197], v8 offset:18432
    v_mfma_f32_16x16x32_bf16 v[68:71], v[200:203], v[156:159], v[68:71]
    ds_read_b64_tr_b16 v[198:199], v8 offset:19200
    v_mfma_f32_16x16x32_bf16 v[80:83], v[200:203], v[160:163], v[80:83]
    v_mfma_f32_16x16x32_bf16 v[92:95], v[200:203], v[164:167], v[92:95]
    v_mfma_f32_16x16x32_bf16 v[104:107], v[200:203], v[168:171], v[104:107]
    v_mfma_f32_16x16x32_bf16 v[116:119], v[200:203], v[172:175], v[116:119]
    v_mfma_f32_16x16x32_bf16 v[128:131], v[200:203], v[176:179], v[128:131]
    ds_read_b64_tr_b16 v[200:201], v6 offset:24576
    s_waitcnt lgkmcnt(3)
    v_mfma_f32_16x16x32_bf16 v[72:75], v[204:207], v[156:159], v[72:75]
    ds_read_b64_tr_b16 v[202:203], v6 offset:25344
    v_mfma_f32_16x16x32_bf16 v[84:87], v[204:207], v[160:163], v[84:87]
    s_add_u32 s26, s26, 30720
    v_mfma_f32_16x16x32_bf16 v[96:99], v[204:207], v[164:167], v[96:99]
    s_cmp_eq_u32 s26, 92160
    v_mfma_f32_16x16x32_bf16 v[108:111], v[204:207], v[168:171], v[108:111]
    s_cselect_b32 s33, 4294875136, 0
    v_mfma_f32_16x16x32_bf16 v[120:123], v[204:207], v[172:175], v[120:123]
    s_cselect_b32 s26, 0, s26
    v_mfma_f32_16x16x32_bf16 v[132:135], v[204:207], v[176:179], v[132:135]
    ds_read_b64_tr_b16 v[204:205], v7 offset:24576
    v_mfma_f32_16x16x32_bf16 v[64:67], v[208:211], v[160:163], v[64:67]
    ds_read_b64_tr_b16 v[206:207], v7 offset:25344
    v_mfma_f32_16x16x32_bf16 v[76:79], v[208:211], v[164:167], v[76:79]
    s_add_u32 s33, s33, 30720
    v_mfma_f32_16x16x32_bf16 v[88:91], v[208:211], v[168:171], v[88:91]
    ds_read_b128 v[156:159], v2 offset:2560
    v_mfma_f32_16x16x32_bf16 v[100:103], v[208:211], v[172:175], v[100:103]
    v_mfma_f32_16x16x32_bf16 v[112:115], v[208:211], v[176:179], v[112:115]
    v_mfma_f32_16x16x32_bf16 v[124:127], v[208:211], v[180:183], v[124:127]
    v_mfma_f32_16x16x32_bf16 v[136:139], v[208:211], v[184:187], v[136:139]
    ds_read_b64_tr_b16 v[208:209], v8 offset:24576
    v_mfma_f32_16x16x32_bf16 v[68:71], v[192:195], v[160:163], v[68:71]
    ds_read_b64_tr_b16 v[210:211], v8 offset:25344
    v_mfma_f32_16x16x32_bf16 v[80:83], v[192:195], v[164:167], v[80:83]
    v_add_u32 v6, s33, v6
    v_mfma_f32_16x16x32_bf16 v[92:95], v[192:195], v[168:171], v[92:95]
    v_add_u32 v7, s33, v7
    v_mfma_f32_16x16x32_bf16 v[104:107], v[192:195], v[172:175], v[104:107]
    v_add_u32 v8, s33, v8
    v_mfma_f32_16x16x32_bf16 v[116:119], v[192:195], v[176:179], v[116:119]
    v_mfma_f32_16x16x32_bf16 v[128:131], v[192:195], v[180:183], v[128:131]
    s_waitcnt lgkmcnt(2)
    v_mfma_f32_16x16x32_bf16 v[72:75], v[196:199], v[160:163], v[72:75]
    s_waitcnt lgkmcnt(0)
    s_barrier
    v_mfma_f32_16x16x32_bf16 v[84:87], v[196:199], v[164:167], v[84:87]
    ds_read_b64_tr_b16 v[192:193], v6 offset:0
    v_mfma_f32_16x16x32_bf16 v[96:99], v[196:199], v[168:171], v[96:99]
    ds_read_b64_tr_b16 v[194:195], v6 offset:768
    v_mfma_f32_16x16x32_bf16 v[108:111], v[196:199], v[172:175], v[108:111]
    ds_read_b128 v[160:163], v3 offset:3840
    v_mfma_f32_16x16x32_bf16 v[120:123], v[196:199], v[176:179], v[120:123]
    v_mfma_f32_16x16x32_bf16 v[132:135], v[196:199], v[180:183], v[132:135]
    ds_read_b64_tr_b16 v[196:197], v7 offset:0
    v_mfma_f32_16x16x32_bf16 v[64:67], v[200:203], v[164:167], v[64:67]
    ds_read_b64_tr_b16 v[198:199], v7 offset:768
    v_mfma_f32_16x16x32_bf16 v[76:79], v[200:203], v[168:171], v[76:79]
    v_mfma_f32_16x16x32_bf16 v[88:91], v[200:203], v[172:175], v[88:91]
    v_mfma_f32_16x16x32_bf16 v[68:71], v[204:207], v[164:167], v[68:71]
    v_mfma_f32_16x16x32_bf16 v[80:83], v[204:207], v[168:171], v[80:83]
    v_mfma_f32_16x16x32_bf16 v[92:95], v[204:207], v[172:175], v[92:95]
    v_mfma_f32_16x16x32_bf16 v[72:75], v[208:211], v[164:167], v[72:75]
    ds_read_b128 v[164:167], v2 offset:5120
    v_mfma_f32_16x16x32_bf16 v[84:87], v[208:211], v[168:171], v[84:87]
    ds_read_b128 v[168:171], v3 offset:6400
    v_mfma_f32_16x16x32_bf16 v[96:99], v[208:211], v[172:175], v[96:99]
    ds_read_b128 v[172:175], v2 offset:7680
    v_mfma_f32_16x16x32_bf16 v[100:103], v[200:203], v[176:179], v[100:103]
    v_mfma_f32_16x16x32_bf16 v[112:115], v[200:203], v[180:183], v[112:115]
    v_mfma_f32_16x16x32_bf16 v[124:127], v[200:203], v[184:187], v[124:127]
    v_mfma_f32_16x16x32_bf16 v[136:139], v[200:203], v[188:191], v[136:139]
    ds_read_b64_tr_b16 v[200:201], v8 offset:0
    v_mfma_f32_16x16x32_bf16 v[104:107], v[204:207], v[176:179], v[104:107]
    ds_read_b64_tr_b16 v[202:203], v8 offset:768
    v_mfma_f32_16x16x32_bf16 v[116:119], v[204:207], v[180:183], v[116:119]
    v_mfma_f32_16x16x32_bf16 v[128:131], v[204:207], v[184:187], v[128:131]
    v_mfma_f32_16x16x32_bf16 v[108:111], v[208:211], v[176:179], v[108:111]
    v_mfma_f32_16x16x32_bf16 v[120:123], v[208:211], v[180:183], v[120:123]
    s_add_u32 s27, s27, 2
    v_mfma_f32_16x16x32_bf16 v[132:135], v[208:211], v[184:187], v[132:135]
    s_cmp_lt_u32 s27, 13
    s_cbranch_scc1 L_loop0
    ds_read_b64_tr_b16 v[172:173], v6 offset:6144
    ds_read_b64_tr_b16 v[174:175], v6 offset:6912
    ds_read_b64_tr_b16 v[176:177], v7 offset:6144
    s_waitcnt lgkmcnt(11)
    v_mfma_f32_16x16x32_bf16 v[64:67], v[192:195], v[148:151], v[64:67]
    ds_read_b64_tr_b16 v[178:179], v7 offset:6912
    ds_read_b64_tr_b16 v[180:181], v8 offset:6144
    ds_read_b64_tr_b16 v[182:183], v8 offset:6912
    v_mfma_f32_16x16x32_bf16 v[76:79], v[192:195], v[152:155], v[76:79]
    ds_read_b64_tr_b16 v[184:185], v6 offset:12288
    ds_read_b64_tr_b16 v[186:187], v6 offset:13056
    s_waitcnt lgkmcnt(13)
    v_mfma_f32_16x16x32_bf16 v[68:71], v[196:199], v[148:151], v[68:71]
    ds_read_b64_tr_b16 v[188:189], v7 offset:12288
    ds_read_b64_tr_b16 v[190:191], v7 offset:13056
    v_mfma_f32_16x16x32_bf16 v[80:83], v[196:199], v[152:155], v[80:83]
    ds_read_b64_tr_b16 v[204:205], v8 offset:12288
    ds_read_b64_tr_b16 v[206:207], v8 offset:13056
    s_waitcnt lgkmcnt(12)
    v_mfma_f32_16x16x32_bf16 v[72:75], v[200:203], v[148:151], v[72:75]
    ds_read_b64_tr_b16 v[208:209], v6 offset:18432
    ds_read_b64_tr_b16 v[210:211], v6 offset:19200
    v_mfma_f32_16x16x32_bf16 v[84:87], v[200:203], v[152:155], v[84:87]
    ds_read_b64_tr_b16 v[212:213], v7 offset:18432
    s_waitcnt lgkmcnt(13)
    v_mfma_f32_16x16x32_bf16 v[64:67], v[172:175], v[152:155], v[64:67]
    ds_read_b64_tr_b16 v[214:215], v7 offset:19200
    v_mfma_f32_16x16x32_bf16 v[76:79], v[172:175], v[156:159], v[76:79]
    ds_read_b64_tr_b16 v[216:217], v8 offset:18432
    s_waitcnt lgkmcnt(13)
    v_mfma_f32_16x16x32_bf16 v[68:71], v[176:179], v[152:155], v[68:71]
    ds_read_b64_tr_b16 v[218:219], v8 offset:19200
    v_mfma_f32_16x16x32_bf16 v[80:83], v[176:179], v[156:159], v[80:83]
    ds_read_b64_tr_b16 v[220:221], v6 offset:24576
    s_waitcnt lgkmcnt(11)
    v_mfma_f32_16x16x32_bf16 v[72:75], v[180:183], v[152:155], v[72:75]
    ds_read_b64_tr_b16 v[222:223], v6 offset:25344
    v_mfma_f32_16x16x32_bf16 v[84:87], v[180:183], v[156:159], v[84:87]
    ds_read_b64_tr_b16 v[224:225], v7 offset:24576
    v_mfma_f32_16x16x32_bf16 v[64:67], v[184:187], v[156:159], v[64:67]
    ds_read_b64_tr_b16 v[226:227], v7 offset:25344
    v_mfma_f32_16x16x32_bf16 v[76:79], v[184:187], v[160:163], v[76:79]
    ds_read_b64_tr_b16 v[228:229], v8 offset:24576
    s_waitcnt lgkmcnt(8)
    v_mfma_f32_16x16x32_bf16 v[68:71], v[188:191], v[156:159], v[68:71]
    ds_read_b64_tr_b16 v[230:231], v8 offset:25344
    v_mfma_f32_16x16x32_bf16 v[80:83], v[188:191], v[160:163], v[80:83]
    ds_read_b64_tr_b16 v[232:233], v6 offset:30720
    v_mfma_f32_16x16x32_bf16 v[72:75], v[204:207], v[156:159], v[72:75]
    ds_read_b64_tr_b16 v[234:235], v6 offset:31488
    ds_read_b128 v[236:239], v26 offset:0
    v_mfma_f32_16x16x32_bf16 v[84:87], v[204:207], v[160:163], v[84:87]
    ds_read_b128 v[240:243], v27 offset:1280
    v_mfma_f32_16x16x32_bf16 v[64:67], v[208:211], v[160:163], v[64:67]
    ds_read_b64_tr_b16 v[244:245], v7 offset:30720
    ds_read_b64_tr_b16 v[246:247], v7 offset:31488
    v_mfma_f32_16x16x32_bf16 v[76:79], v[208:211], v[164:167], v[76:79]
    ds_read_b64_tr_b16 v[248:249], v8 offset:30720
    s_waitcnt lgkmcnt(10)
    v_mfma_f32_16x16x32_bf16 v[68:71], v[212:215], v[160:163], v[68:71]
    ds_read_b64_tr_b16 v[250:251], v8 offset:31488
    v_mfma_f32_16x16x32_bf16 v[80:83], v[212:215], v[164:167], v[80:83]
    ds_read_b64_tr_b16 v[252:253], v6 offset:36864
    v_mfma_f32_16x16x32_bf16 v[72:75], v[216:219], v[160:163], v[72:75]
    ds_read_b64_tr_b16 v[254:255], v6 offset:37632
    v_mfma_f32_16x16x32_bf16 v[84:87], v[216:219], v[164:167], v[84:87]
    ds_read_b128 v[192:195], v26 offset:2560
    v_mfma_f32_16x16x32_bf16 v[64:67], v[220:223], v[164:167], v[64:67]
    ds_read_b64_tr_b16 v[196:197], v7 offset:36864
    ds_read_b64_tr_b16 v[198:199], v7 offset:37632
    v_mfma_f32_16x16x32_bf16 v[76:79], v[220:223], v[168:171], v[76:79]
    ds_read_b64_tr_b16 v[148:149], v8 offset:36864
    s_waitcnt lgkmcnt(10)
    v_mfma_f32_16x16x32_bf16 v[68:71], v[224:227], v[164:167], v[68:71]
    ds_read_b64_tr_b16 v[150:151], v8 offset:37632
    v_mfma_f32_16x16x32_bf16 v[80:83], v[224:227], v[168:171], v[80:83]
    ds_read_b64_tr_b16 v[200:201], v6 offset:43008
    v_mfma_f32_16x16x32_bf16 v[72:75], v[228:231], v[164:167], v[72:75]
    ds_read_b64_tr_b16 v[202:203], v6 offset:43776
    v_mfma_f32_16x16x32_bf16 v[84:87], v[228:231], v[168:171], v[84:87]
    ds_read_b128 v[172:175], v27 offset:3840
    v_mfma_f32_16x16x32_bf16 v[64:67], v[232:235], v[236:239], v[64:67]
    ds_read_b64_tr_b16 v[176:177], v7 offset:43008
    ds_read_b64_tr_b16 v[178:179], v7 offset:43776
    v_mfma_f32_16x16x32_bf16 v[76:79], v[232:235], v[240:243], v[76:79]
    ds_read_b64_tr_b16 v[152:153], v8 offset:43008
    s_waitcnt lgkmcnt(10)
    v_mfma_f32_16x16x32_bf16 v[68:71], v[244:247], v[236:239], v[68:71]
    ds_read_b64_tr_b16 v[154:155], v8 offset:43776
    v_mfma_f32_16x16x32_bf16 v[80:83], v[244:247], v[240:243], v[80:83]
    ds_read_b64_tr_b16 v[180:181], v6 offset:49152
    v_mfma_f32_16x16x32_bf16 v[72:75], v[248:251], v[236:239], v[72:75]
    ds_read_b64_tr_b16 v[182:183], v6 offset:49920
    v_mfma_f32_16x16x32_bf16 v[84:87], v[248:251], v[240:243], v[84:87]
    ds_read_b128 v[184:187], v26 offset:5120
    v_mfma_f32_16x16x32_bf16 v[64:67], v[252:255], v[240:243], v[64:67]
    ds_read_b64_tr_b16 v[188:189], v7 offset:49152
    ds_read_b64_tr_b16 v[190:191], v7 offset:49920
    v_mfma_f32_16x16x32_bf16 v[76:79], v[252:255], v[192:195], v[76:79]
    ds_read_b64_tr_b16 v[156:157], v8 offset:49152
    s_waitcnt lgkmcnt(10)
    v_mfma_f32_16x16x32_bf16 v[68:71], v[196:199], v[240:243], v[68:71]
    ds_read_b64_tr_b16 v[158:159], v8 offset:49920
    v_mfma_f32_16x16x32_bf16 v[80:83], v[196:199], v[192:195], v[80:83]
    ds_read_b64_tr_b16 v[204:205], v6 offset:55296
    v_mfma_f32_16x16x32_bf16 v[72:75], v[148:151], v[240:243], v[72:75]
    ds_read_b64_tr_b16 v[206:207], v6 offset:56064
    v_mfma_f32_16x16x32_bf16 v[84:87], v[148:151], v[192:195], v[84:87]
    ds_read_b128 v[208:211], v27 offset:6400
    v_mfma_f32_16x16x32_bf16 v[64:67], v[200:203], v[192:195], v[64:67]
    ds_read_b64_tr_b16 v[212:213], v7 offset:55296
    ds_read_b64_tr_b16 v[214:215], v7 offset:56064
    v_mfma_f32_16x16x32_bf16 v[76:79], v[200:203], v[172:175], v[76:79]
    ds_read_b64_tr_b16 v[160:161], v8 offset:55296
    s_waitcnt lgkmcnt(10)
    v_mfma_f32_16x16x32_bf16 v[68:71], v[176:179], v[192:195], v[68:71]
    ds_read_b64_tr_b16 v[162:163], v8 offset:56064
    v_mfma_f32_16x16x32_bf16 v[80:83], v[176:179], v[172:175], v[80:83]
    ds_read_b128 v[216:219], v26 offset:7680
    v_mfma_f32_16x16x32_bf16 v[72:75], v[152:155], v[192:195], v[72:75]
    ds_read_b128 v[220:223], v27 offset:8960
    v_mfma_f32_16x16x32_bf16 v[84:87], v[152:155], v[172:175], v[84:87]
    v_mfma_f32_16x16x32_bf16 v[64:67], v[180:183], v[172:175], v[64:67]
    v_mfma_f32_16x16x32_bf16 v[76:79], v[180:183], v[184:187], v[76:79]
    ds_read_b64_tr_b16 v[224:225], v6 offset:0
    s_waitcnt lgkmcnt(7)
    v_mfma_f32_16x16x32_bf16 v[68:71], v[188:191], v[172:175], v[68:71]
    ds_read_b64_tr_b16 v[226:227], v6 offset:768
    v_mfma_f32_16x16x32_bf16 v[80:83], v[188:191], v[184:187], v[80:83]
    ds_read_b128 v[164:167], v2 offset:2560
    v_mfma_f32_16x16x32_bf16 v[72:75], v[156:159], v[172:175], v[72:75]
    ds_read_b128 v[168:171], v3 offset:3840
    v_mfma_f32_16x16x32_bf16 v[84:87], v[156:159], v[184:187], v[84:87]
    ds_read_b64_tr_b16 v[228:229], v7 offset:0
    v_mfma_f32_16x16x32_bf16 v[64:67], v[204:207], v[184:187], v[64:67]
    ds_read_b64_tr_b16 v[230:231], v7 offset:768
    v_mfma_f32_16x16x32_bf16 v[76:79], v[204:207], v[208:211], v[76:79]
    ds_read_b64_tr_b16 v[236:237], v8 offset:0
    s_waitcnt lgkmcnt(7)
    v_mfma_f32_16x16x32_bf16 v[68:71], v[212:215], v[184:187], v[68:71]
    ds_read_b64_tr_b16 v[238:239], v8 offset:768
    v_mfma_f32_16x16x32_bf16 v[80:83], v[212:215], v[208:211], v[80:83]
    ds_read_b64_tr_b16 v[240:241], v6 offset:6144
    v_mfma_f32_16x16x32_bf16 v[72:75], v[160:163], v[184:187], v[72:75]
    ds_read_b64_tr_b16 v[242:243], v6 offset:6912
    v_mfma_f32_16x16x32_bf16 v[84:87], v[160:163], v[208:211], v[84:87]
    v_mfma_f32_16x16x32_bf16 v[88:91], v[232:235], v[192:195], v[88:91]
    v_mfma_f32_16x16x32_bf16 v[100:103], v[232:235], v[172:175], v[100:103]
    ds_read_b128 v[232:235], v2 offset:5120
    v_mfma_f32_16x16x32_bf16 v[92:95], v[244:247], v[192:195], v[92:95]
    v_cvt_pk_bf16_f32 v64, v64, v65
    v_mfma_f32_16x16x32_bf16 v[104:107], v[244:247], v[172:175], v[104:107]
    ds_read_b64_tr_b16 v[244:245], v7 offset:6144
    v_mfma_f32_16x16x32_bf16 v[96:99], v[248:251], v[192:195], v[96:99]
    ds_read_b64_tr_b16 v[246:247], v7 offset:6912
    v_mfma_f32_16x16x32_bf16 v[108:111], v[248:251], v[172:175], v[108:111]
    ds_read_b64_tr_b16 v[192:193], v8 offset:6144
    v_mfma_f32_16x16x32_bf16 v[88:91], v[252:255], v[172:175], v[88:91]
    ds_read_b64_tr_b16 v[194:195], v8 offset:6912
    v_mfma_f32_16x16x32_bf16 v[100:103], v[252:255], v[184:187], v[100:103]
    ds_read_b64_tr_b16 v[248:249], v6 offset:12288
    v_mfma_f32_16x16x32_bf16 v[92:95], v[196:199], v[172:175], v[92:95]
    ds_read_b64_tr_b16 v[250:251], v6 offset:13056
    v_mfma_f32_16x16x32_bf16 v[104:107], v[196:199], v[184:187], v[104:107]
    ds_read_b128 v[252:255], v3 offset:6400
    v_mfma_f32_16x16x32_bf16 v[96:99], v[148:151], v[172:175], v[96:99]
    ds_read_b64_tr_b16 v[196:197], v7 offset:12288
    v_mfma_f32_16x16x32_bf16 v[108:111], v[148:151], v[184:187], v[108:111]
    ds_read_b64_tr_b16 v[198:199], v7 offset:13056
    v_mfma_f32_16x16x32_bf16 v[88:91], v[200:203], v[184:187], v[88:91]
    v_cvt_pk_bf16_f32 v65, v66, v67
    v_mfma_f32_16x16x32_bf16 v[100:103], v[200:203], v[208:211], v[100:103]
    ds_write_b64 v20, v[64:65] offset:0
    v_mfma_f32_16x16x32_bf16 v[92:95], v[176:179], v[184:187], v[92:95]
    ds_read_b64_tr_b16 v[172:173], v8 offset:12288
    v_mfma_f32_16x16x32_bf16 v[104:107], v[176:179], v[208:211], v[104:107]
    ds_read_b64_tr_b16 v[174:175], v8 offset:13056
    v_mfma_f32_16x16x32_bf16 v[96:99], v[152:155], v[184:187], v[96:99]
    v_cvt_pk_bf16_f32 v76, v76, v77
    v_mfma_f32_16x16x32_bf16 v[108:111], v[152:155], v[208:211], v[108:111]
    v_cvt_pk_bf16_f32 v77, v78, v79
    v_mfma_f32_16x16x32_bf16 v[88:91], v[180:183], v[208:211], v[88:91]
    ds_read_b64_tr_b16 v[148:149], v6 offset:18432
    v_mfma_f32_16x16x32_bf16 v[100:103], v[180:183], v[216:219], v[100:103]
    ds_read_b64_tr_b16 v[150:151], v6 offset:19200
    v_mfma_f32_16x16x32_bf16 v[92:95], v[188:191], v[208:211], v[92:95]
    ds_write_b64 v20, v[76:77] offset:3072
    v_mfma_f32_16x16x32_bf16 v[104:107], v[188:191], v[216:219], v[104:107]
    ds_read_b128 v[200:203], v2 offset:7680
    v_mfma_f32_16x16x32_bf16 v[96:99], v[156:159], v[208:211], v[96:99]
    v_cvt_pk_bf16_f32 v68, v68, v69
    v_mfma_f32_16x16x32_bf16 v[108:111], v[156:159], v[216:219], v[108:111]
    ds_read_b64_tr_b16 v[176:177], v7 offset:18432
    v_mfma_f32_16x16x32_bf16 v[88:91], v[204:207], v[216:219], v[88:91]
    ds_read_b64_tr_b16 v[178:179], v7 offset:19200
    v_mfma_f32_16x16x32_bf16 v[100:103], v[204:207], v[220:223], v[100:103]
    v_cvt_pk_bf16_f32 v69, v70, v71
    v_mfma_f32_16x16x32_bf16 v[92:95], v[212:215], v[216:219], v[92:95]
    ds_write_b64 v20, v[68:69] offset:64
    v_mfma_f32_16x16x32_bf16 v[104:107], v[212:215], v[220:223], v[104:107]
    ds_read_b64_tr_b16 v[184:185], v8 offset:18432
    v_mfma_f32_16x16x32_bf16 v[96:99], v[160:163], v[216:219], v[96:99]
    ds_read_b64_tr_b16 v[186:187], v8 offset:19200
    v_mfma_f32_16x16x32_bf16 v[108:111], v[160:163], v[220:223], v[108:111]
    v_cvt_pk_bf16_f32 v80, v80, v81
    s_waitcnt lgkmcnt(5)
    v_mfma_f32_16x16x32_bf16 v[88:91], v[224:227], v[164:167], v[88:91]
    v_cvt_pk_bf16_f32 v81, v82, v83
    v_mfma_f32_16x16x32_bf16 v[100:103], v[224:227], v[168:171], v[100:103]
    ds_read_b64_tr_b16 v[152:153], v6 offset:24576
    v_mfma_f32_16x16x32_bf16 v[92:95], v[228:231], v[164:167], v[92:95]
    ds_read_b64_tr_b16 v[154:155], v6 offset:25344
    v_mfma_f32_16x16x32_bf16 v[104:107], v[228:231], v[168:171], v[104:107]
    ds_write_b64 v20, v[80:81] offset:3136
    v_mfma_f32_16x16x32_bf16 v[96:99], v[236:239], v[164:167], v[96:99]
    ds_read_b128 v[180:183], v3 offset:8960
    v_mfma_f32_16x16x32_bf16 v[108:111], v[236:239], v[168:171], v[108:111]
    v_cvt_pk_bf16_f32 v72, v72, v73
    v_mfma_f32_16x16x32_bf16 v[88:91], v[240:243], v[168:171], v[88:91]
    ds_read_b64_tr_b16 v[188:189], v7 offset:24576
    v_mfma_f32_16x16x32_bf16 v[100:103], v[240:243], v[232:235], v[100:103]
    ds_read_b64_tr_b16 v[190:191], v7 offset:25344
    v_mfma_f32_16x16x32_bf16 v[92:95], v[244:247], v[168:171], v[92:95]
    v_cvt_pk_bf16_f32 v73, v74, v75
    v_mfma_f32_16x16x32_bf16 v[104:107], v[244:247], v[232:235], v[104:107]
    ds_write_b64 v20, v[72:73] offset:128
    v_mfma_f32_16x16x32_bf16 v[96:99], v[192:195], v[168:171], v[96:99]
    ds_read_b64_tr_b16 v[208:209], v8 offset:24576
    v_mfma_f32_16x16x32_bf16 v[108:111], v[192:195], v[232:235], v[108:111]
    ds_read_b64_tr_b16 v[210:211], v8 offset:25344
    v_mfma_f32_16x16x32_bf16 v[88:91], v[248:251], v[232:235], v[88:91]
    v_cvt_pk_bf16_f32 v84, v84, v85
    v_mfma_f32_16x16x32_bf16 v[100:103], v[248:251], v[252:255], v[100:103]
    v_cvt_pk_bf16_f32 v85, v86, v87
    v_mfma_f32_16x16x32_bf16 v[92:95], v[196:199], v[232:235], v[92:95]
    ds_write_b64 v20, v[84:85] offset:3200
    v_mfma_f32_16x16x32_bf16 v[104:107], v[196:199], v[252:255], v[104:107]
    ds_read_b128 v[156:159], v2 offset:10240
    v_mfma_f32_16x16x32_bf16 v[96:99], v[172:175], v[232:235], v[96:99]
    ds_read_b128 v[204:207], v3 offset:11520
    v_mfma_f32_16x16x32_bf16 v[108:111], v[172:175], v[252:255], v[108:111]
    v_mfma_f32_16x16x32_bf16 v[88:91], v[148:151], v[252:255], v[88:91]
    v_mfma_f32_16x16x32_bf16 v[100:103], v[148:151], v[200:203], v[100:103]
    ds_read_b128 v[212:215], v2 offset:12800
    s_waitcnt lgkmcnt(4)
    v_mfma_f32_16x16x32_bf16 v[92:95], v[176:179], v[252:255], v[92:95]
    v_mfma_f32_16x16x32_bf16 v[104:107], v[176:179], v[200:203], v[104:107]
    v_mfma_f32_16x16x32_bf16 v[96:99], v[184:187], v[252:255], v[96:99]
    v_mfma_f32_16x16x32_bf16 v[108:111], v[184:187], v[200:203], v[108:111]
    v_mfma_f32_16x16x32_bf16 v[88:91], v[152:155], v[200:203], v[88:91]
    s_waitcnt lgkmcnt(3)
    s_barrier
    v_mfma_f32_16x16x32_bf16 v[100:103], v[152:155], v[180:183], v[100:103]
    ds_read_b64_tr_b16 v[216:217], v6 offset:30720
    v_mfma_f32_16x16x32_bf16 v[92:95], v[188:191], v[200:203], v[92:95]
    ds_read_b64_tr_b16 v[218:219], v6 offset:31488
    v_mfma_f32_16x16x32_bf16 v[104:107], v[188:191], v[180:183], v[104:107]
    ds_read_b128 v[160:163], v26 offset:5120
    v_mfma_f32_16x16x32_bf16 v[96:99], v[208:211], v[200:203], v[96:99]
    ds_read_b128 v[220:223], v27 offset:6400
    v_mfma_f32_16x16x32_bf16 v[108:111], v[208:211], v[180:183], v[108:111]
    ds_read_b128 v[164:167], v26 offset:7680
    v_mfma_f32_16x16x32_bf16 v[112:115], v[224:227], v[232:235], v[112:115]
    ds_read_b64_tr_b16 v[168:169], v7 offset:30720
    v_mfma_f32_16x16x32_bf16 v[124:127], v[224:227], v[252:255], v[124:127]
    ds_read_b64_tr_b16 v[170:171], v7 offset:31488
    v_mfma_f32_16x16x32_bf16 v[136:139], v[224:227], v[200:203], v[136:139]
    v_cvt_pk_bf16_f32 v88, v88, v89
    v_mfma_f32_16x16x32_bf16 v[116:119], v[228:231], v[232:235], v[116:119]
    v_cvt_pk_bf16_f32 v89, v90, v91
    v_mfma_f32_16x16x32_bf16 v[128:131], v[228:231], v[252:255], v[128:131]
    ds_write_b64 v20, v[88:89] offset:6144
    v_mfma_f32_16x16x32_bf16 v[120:123], v[236:239], v[232:235], v[120:123]
    ds_read_b64_tr_b16 v[224:225], v8 offset:30720
    v_mfma_f32_16x16x32_bf16 v[132:135], v[236:239], v[252:255], v[132:135]
    ds_read_b64_tr_b16 v[226:227], v8 offset:31488
    v_mfma_f32_16x16x32_bf16 v[112:115], v[240:243], v[252:255], v[112:115]
    v_cvt_pk_bf16_f32 v100, v100, v101
    v_mfma_f32_16x16x32_bf16 v[124:127], v[240:243], v[200:203], v[124:127]
    v_cvt_pk_bf16_f32 v101, v102, v103
    v_mfma_f32_16x16x32_bf16 v[136:139], v[240:243], v[180:183], v[136:139]
    ds_read_b64_tr_b16 v[228:229], v6 offset:36864
    v_mfma_f32_16x16x32_bf16 v[116:119], v[244:247], v[252:255], v[116:119]
    ds_read_b64_tr_b16 v[230:231], v6 offset:37632
    v_mfma_f32_16x16x32_bf16 v[128:131], v[244:247], v[200:203], v[128:131]
    ds_write_b64 v20, v[100:101] offset:9216
    v_mfma_f32_16x16x32_bf16 v[120:123], v[192:195], v[252:255], v[120:123]
    v_cvt_pk_bf16_f32 v92, v92, v93
    v_mfma_f32_16x16x32_bf16 v[132:135], v[192:195], v[200:203], v[132:135]
    ds_read_b128 v[232:235], v27 offset:8960
    v_mfma_f32_16x16x32_bf16 v[112:115], v[248:251], v[200:203], v[112:115]
    v_cvt_pk_bf16_f32 v93, v94, v95
    v_mfma_f32_16x16x32_bf16 v[124:127], v[248:251], v[180:183], v[124:127]
    ds_read_b64_tr_b16 v[236:237], v7 offset:36864
    s_waitcnt lgkmcnt(5)
    v_mfma_f32_16x16x32_bf16 v[136:139], v[248:251], v[156:159], v[136:139]
    ds_read_b64_tr_b16 v[238:239], v7 offset:37632
    v_mfma_f32_16x16x32_bf16 v[116:119], v[196:199], v[200:203], v[116:119]
    ds_write_b64 v20, v[92:93] offset:6208
    v_mfma_f32_16x16x32_bf16 v[128:131], v[196:199], v[180:183], v[128:131]
    v_cvt_pk_bf16_f32 v104, v104, v105
    v_mfma_f32_16x16x32_bf16 v[120:123], v[172:175], v[200:203], v[120:123]
    ds_read_b64_tr_b16 v[240:241], v8 offset:36864
    v_mfma_f32_16x16x32_bf16 v[132:135], v[172:175], v[180:183], v[132:135]
    ds_read_b64_tr_b16 v[242:243], v8 offset:37632
    v_mfma_f32_16x16x32_bf16 v[112:115], v[148:151], v[180:183], v[112:115]
    v_cvt_pk_bf16_f32 v105, v106, v107
    v_mfma_f32_16x16x32_bf16 v[124:127], v[148:151], v[156:159], v[124:127]
    ds_write_b64 v20, v[104:105] offset:9280
    v_mfma_f32_16x16x32_bf16 v[136:139], v[148:151], v[204:207], v[136:139]
    ds_read_b64_tr_b16 v[244:245], v6 offset:43008
    v_mfma_f32_16x16x32_bf16 v[116:119], v[176:179], v[180:183], v[116:119]
    ds_read_b64_tr_b16 v[246:247], v6 offset:43776
    v_mfma_f32_16x16x32_bf16 v[128:131], v[176:179], v[156:159], v[128:131]
    v_cvt_pk_bf16_f32 v96, v96, v97
    v_mfma_f32_16x16x32_bf16 v[120:123], v[184:187], v[180:183], v[120:123]
    v_cvt_pk_bf16_f32 v97, v98, v99
    v_mfma_f32_16x16x32_bf16 v[132:135], v[184:187], v[156:159], v[132:135]
    ds_read_b128 v[252:255], v26 offset:10240
    v_mfma_f32_16x16x32_bf16 v[112:115], v[152:155], v[156:159], v[112:115]
    ds_write_b64 v20, v[96:97] offset:6272
    v_mfma_f32_16x16x32_bf16 v[124:127], v[152:155], v[204:207], v[124:127]
    ds_read_b64_tr_b16 v[192:193], v7 offset:43008
    v_mfma_f32_16x16x32_bf16 v[136:139], v[152:155], v[212:215], v[136:139]
    ds_read_b64_tr_b16 v[194:195], v7 offset:43776
    v_mfma_f32_16x16x32_bf16 v[116:119], v[188:191], v[156:159], v[116:119]
    v_cvt_pk_bf16_f32 v108, v108, v109
    v_mfma_f32_16x16x32_bf16 v[128:131], v[188:191], v[204:207], v[128:131]
    v_cvt_pk_bf16_f32 v109, v110, v111
    v_mfma_f32_16x16x32_bf16 v[120:123], v[208:211], v[156:159], v[120:123]
    ds_read_b64_tr_b16 v[248:249], v8 offset:43008
    v_mfma_f32_16x16x32_bf16 v[132:135], v[208:211], v[204:207], v[132:135]
    ds_read_b64_tr_b16 v[250:251], v8 offset:43776
    v_mfma_f32_16x16x32_bf16 v[112:115], v[216:219], v[160:163], v[112:115]
    ds_write_b64 v20, v[108:109] offset:9344
    v_mfma_f32_16x16x32_bf16 v[124:127], v[216:219], v[220:223], v[124:127]
    ds_read_b64_tr_b16 v[196:197], v6 offset:49152
    v_mfma_f32_16x16x32_bf16 v[136:139], v[216:219], v[164:167], v[136:139]
    ds_read_b64_tr_b16 v[198:199], v6 offset:49920
    v_mfma_f32_16x16x32_bf16 v[116:119], v[168:171], v[160:163], v[116:119]
    ds_read_b128 v[200:203], v27 offset:11520
    v_mfma_f32_16x16x32_bf16 v[128:131], v[168:171], v[220:223], v[128:131]
    ds_read_b64_tr_b16 v[172:173], v7 offset:49152
    v_mfma_f32_16x16x32_bf16 v[120:123], v[224:227], v[160:163], v[120:123]
    ds_read_b64_tr_b16 v[174:175], v7 offset:49920
    v_mfma_f32_16x16x32_bf16 v[132:135], v[224:227], v[220:223], v[132:135]
    ds_read_b64_tr_b16 v[148:149], v8 offset:49152
    s_waitcnt lgkmcnt(8)
    v_mfma_f32_16x16x32_bf16 v[112:115], v[228:231], v[220:223], v[112:115]
    ds_read_b64_tr_b16 v[150:151], v8 offset:49920
    v_mfma_f32_16x16x32_bf16 v[124:127], v[228:231], v[164:167], v[124:127]
    ds_read_b64_tr_b16 v[176:177], v6 offset:55296
    v_mfma_f32_16x16x32_bf16 v[136:139], v[228:231], v[232:235], v[136:139]
    ds_read_b64_tr_b16 v[178:179], v6 offset:56064
    v_mfma_f32_16x16x32_bf16 v[116:119], v[236:239], v[220:223], v[116:119]
    ds_read_b128 v[180:183], v26 offset:12800
    v_mfma_f32_16x16x32_bf16 v[128:131], v[236:239], v[164:167], v[128:131]
    ds_read_b64_tr_b16 v[184:185], v7 offset:55296
    v_mfma_f32_16x16x32_bf16 v[120:123], v[240:243], v[220:223], v[120:123]
    ds_read_b64_tr_b16 v[186:187], v7 offset:56064
    v_mfma_f32_16x16x32_bf16 v[132:135], v[240:243], v[164:167], v[132:135]
    s_waitcnt lgkmcnt(12)
    s_barrier
    v_mfma_f32_16x16x32_bf16 v[112:115], v[244:247], v[164:167], v[112:115]
    ds_read_b64_tr_b16 v[152:153], v8 offset:55296
    v_mfma_f32_16x16x32_bf16 v[124:127], v[244:247], v[232:235], v[124:127]
    ds_read_b64_tr_b16 v[154:155], v8 offset:56064
    v_mfma_f32_16x16x32_bf16 v[136:139], v[244:247], v[252:255], v[136:139]
    v_mfma_f32_16x16x32_bf16 v[116:119], v[192:195], v[164:167], v[116:119]
    v_mfma_f32_16x16x32_bf16 v[128:131], v[192:195], v[232:235], v[128:131]
    v_mfma_f32_16x16x32_bf16 v[120:123], v[248:251], v[164:167], v[120:123]
    v_mfma_f32_16x16x32_bf16 v[132:135], v[248:251], v[232:235], v[132:135]
    s_waitcnt lgkmcnt(2)
    v_mfma_f32_16x16x32_bf16 v[112:115], v[196:199], v[232:235], v[112:115]
    v_mfma_f32_16x16x32_bf16 v[124:127], v[196:199], v[252:255], v[124:127]
    v_mfma_f32_16x16x32_bf16 v[136:139], v[196:199], v[200:203], v[136:139]
    v_mfma_f32_16x16x32_bf16 v[116:119], v[172:175], v[232:235], v[116:119]
    v_mfma_f32_16x16x32_bf16 v[128:131], v[172:175], v[252:255], v[128:131]
    v_mfma_f32_16x16x32_bf16 v[120:123], v[148:151], v[232:235], v[120:123]
    v_mfma_f32_16x16x32_bf16 v[132:135], v[148:151], v[252:255], v[132:135]
    v_mfma_f32_16x16x32_bf16 v[112:115], v[176:179], v[252:255], v[112:115]
    v_mfma_f32_16x16x32_bf16 v[124:127], v[176:179], v[200:203], v[124:127]
    v_mfma_f32_16x16x32_bf16 v[136:139], v[176:179], v[180:183], v[136:139]
    v_mfma_f32_16x16x32_bf16 v[116:119], v[184:187], v[252:255], v[116:119]
    v_mfma_f32_16x16x32_bf16 v[128:131], v[184:187], v[200:203], v[128:131]
    s_waitcnt lgkmcnt(0)
    v_mfma_f32_16x16x32_bf16 v[120:123], v[152:155], v[252:255], v[120:123]
    v_mfma_f32_16x16x32_bf16 v[132:135], v[152:155], v[200:203], v[132:135]
    s_nop 7
    v_cvt_pk_bf16_f32 v112, v112, v113
    v_cvt_pk_bf16_f32 v113, v114, v115
    ds_write_b64 v20, v[112:113] offset:12288
    v_cvt_pk_bf16_f32 v124, v124, v125
    v_cvt_pk_bf16_f32 v125, v126, v127
    ds_write_b64 v20, v[124:125] offset:15360
    v_cvt_pk_bf16_f32 v136, v136, v137
    v_cvt_pk_bf16_f32 v137, v138, v139
    ds_write_b64 v20, v[136:137] offset:18432
    v_cvt_pk_bf16_f32 v116, v116, v117
    v_cvt_pk_bf16_f32 v117, v118, v119
    ds_write_b64 v20, v[116:117] offset:12352
    v_cvt_pk_bf16_f32 v128, v128, v129
    v_cvt_pk_bf16_f32 v129, v130, v131
    ds_write_b64 v20, v[128:129] offset:15424
    v_cvt_pk_bf16_f32 v120, v120, v121
    v_cvt_pk_bf16_f32 v121, v122, v123
    ds_write_b64 v20, v[120:121] offset:12416
    v_cvt_pk_bf16_f32 v132, v132, v133
    v_cvt_pk_bf16_f32 v133, v134, v135
    ds_write_b64 v20, v[132:133] offset:15488
    s_waitcnt lgkmcnt(0)
    s_barrier
    s_branch L_store
L_cls1:
    s_waitcnt lgkmcnt(0)
    v_and_b32 v15, 15, v1
    v_lshrrev_b32 v17, 4, v1
    v_bfe_u32 v18, v1, 2, 2
    v_lshl_add_u32 v18, v17, 3, v18
    v_mul_u32_u24 v18, 192, v18
    v_and_b32 v19, 3, v1
    v_lshl_add_u32 v18, v19, 3, v18
    v_add_u32 v18, 69120, v18
    v_and_b32 v19, 1, v17
    v_lshlrev_b32 v19, 5, v19
    s_lshl_b32 s20, s17, 5
    s_add_u32 s21, s20, 64
    s_add_u32 s22, s20, 128
    v_xor_b32 v6, s20, v19
    v_add_u32 v6, v6, v18
    v_xor_b32 v7, s21, v19
    v_add_u32 v7, v7, v18
    v_xor_b32 v8, s22, v19
    v_add_u32 v8, v8, v18
    s_and_b32 s3, s18, 1
    s_lshl_b32 s3, s3, 1
    v_xor_b32 v16, s3, v17
    s_mul_i32 s25, s18, 1280
    v_lshrrev_b32 v18, 1, v15
    v_and_b32 v18, 2, v18
    v_xor_b32 v18, v18, v16
    v_lshlrev_b32 v18, 4, v18
    v_lshl_add_u32 v18, v15, 6, v18
    v_add_u32 v4, s25, v18
    v_xor_b32 v5, 32, v4
    s_barrier
    ds_read_b64_tr_b16 v[196:197], v7 offset:0
    ds_read_b64_tr_b16 v[198:199], v7 offset:768
    ds_read_b128 v[148:151], v4 offset:0
    ds_read_b64_tr_b16 v[200:201], v8 offset:0
    ds_read_b64_tr_b16 v[202:203], v8 offset:768
    ds_read_b64_tr_b16 v[192:193], v6 offset:0
    ds_read_b64_tr_b16 v[194:195], v6 offset:768
    s_waitcnt lgkmcnt(4)
    v_mfma_f32_16x16x32_bf16 v[68:71], v[196:199], v[148:151], 0
    s_waitcnt lgkmcnt(2)
    v_mfma_f32_16x16x32_bf16 v[72:75], v[200:203], v[148:151], 0
    v_add_u32 v19, 1, v15
    v_lshrrev_b32 v18, 1, v19
    v_and_b32 v18, 2, v18
    v_xor_b32 v18, v18, v16
    v_lshlrev_b32 v18, 4, v18
    v_lshl_add_u32 v18, v19, 6, v18
    v_add_u32 v2, s25, v18
    v_xor_b32 v3, 32, v2
    v_lshrrev_b32 v18, 1, v17
    s_lshl_b32 s3, s17, 1
    v_add_u32 v18, s3, v18
    v_bfe_u32 v19, v15, 1, 2
    s_barrier
    ds_read_b128 v[152:155], v5 offset:1280
    ds_read_b64_tr_b16 v[204:205], v7 offset:6144
    ds_read_b64_tr_b16 v[206:207], v7 offset:6912
    ds_read_b64_tr_b16 v[208:209], v8 offset:6144
    ds_read_b64_tr_b16 v[210:211], v8 offset:6912
    s_waitcnt lgkmcnt(4)
    v_mfma_f32_16x16x32_bf16 v[76:79], v[192:195], v[152:155], 0
    ds_read_b64_tr_b16 v[212:213], v6 offset:6144
    ds_read_b64_tr_b16 v[214:215], v6 offset:6912
    v_mfma_f32_16x16x32_bf16 v[80:83], v[196:199], v[152:155], 0
    v_mfma_f32_16x16x32_bf16 v[84:87], v[200:203], v[152:155], 0
    s_waitcnt lgkmcnt(4)
    v_mfma_f32_16x16x32_bf16 v[68:71], v[204:207], v[152:155], v[68:71]
    s_waitcnt lgkmcnt(2)
    v_mfma_f32_16x16x32_bf16 v[72:75], v[208:211], v[152:155], v[72:75]
    v_xor_b32 v18, v18, v19
    v_mul_u32_u24 v20, 192, v15
    v_lshl_add_u32 v20, v18, 4, v20
    v_and_b32 v19, 1, v17
    v_lshl_add_u32 v20, v19, 3, v20
    s_mul_i32 s3, s18, 3072
    v_add_u32 v20, s3, v20
    s_mov_b32 s24, 1
    s_mov_b32 s26, 30720
    s_mov_b32 s27, 1
    s_add_u32 s23, s25, 46080
    v_add_u32 v19, 4, v15
    s_barrier
    ds_read_b128 v[156:159], v4 offset:2560
    ds_read_b64_tr_b16 v[216:217], v7 offset:12288
    ds_read_b64_tr_b16 v[218:219], v7 offset:13056
    ds_read_b64_tr_b16 v[220:221], v8 offset:12288
    ds_read_b64_tr_b16 v[222:223], v8 offset:13056
    s_waitcnt lgkmcnt(4)
    v_mfma_f32_16x16x32_bf16 v[88:91], v[192:195], v[156:159], 0
    ds_read_b64_tr_b16 v[224:225], v6 offset:12288
    ds_read_b64_tr_b16 v[226:227], v6 offset:13056
    v_mfma_f32_16x16x32_bf16 v[92:95], v[196:199], v[156:159], 0
    v_mfma_f32_16x16x32_bf16 v[96:99], v[200:203], v[156:159], 0
    v_mfma_f32_16x16x32_bf16 v[76:79], v[212:215], v[156:159], v[76:79]
    v_mfma_f32_16x16x32_bf16 v[80:83], v[204:207], v[156:159], v[80:83]
    v_mfma_f32_16x16x32_bf16 v[84:87], v[208:211], v[156:159], v[84:87]
    s_waitcnt lgkmcnt(4)
    v_mfma_f32_16x16x32_bf16 v[68:71], v[216:219], v[156:159], v[68:71]
    s_waitcnt lgkmcnt(2)
    v_mfma_f32_16x16x32_bf16 v[72:75], v[220:223], v[156:159], v[72:75]
    v_lshrrev_b32 v18, 1, v19
    v_and_b32 v18, 2, v18
    v_xor_b32 v18, v18, v16
    v_lshlrev_b32 v18, 4, v18
    v_lshl_add_u32 v18, v19, 6, v18
    v_add_u32 v26, s23, v18
    v_xor_b32 v27, 32, v26
    v_lshlrev_b32 v46, 4, v1
    v_add_u32 v47, 0, v1
    v_mul_u32_u24 v48, 5462, v47
    v_lshrrev_b32 v48, 16, v48
    v_mul_u32_u24 v49, 12, v48
    s_barrier
    ds_read_b128 v[160:163], v5 offset:3840
    ds_read_b64_tr_b16 v[228:229], v7 offset:18432
    s_waitcnt lgkmcnt(1)
    v_mfma_f32_16x16x32_bf16 v[100:103], v[192:195], v[160:163], 0
    ds_read_b64_tr_b16 v[230:231], v7 offset:19200
    ds_read_b64_tr_b16 v[232:233], v8 offset:18432
    ds_read_b64_tr_b16 v[234:235], v8 offset:19200
    v_mfma_f32_16x16x32_bf16 v[104:107], v[196:199], v[160:163], 0
    ds_read_b64_tr_b16 v[236:237], v6 offset:18432
    ds_read_b64_tr_b16 v[238:239], v6 offset:19200
    v_mfma_f32_16x16x32_bf16 v[108:111], v[200:203], v[160:163], 0
    v_mfma_f32_16x16x32_bf16 v[88:91], v[212:215], v[160:163], v[88:91]
    v_sub_u32 v49, v47, v49
    v_lshrrev_b32 v43, 2, v49
    v_bfe_u32 v50, v48, 1, 2
    v_xor_b32 v50, v50, v49
    v_and_b32 v50, 3, v50
    v_and_b32 v49, 12, v49
    v_or_b32 v49, v49, v50
    v_mul_u32_u24 v48, 192, v48
    v_lshl_add_u32 v40, v49, 4, v48
    v_add_u32 v47, 64, v1
    v_mul_u32_u24 v48, 5462, v47
    v_lshrrev_b32 v48, 16, v48
    s_barrier
    ds_read_b128 v[164:167], v4 offset:5120
    v_mfma_f32_16x16x32_bf16 v[92:95], v[204:207], v[160:163], v[92:95]
    ds_read_b64_tr_b16 v[240:241], v7 offset:24576
    ds_read_b64_tr_b16 v[242:243], v7 offset:25344
    v_mfma_f32_16x16x32_bf16 v[96:99], v[208:211], v[160:163], v[96:99]
    ds_read_b64_tr_b16 v[244:245], v8 offset:24576
    ds_read_b64_tr_b16 v[246:247], v8 offset:25344
    v_mfma_f32_16x16x32_bf16 v[76:79], v[224:227], v[160:163], v[76:79]
    ds_read_b64_tr_b16 v[248:249], v6 offset:24576
    ds_read_b64_tr_b16 v[250:251], v6 offset:25344
    v_mfma_f32_16x16x32_bf16 v[80:83], v[216:219], v[160:163], v[80:83]
    v_mfma_f32_16x16x32_bf16 v[84:87], v[220:223], v[160:163], v[84:87]
    s_waitcnt lgkmcnt(9)
    v_mfma_f32_16x16x32_bf16 v[68:71], v[228:231], v[160:163], v[68:71]
    v_mfma_f32_16x16x32_bf16 v[72:75], v[232:235], v[160:163], v[72:75]
    s_waitcnt lgkmcnt(6)
    v_mfma_f32_16x16x32_bf16 v[112:115], v[192:195], v[164:167], 0
    v_mfma_f32_16x16x32_bf16 v[116:119], v[196:199], v[164:167], 0
    v_mfma_f32_16x16x32_bf16 v[120:123], v[200:203], v[164:167], 0
    v_mfma_f32_16x16x32_bf16 v[100:103], v[212:215], v[164:167], v[100:103]
    v_mfma_f32_16x16x32_bf16 v[104:107], v[204:207], v[164:167], v[104:107]
    v_mfma_f32_16x16x32_bf16 v[108:111], v[208:211], v[164:167], v[108:111]
    v_mfma_f32_16x16x32_bf16 v[88:91], v[224:227], v[164:167], v[88:91]
    v_mul_u32_u24 v49, 12, v48
    v_sub_u32 v49, v47, v49
    v_lshrrev_b32 v44, 2, v49
    v_bfe_u32 v50, v48, 1, 2
    v_xor_b32 v50, v50, v49
    v_and_b32 v50, 3, v50
    v_and_b32 v49, 12, v49
    v_or_b32 v49, v49, v50
    v_mul_u32_u24 v48, 192, v48
    v_lshl_add_u32 v41, v49, 4, v48
    v_add_u32 v47, 128, v1
    v_mul_u32_u24 v48, 5462, v47
    s_barrier
    ds_read_b128 v[168:171], v5 offset:6400
    v_mfma_f32_16x16x32_bf16 v[92:95], v[216:219], v[164:167], v[92:95]
    v_mfma_f32_16x16x32_bf16 v[96:99], v[220:223], v[164:167], v[96:99]
    v_mfma_f32_16x16x32_bf16 v[76:79], v[236:239], v[164:167], v[76:79]
    v_mfma_f32_16x16x32_bf16 v[80:83], v[228:231], v[164:167], v[80:83]
    v_mfma_f32_16x16x32_bf16 v[84:87], v[232:235], v[164:167], v[84:87]
    s_waitcnt lgkmcnt(1)
    v_mfma_f32_16x16x32_bf16 v[68:71], v[240:243], v[164:167], v[68:71]
    v_mfma_f32_16x16x32_bf16 v[72:75], v[244:247], v[164:167], v[72:75]
    s_waitcnt lgkmcnt(0)
    v_mfma_f32_16x16x32_bf16 v[124:127], v[192:195], v[168:171], 0
    v_mfma_f32_16x16x32_bf16 v[128:131], v[196:199], v[168:171], 0
    v_mfma_f32_16x16x32_bf16 v[132:135], v[200:203], v[168:171], 0
    v_mfma_f32_16x16x32_bf16 v[112:115], v[212:215], v[168:171], v[112:115]
    v_mfma_f32_16x16x32_bf16 v[116:119], v[204:207], v[168:171], v[116:119]
    v_mfma_f32_16x16x32_bf16 v[120:123], v[208:211], v[168:171], v[120:123]
    v_mfma_f32_16x16x32_bf16 v[100:103], v[224:227], v[168:171], v[100:103]
    v_mfma_f32_16x16x32_bf16 v[104:107], v[216:219], v[168:171], v[104:107]
    v_lshrrev_b32 v48, 16, v48
    v_mul_u32_u24 v49, 12, v48
    v_sub_u32 v49, v47, v49
    v_lshrrev_b32 v45, 2, v49
    v_bfe_u32 v50, v48, 1, 2
    v_xor_b32 v50, v50, v49
    v_and_b32 v50, 3, v50
    v_and_b32 v49, 12, v49
    v_or_b32 v49, v49, v50
    v_mul_u32_u24 v48, 192, v48
    v_lshl_add_u32 v42, v49, 4, v48
    s_mov_b32 s76, s8
    s_barrier
    ds_read_b128 v[172:175], v4 offset:7680
    v_mfma_f32_16x16x32_bf16 v[108:111], v[220:223], v[168:171], v[108:111]
    s_mov_b32 s77, s9
    s_mov_b32 s78, 9633792
    v_mfma_f32_16x16x32_bf16 v[88:91], v[236:239], v[168:171], v[88:91]
    s_mov_b32 s79, 0x20000
    s_mov_b32 s85, 3088
    v_mfma_f32_16x16x32_bf16 v[92:95], v[228:231], v[168:171], v[92:95]
    s_cmp_eq_u32 s14, 1
    s_cselect_b32 s85, 3330, s85
    v_mfma_f32_16x16x32_bf16 v[96:99], v[232:235], v[168:171], v[96:99]
    s_cmp_eq_u32 s14, 2
    s_cselect_b32 s85, 25377, s85
    v_mfma_f32_16x16x32_bf16 v[76:79], v[248:251], v[168:171], v[76:79]
    ds_read_b128 v[176:179], v5 offset:8960
    s_cmp_eq_u32 s14, 3
    v_mfma_f32_16x16x32_bf16 v[80:83], v[240:243], v[168:171], v[80:83]
    s_cselect_b32 s85, 2576, s85
    s_cmp_eq_u32 s14, 4
    v_mfma_f32_16x16x32_bf16 v[84:87], v[244:247], v[168:171], v[84:87]
    s_cselect_b32 s85, 2818, s85
    s_and_b32 s84, s85, 15
    s_waitcnt lgkmcnt(1)
    v_mfma_f32_16x16x32_bf16 v[136:139], v[192:195], v[172:175], 0
    s_bfe_u32 s86, s85, 0x40004
    s_lshr_b32 s85, s85, 8
    v_mfma_f32_16x16x32_bf16 v[140:143], v[196:199], v[172:175], 0
    s_mov_b32 s87, 4294751828
    s_cmp_eq_u32 s14, 1
    v_mfma_f32_16x16x32_bf16 v[124:127], v[212:215], v[172:175], v[124:127]
    s_cselect_b32 s87, 4292654682, s87
    s_cmp_eq_u32 s14, 2
    v_mfma_f32_16x16x32_bf16 v[128:131], v[204:207], v[172:175], v[128:131]
    s_cselect_b32 s87, 4294751834, s87
    ds_read_b128 v[180:183], v4 offset:10240
    v_mfma_f32_16x16x32_bf16 v[132:135], v[208:211], v[172:175], v[132:135]
    s_cmp_eq_u32 s14, 3
    s_cselect_b32 s87, 4294945108, s87
    v_mfma_f32_16x16x32_bf16 v[112:115], v[224:227], v[172:175], v[112:115]
    s_cmp_eq_u32 s14, 4
    s_cselect_b32 s87, 4294949460, s87
    v_mfma_f32_16x16x32_bf16 v[116:119], v[216:219], v[172:175], v[116:119]
    s_lshl_b32 s3, s16, 2
    s_lshr_b32 s87, s87, s3
    v_mfma_f32_16x16x32_bf16 v[120:123], v[220:223], v[172:175], v[120:123]
    s_and_b32 s87, s87, 15
    s_add_u32 s80, s15, s87
    v_mfma_f32_16x16x32_bf16 v[100:103], v[236:239], v[172:175], v[100:103]
    s_mul_i32 s80, s80, 43008
    s_mul_i32 s3, s12, 192
    v_mfma_f32_16x16x32_bf16 v[104:107], v[228:231], v[172:175], v[104:107]
    ds_read_b128 v[184:187], v5 offset:11520
    s_add_u32 s80, s80, s3
    v_mfma_f32_16x16x32_bf16 v[108:111], v[232:235], v[172:175], v[108:111]
    s_mul_i32 s81, s87, 3072
    v_add_u32 v47, s81, v40
    v_mfma_f32_16x16x32_bf16 v[88:91], v[248:251], v[172:175], v[88:91]
    v_add_u32 v48, s81, v41
    v_add_u32 v49, s81, v42
    v_mfma_f32_16x16x32_bf16 v[92:95], v[240:243], v[172:175], v[92:95]
    ds_read_b128 v[188:191], v4 offset:12800
    s_cmp_eq_u32 s87, 0
    v_mfma_f32_16x16x32_bf16 v[96:99], v[244:247], v[172:175], v[96:99]
    s_barrier
    ds_read_b128 v[148:151], v2 offset:0
    s_waitcnt lgkmcnt(3)
    v_mfma_f32_16x16x32_bf16 v[136:139], v[212:215], v[176:179], v[136:139]
    ds_read_b128 v[152:155], v3 offset:1280
    ds_read_b128 v[156:159], v2 offset:2560
    v_mfma_f32_16x16x32_bf16 v[140:143], v[204:207], v[176:179], v[140:143]
    ds_read_b64_tr_b16 v[192:193], v6 offset:30720
    ds_read_b64_tr_b16 v[194:195], v6 offset:31488
    v_mfma_f32_16x16x32_bf16 v[124:127], v[224:227], v[176:179], v[124:127]
    ds_read_b128 v[160:163], v3 offset:3840
    ds_read_b64_tr_b16 v[196:197], v7 offset:30720
    v_mfma_f32_16x16x32_bf16 v[128:131], v[216:219], v[176:179], v[128:131]
    ds_read_b64_tr_b16 v[198:199], v7 offset:31488
    ds_read_b128 v[164:167], v2 offset:5120
    v_mfma_f32_16x16x32_bf16 v[132:135], v[220:223], v[176:179], v[132:135]
    ds_read_b128 v[168:171], v3 offset:6400
    ds_read_b128 v[172:175], v2 offset:7680
    v_mfma_f32_16x16x32_bf16 v[112:115], v[236:239], v[176:179], v[112:115]
    ds_read_b64_tr_b16 v[200:201], v8 offset:30720
    v_mfma_f32_16x16x32_bf16 v[116:119], v[228:231], v[176:179], v[116:119]
    ds_read_b64_tr_b16 v[202:203], v8 offset:31488
    v_mfma_f32_16x16x32_bf16 v[120:123], v[232:235], v[176:179], v[120:123]
    s_cselect_b32 s82, s84, 0
    v_mfma_f32_16x16x32_bf16 v[100:103], v[248:251], v[176:179], v[100:103]
    s_cmp_eq_u32 s87, s85
    v_mfma_f32_16x16x32_bf16 v[104:107], v[240:243], v[176:179], v[104:107]
    s_cselect_b32 s83, s86, 2
    v_mfma_f32_16x16x32_bf16 v[108:111], v[244:247], v[176:179], v[108:111]
    v_cmp_le_u32 vcc, s82, v43
    v_mfma_f32_16x16x32_bf16 v[136:139], v[224:227], v[180:183], v[136:139]
    v_cmp_ge_u32 s[64:65], s83, v43
    v_mfma_f32_16x16x32_bf16 v[140:143], v[216:219], v[180:183], v[140:143]
    s_nop 0
    v_mfma_f32_16x16x32_bf16 v[124:127], v[236:239], v[180:183], v[124:127]
    s_and_b64 s[64:65], s[64:65], vcc
    v_mfma_f32_16x16x32_bf16 v[128:131], v[228:231], v[180:183], v[128:131]
    v_cmp_le_u32 vcc, s82, v44
    v_mfma_f32_16x16x32_bf16 v[132:135], v[232:235], v[180:183], v[132:135]
    v_cmp_ge_u32 s[66:67], s83, v44
    v_mfma_f32_16x16x32_bf16 v[112:115], v[248:251], v[180:183], v[112:115]
    s_nop 0
    v_mfma_f32_16x16x32_bf16 v[116:119], v[240:243], v[180:183], v[116:119]
    s_and_b64 s[66:67], s[66:67], vcc
    v_cmp_le_u32 vcc, s82, v45
    v_mfma_f32_16x16x32_bf16 v[120:123], v[244:247], v[180:183], v[120:123]
    v_cmp_ge_u32 s[68:69], s83, v45
    s_nop 0
    s_waitcnt lgkmcnt(0)
    v_mfma_f32_16x16x32_bf16 v[136:139], v[236:239], v[184:187], v[136:139]
    s_and_b64 s[68:69], s[68:69], vcc
    v_add_u32 v6, 30720, v6
    v_mfma_f32_16x16x32_bf16 v[140:143], v[228:231], v[184:187], v[140:143]
    v_add_u32 v7, 30720, v7
    v_add_u32 v8, 30720, v8
    v_mfma_f32_16x16x32_bf16 v[124:127], v[248:251], v[184:187], v[124:127]
    v_mfma_f32_16x16x32_bf16 v[128:131], v[240:243], v[184:187], v[128:131]
    v_mfma_f32_16x16x32_bf16 v[132:135], v[244:247], v[184:187], v[132:135]
    v_mfma_f32_16x16x32_bf16 v[136:139], v[248:251], v[188:191], v[136:139]
    v_mfma_f32_16x16x32_bf16 v[140:143], v[240:243], v[188:191], v[140:143]
    s_waitcnt lgkmcnt(0)
    s_waitcnt vmcnt(0)
L_loop1:
    ds_read_b64_tr_b16 v[204:205], v6 offset:6144
    s_waitcnt lgkmcnt(3)
    v_mfma_f32_16x16x32_bf16 v[76:79], v[192:195], v[152:155], v[76:79]
    ds_read_b64_tr_b16 v[206:207], v6 offset:6912
    v_mfma_f32_16x16x32_bf16 v[88:91], v[192:195], v[156:159], v[88:91]
    ds_read_b128 v[176:179], v3 offset:8960
    v_mfma_f32_16x16x32_bf16 v[100:103], v[192:195], v[160:163], v[100:103]
    ds_read_b64_tr_b16 v[208:209], v7 offset:6144
    v_mfma_f32_16x16x32_bf16 v[68:71], v[196:199], v[148:151], v[68:71]
    ds_read_b64_tr_b16 v[210:211], v7 offset:6912
    v_mfma_f32_16x16x32_bf16 v[80:83], v[196:199], v[152:155], v[80:83]
    ds_read_b128 v[180:183], v2 offset:10240
    v_mfma_f32_16x16x32_bf16 v[92:95], v[196:199], v[156:159], v[92:95]
    ds_read_b128 v[184:187], v3 offset:11520
    v_mfma_f32_16x16x32_bf16 v[104:107], v[196:199], v[160:163], v[104:107]
    ds_read_b128 v[188:191], v2 offset:12800
    s_waitcnt lgkmcnt(8)
    v_mfma_f32_16x16x32_bf16 v[72:75], v[200:203], v[148:151], v[72:75]
    s_add_u32 s24, s24, 1
    v_mfma_f32_16x16x32_bf16 v[84:87], v[200:203], v[152:155], v[84:87]
    s_cmp_eq_u32 s24, 5
    v_mfma_f32_16x16x32_bf16 v[96:99], v[200:203], v[156:159], v[96:99]
    s_cselect_b32 s3, 23040, 0
    v_mfma_f32_16x16x32_bf16 v[108:111], v[200:203], v[160:163], v[108:111]
    s_cselect_b32 s24, 0, s24
    v_mfma_f32_16x16x32_bf16 v[112:115], v[192:195], v[164:167], v[112:115]
    s_add_u32 s25, s25, s3
    v_mfma_f32_16x16x32_bf16 v[124:127], v[192:195], v[168:171], v[124:127]
    v_add_u32 v17, s24, v15
    v_mfma_f32_16x16x32_bf16 v[136:139], v[192:195], v[172:175], v[136:139]
    ds_read_b64_tr_b16 v[192:193], v8 offset:6144
    v_mfma_f32_16x16x32_bf16 v[116:119], v[196:199], v[164:167], v[116:119]
    ds_read_b64_tr_b16 v[194:195], v8 offset:6912
    v_mfma_f32_16x16x32_bf16 v[128:131], v[196:199], v[168:171], v[128:131]
    v_lshrrev_b32 v18, 1, v17
    v_mfma_f32_16x16x32_bf16 v[140:143], v[196:199], v[172:175], v[140:143]
    ds_read_b64_tr_b16 v[196:197], v6 offset:12288
    v_mfma_f32_16x16x32_bf16 v[120:123], v[200:203], v[164:167], v[120:123]
    ds_read_b64_tr_b16 v[198:199], v6 offset:13056
    v_mfma_f32_16x16x32_bf16 v[132:135], v[200:203], v[168:171], v[132:135]
    ds_read_b64_tr_b16 v[200:201], v7 offset:12288
    s_waitcnt lgkmcnt(5)
    v_mfma_f32_16x16x32_bf16 v[76:79], v[204:207], v[156:159], v[76:79]
    ds_read_b64_tr_b16 v[202:203], v7 offset:13056
    v_mfma_f32_16x16x32_bf16 v[88:91], v[204:207], v[160:163], v[88:91]
    v_and_b32 v18, 2, v18
    v_mfma_f32_16x16x32_bf16 v[100:103], v[204:207], v[164:167], v[100:103]
    v_xor_b32 v18, v18, v16
    v_mfma_f32_16x16x32_bf16 v[112:115], v[204:207], v[168:171], v[112:115]
    v_lshlrev_b32 v18, 4, v18
    v_mfma_f32_16x16x32_bf16 v[124:127], v[204:207], v[172:175], v[124:127]
    v_lshl_add_u32 v18, v17, 6, v18
    v_mfma_f32_16x16x32_bf16 v[136:139], v[204:207], v[176:179], v[136:139]
    ds_read_b64_tr_b16 v[204:205], v8 offset:12288
    v_mfma_f32_16x16x32_bf16 v[68:71], v[208:211], v[152:155], v[68:71]
    ds_read_b64_tr_b16 v[206:207], v8 offset:13056
    v_mfma_f32_16x16x32_bf16 v[80:83], v[208:211], v[156:159], v[80:83]
    v_add_u32 v2, s25, v18
    v_mfma_f32_16x16x32_bf16 v[92:95], v[208:211], v[160:163], v[92:95]
    v_xor_b32 v3, 32, v2
    v_mfma_f32_16x16x32_bf16 v[104:107], v[208:211], v[164:167], v[104:107]
    ds_read_b128 v[148:151], v2 offset:0
    v_mfma_f32_16x16x32_bf16 v[116:119], v[208:211], v[168:171], v[116:119]
    v_mfma_f32_16x16x32_bf16 v[128:131], v[208:211], v[172:175], v[128:131]
    v_mfma_f32_16x16x32_bf16 v[140:143], v[208:211], v[176:179], v[140:143]
    ds_read_b64_tr_b16 v[208:209], v6 offset:18432
    s_waitcnt lgkmcnt(4)
    v_mfma_f32_16x16x32_bf16 v[72:75], v[192:195], v[152:155], v[72:75]
    ds_read_b64_tr_b16 v[210:211], v6 offset:19200
    v_mfma_f32_16x16x32_bf16 v[84:87], v[192:195], v[156:159], v[84:87]
    ds_read_b128 v[152:155], v3 offset:1280
    v_mfma_f32_16x16x32_bf16 v[96:99], v[192:195], v[160:163], v[96:99]
    v_mfma_f32_16x16x32_bf16 v[108:111], v[192:195], v[164:167], v[108:111]
    v_mfma_f32_16x16x32_bf16 v[120:123], v[192:195], v[168:171], v[120:123]
    v_mfma_f32_16x16x32_bf16 v[132:135], v[192:195], v[172:175], v[132:135]
    ds_read_b64_tr_b16 v[192:193], v7 offset:18432
    v_mfma_f32_16x16x32_bf16 v[76:79], v[196:199], v[160:163], v[76:79]
    ds_read_b64_tr_b16 v[194:195], v7 offset:19200
    v_mfma_f32_16x16x32_bf16 v[88:91], v[196:199], v[164:167], v[88:91]
    v_mfma_f32_16x16x32_bf16 v[100:103], v[196:199], v[168:171], v[100:103]
    v_mfma_f32_16x16x32_bf16 v[112:115], v[196:199], v[172:175], v[112:115]
    v_mfma_f32_16x16x32_bf16 v[124:127], v[196:199], v[176:179], v[124:127]
    v_mfma_f32_16x16x32_bf16 v[136:139], v[196:199], v[180:183], v[136:139]
    ds_read_b64_tr_b16 v[196:197], v8 offset:18432
    v_mfma_f32_16x16x32_bf16 v[68:71], v[200:203], v[156:159], v[68:71]
    ds_read_b64_tr_b16 v[198:199], v8 offset:19200
    v_mfma_f32_16x16x32_bf16 v[80:83], v[200:203], v[160:163], v[80:83]
    v_mfma_f32_16x16x32_bf16 v[92:95], v[200:203], v[164:167], v[92:95]
    v_mfma_f32_16x16x32_bf16 v[104:107], v[200:203], v[168:171], v[104:107]
    v_mfma_f32_16x16x32_bf16 v[116:119], v[200:203], v[172:175], v[116:119]
    v_mfma_f32_16x16x32_bf16 v[128:131], v[200:203], v[176:179], v[128:131]
    v_mfma_f32_16x16x32_bf16 v[140:143], v[200:203], v[180:183], v[140:143]
    ds_read_b64_tr_b16 v[200:201], v6 offset:24576
    s_waitcnt lgkmcnt(3)
    v_mfma_f32_16x16x32_bf16 v[72:75], v[204:207], v[156:159], v[72:75]
    ds_read_b64_tr_b16 v[202:203], v6 offset:25344
    v_mfma_f32_16x16x32_bf16 v[84:87], v[204:207], v[160:163], v[84:87]
    s_add_u32 s26, s26, 30720
    v_mfma_f32_16x16x32_bf16 v[96:99], v[204:207], v[164:167], v[96:99]
    s_cmp_eq_u32 s26, 92160
    v_mfma_f32_16x16x32_bf16 v[108:111], v[204:207], v[168:171], v[108:111]
    s_cselect_b32 s33, 4294875136, 0
    v_mfma_f32_16x16x32_bf16 v[120:123], v[204:207], v[172:175], v[120:123]
    s_cselect_b32 s26, 0, s26
    v_mfma_f32_16x16x32_bf16 v[132:135], v[204:207], v[176:179], v[132:135]
    ds_read_b64_tr_b16 v[204:205], v7 offset:24576
    v_mfma_f32_16x16x32_bf16 v[76:79], v[208:211], v[164:167], v[76:79]
    ds_read_b64_tr_b16 v[206:207], v7 offset:25344
    v_mfma_f32_16x16x32_bf16 v[88:91], v[208:211], v[168:171], v[88:91]
    s_add_u32 s33, s33, 30720
    v_mfma_f32_16x16x32_bf16 v[100:103], v[208:211], v[172:175], v[100:103]
    ds_read_b128 v[156:159], v2 offset:2560
    v_mfma_f32_16x16x32_bf16 v[112:115], v[208:211], v[176:179], v[112:115]
    v_mfma_f32_16x16x32_bf16 v[124:127], v[208:211], v[180:183], v[124:127]
    v_mfma_f32_16x16x32_bf16 v[136:139], v[208:211], v[184:187], v[136:139]
    ds_read_b64_tr_b16 v[208:209], v8 offset:24576
    v_mfma_f32_16x16x32_bf16 v[68:71], v[192:195], v[160:163], v[68:71]
    ds_read_b64_tr_b16 v[210:211], v8 offset:25344
    v_mfma_f32_16x16x32_bf16 v[80:83], v[192:195], v[164:167], v[80:83]
    v_add_u32 v6, s33, v6
    v_mfma_f32_16x16x32_bf16 v[92:95], v[192:195], v[168:171], v[92:95]
    v_add_u32 v7, s33, v7
    v_mfma_f32_16x16x32_bf16 v[104:107], v[192:195], v[172:175], v[104:107]
    v_add_u32 v8, s33, v8
    v_mfma_f32_16x16x32_bf16 v[116:119], v[192:195], v[176:179], v[116:119]
    v_mfma_f32_16x16x32_bf16 v[128:131], v[192:195], v[180:183], v[128:131]
    v_mfma_f32_16x16x32_bf16 v[140:143], v[192:195], v[184:187], v[140:143]
    s_waitcnt lgkmcnt(0)
    s_barrier
    v_mfma_f32_16x16x32_bf16 v[72:75], v[196:199], v[160:163], v[72:75]
    ds_read_b64_tr_b16 v[192:193], v6 offset:0
    v_mfma_f32_16x16x32_bf16 v[84:87], v[196:199], v[164:167], v[84:87]
    ds_read_b64_tr_b16 v[194:195], v6 offset:768
    v_mfma_f32_16x16x32_bf16 v[96:99], v[196:199], v[168:171], v[96:99]
    ds_read_b128 v[160:163], v3 offset:3840
    v_mfma_f32_16x16x32_bf16 v[108:111], v[196:199], v[172:175], v[108:111]
    v_mfma_f32_16x16x32_bf16 v[120:123], v[196:199], v[176:179], v[120:123]
    v_mfma_f32_16x16x32_bf16 v[132:135], v[196:199], v[180:183], v[132:135]
    ds_read_b64_tr_b16 v[196:197], v7 offset:0
    v_mfma_f32_16x16x32_bf16 v[76:79], v[200:203], v[168:171], v[76:79]
    ds_read_b64_tr_b16 v[198:199], v7 offset:768
    v_mfma_f32_16x16x32_bf16 v[88:91], v[200:203], v[172:175], v[88:91]
    v_mfma_f32_16x16x32_bf16 v[68:71], v[204:207], v[164:167], v[68:71]
    v_mfma_f32_16x16x32_bf16 v[80:83], v[204:207], v[168:171], v[80:83]
    v_mfma_f32_16x16x32_bf16 v[92:95], v[204:207], v[172:175], v[92:95]
    v_mfma_f32_16x16x32_bf16 v[72:75], v[208:211], v[164:167], v[72:75]
    ds_read_b128 v[164:167], v2 offset:5120
    v_mfma_f32_16x16x32_bf16 v[84:87], v[208:211], v[168:171], v[84:87]
    ds_read_b128 v[168:171], v3 offset:6400
    v_mfma_f32_16x16x32_bf16 v[96:99], v[208:211], v[172:175], v[96:99]
    ds_read_b128 v[172:175], v2 offset:7680
    v_mfma_f32_16x16x32_bf16 v[100:103], v[200:203], v[176:179], v[100:103]
    v_mfma_f32_16x16x32_bf16 v[112:115], v[200:203], v[180:183], v[112:115]
    v_mfma_f32_16x16x32_bf16 v[124:127], v[200:203], v[184:187], v[124:127]
    v_mfma_f32_16x16x32_bf16 v[136:139], v[200:203], v[188:191], v[136:139]
    ds_read_b64_tr_b16 v[200:201], v8 offset:0
    v_mfma_f32_16x16x32_bf16 v[104:107], v[204:207], v[176:179], v[104:107]
    ds_read_b64_tr_b16 v[202:203], v8 offset:768
    v_mfma_f32_16x16x32_bf16 v[116:119], v[204:207], v[180:183], v[116:119]
    v_mfma_f32_16x16x32_bf16 v[128:131], v[204:207], v[184:187], v[128:131]
    v_mfma_f32_16x16x32_bf16 v[140:143], v[204:207], v[188:191], v[140:143]
    v_mfma_f32_16x16x32_bf16 v[108:111], v[208:211], v[176:179], v[108:111]
    v_mfma_f32_16x16x32_bf16 v[120:123], v[208:211], v[180:183], v[120:123]
    v_mfma_f32_16x16x32_bf16 v[132:135], v[208:211], v[184:187], v[132:135]
    ds_read_b64_tr_b16 v[204:205], v6 offset:6144
    s_waitcnt lgkmcnt(3)
    v_mfma_f32_16x16x32_bf16 v[76:79], v[192:195], v[152:155], v[76:79]
    ds_read_b64_tr_b16 v[206:207], v6 offset:6912
    v_mfma_f32_16x16x32_bf16 v[88:91], v[192:195], v[156:159], v[88:91]
    ds_read_b128 v[176:179], v3 offset:8960
    v_mfma_f32_16x16x32_bf16 v[100:103], v[192:195], v[160:163], v[100:103]
    ds_read_b64_tr_b16 v[208:209], v7 offset:6144
    v_mfma_f32_16x16x32_bf16 v[68:71], v[196:199], v[148:151], v[68:71]
    ds_read_b64_tr_b16 v[210:211], v7 offset:6912
    v_mfma_f32_16x16x32_bf16 v[80:83], v[196:199], v[152:155], v[80:83]
    ds_read_b128 v[180:183], v2 offset:10240
    v_mfma_f32_16x16x32_bf16 v[92:95], v[196:199], v[156:159], v[92:95]
    ds_read_b128 v[184:187], v3 offset:11520
    v_mfma_f32_16x16x32_bf16 v[104:107], v[196:199], v[160:163], v[104:107]
    ds_read_b128 v[188:191], v2 offset:12800
    s_waitcnt lgkmcnt(8)
    v_mfma_f32_16x16x32_bf16 v[72:75], v[200:203], v[148:151], v[72:75]
    s_add_u32 s24, s24, 1
    v_mfma_f32_16x16x32_bf16 v[84:87], v[200:203], v[152:155], v[84:87]
    s_cmp_eq_u32 s24, 5
    v_mfma_f32_16x16x32_bf16 v[96:99], v[200:203], v[156:159], v[96:99]
    s_cselect_b32 s3, 23040, 0
    v_mfma_f32_16x16x32_bf16 v[108:111], v[200:203], v[160:163], v[108:111]
    s_cselect_b32 s24, 0, s24
    v_mfma_f32_16x16x32_bf16 v[112:115], v[192:195], v[164:167], v[112:115]
    s_add_u32 s25, s25, s3
    v_mfma_f32_16x16x32_bf16 v[124:127], v[192:195], v[168:171], v[124:127]
    v_add_u32 v17, s24, v15
    v_mfma_f32_16x16x32_bf16 v[136:139], v[192:195], v[172:175], v[136:139]
    ds_read_b64_tr_b16 v[192:193], v8 offset:6144
    v_mfma_f32_16x16x32_bf16 v[116:119], v[196:199], v[164:167], v[116:119]
    ds_read_b64_tr_b16 v[194:195], v8 offset:6912
    v_mfma_f32_16x16x32_bf16 v[128:131], v[196:199], v[168:171], v[128:131]
    v_lshrrev_b32 v18, 1, v17
    v_mfma_f32_16x16x32_bf16 v[140:143], v[196:199], v[172:175], v[140:143]
    ds_read_b64_tr_b16 v[196:197], v6 offset:12288
    v_mfma_f32_16x16x32_bf16 v[120:123], v[200:203], v[164:167], v[120:123]
    ds_read_b64_tr_b16 v[198:199], v6 offset:13056
    v_mfma_f32_16x16x32_bf16 v[132:135], v[200:203], v[168:171], v[132:135]
    ds_read_b64_tr_b16 v[200:201], v7 offset:12288
    s_waitcnt lgkmcnt(5)
    v_mfma_f32_16x16x32_bf16 v[76:79], v[204:207], v[156:159], v[76:79]
    ds_read_b64_tr_b16 v[202:203], v7 offset:13056
    v_mfma_f32_16x16x32_bf16 v[88:91], v[204:207], v[160:163], v[88:91]
    v_and_b32 v18, 2, v18
    v_mfma_f32_16x16x32_bf16 v[100:103], v[204:207], v[164:167], v[100:103]
    v_xor_b32 v18, v18, v16
    v_mfma_f32_16x16x32_bf16 v[112:115], v[204:207], v[168:171], v[112:115]
    v_lshlrev_b32 v18, 4, v18
    v_mfma_f32_16x16x32_bf16 v[124:127], v[204:207], v[172:175], v[124:127]
    v_lshl_add_u32 v18, v17, 6, v18
    v_mfma_f32_16x16x32_bf16 v[136:139], v[204:207], v[176:179], v[136:139]
    ds_read_b64_tr_b16 v[204:205], v8 offset:12288
    v_mfma_f32_16x16x32_bf16 v[68:71], v[208:211], v[152:155], v[68:71]
    ds_read_b64_tr_b16 v[206:207], v8 offset:13056
    v_mfma_f32_16x16x32_bf16 v[80:83], v[208:211], v[156:159], v[80:83]
    v_add_u32 v2, s25, v18
    v_mfma_f32_16x16x32_bf16 v[92:95], v[208:211], v[160:163], v[92:95]
    v_xor_b32 v3, 32, v2
    v_mfma_f32_16x16x32_bf16 v[104:107], v[208:211], v[164:167], v[104:107]
    ds_read_b128 v[148:151], v2 offset:0
    v_mfma_f32_16x16x32_bf16 v[116:119], v[208:211], v[168:171], v[116:119]
    v_mfma_f32_16x16x32_bf16 v[128:131], v[208:211], v[172:175], v[128:131]
    v_mfma_f32_16x16x32_bf16 v[140:143], v[208:211], v[176:179], v[140:143]
    ds_read_b64_tr_b16 v[208:209], v6 offset:18432
    s_waitcnt lgkmcnt(4)
    v_mfma_f32_16x16x32_bf16 v[72:75], v[192:195], v[152:155], v[72:75]
    ds_read_b64_tr_b16 v[210:211], v6 offset:19200
    v_mfma_f32_16x16x32_bf16 v[84:87], v[192:195], v[156:159], v[84:87]
    ds_read_b128 v[152:155], v3 offset:1280
    v_mfma_f32_16x16x32_bf16 v[96:99], v[192:195], v[160:163], v[96:99]
    v_mfma_f32_16x16x32_bf16 v[108:111], v[192:195], v[164:167], v[108:111]
    v_mfma_f32_16x16x32_bf16 v[120:123], v[192:195], v[168:171], v[120:123]
    v_mfma_f32_16x16x32_bf16 v[132:135], v[192:195], v[172:175], v[132:135]
    ds_read_b64_tr_b16 v[192:193], v7 offset:18432
    v_mfma_f32_16x16x32_bf16 v[76:79], v[196:199], v[160:163], v[76:79]
    ds_read_b64_tr_b16 v[194:195], v7 offset:19200
    v_mfma_f32_16x16x32_bf16 v[88:91], v[196:199], v[164:167], v[88:91]
    v_mfma_f32_16x16x32_bf16 v[100:103], v[196:199], v[168:171], v[100:103]
    v_mfma_f32_16x16x32_bf16 v[112:115], v[196:199], v[172:175], v[112:115]
    v_mfma_f32_16x16x32_bf16 v[124:127], v[196:199], v[176:179], v[124:127]
    v_mfma_f32_16x16x32_bf16 v[136:139], v[196:199], v[180:183], v[136:139]
    ds_read_b64_tr_b16 v[196:197], v8 offset:18432
    v_mfma_f32_16x16x32_bf16 v[68:71], v[200:203], v[156:159], v[68:71]
    ds_read_b64_tr_b16 v[198:199], v8 offset:19200
    v_mfma_f32_16x16x32_bf16 v[80:83], v[200:203], v[160:163], v[80:83]
    v_mfma_f32_16x16x32_bf16 v[92:95], v[200:203], v[164:167], v[92:95]
    v_mfma_f32_16x16x32_bf16 v[104:107], v[200:203], v[168:171], v[104:107]
    v_mfma_f32_16x16x32_bf16 v[116:119], v[200:203], v[172:175], v[116:119]
    v_mfma_f32_16x16x32_bf16 v[128:131], v[200:203], v[176:179], v[128:131]
    v_mfma_f32_16x16x32_bf16 v[140:143], v[200:203], v[180:183], v[140:143]
    ds_read_b64_tr_b16 v[200:201], v6 offset:24576
    s_waitcnt lgkmcnt(3)
    v_mfma_f32_16x16x32_bf16 v[72:75], v[204:207], v[156:159], v[72:75]
    ds_read_b64_tr_b16 v[202:203], v6 offset:25344
    v_mfma_f32_16x16x32_bf16 v[84:87], v[204:207], v[160:163], v[84:87]
    s_add_u32 s26, s26, 30720
    v_mfma_f32_16x16x32_bf16 v[96:99], v[204:207], v[164:167], v[96:99]
    s_cmp_eq_u32 s26, 92160
    v_mfma_f32_16x16x32_bf16 v[108:111], v[204:207], v[168:171], v[108:111]
    s_cselect_b32 s33, 4294875136, 0
    v_mfma_f32_16x16x32_bf16 v[120:123], v[204:207], v[172:175], v[120:123]
    s_cselect_b32 s26, 0, s26
    v_mfma_f32_16x16x32_bf16 v[132:135], v[204:207], v[176:179], v[132:135]
    ds_read_b64_tr_b16 v[204:205], v7 offset:24576
    v_mfma_f32_16x16x32_bf16 v[76:79], v[208:211], v[164:167], v[76:79]
    ds_read_b64_tr_b16 v[206:207], v7 offset:25344
    v_mfma_f32_16x16x32_bf16 v[88:91], v[208:211], v[168:171], v[88:91]
    s_add_u32 s33, s33, 30720
    v_mfma_f32_16x16x32_bf16 v[100:103], v[208:211], v[172:175], v[100:103]
    ds_read_b128 v[156:159], v2 offset:2560
    v_mfma_f32_16x16x32_bf16 v[112:115], v[208:211], v[176:179], v[112:115]
    v_mfma_f32_16x16x32_bf16 v[124:127], v[208:211], v[180:183], v[124:127]
    v_mfma_f32_16x16x32_bf16 v[136:139], v[208:211], v[184:187], v[136:139]
    ds_read_b64_tr_b16 v[208:209], v8 offset:24576
    v_mfma_f32_16x16x32_bf16 v[68:71], v[192:195], v[160:163], v[68:71]
    ds_read_b64_tr_b16 v[210:211], v8 offset:25344
    v_mfma_f32_16x16x32_bf16 v[80:83], v[192:195], v[164:167], v[80:83]
    v_add_u32 v6, s33, v6
    v_mfma_f32_16x16x32_bf16 v[92:95], v[192:195], v[168:171], v[92:95]
    v_add_u32 v7, s33, v7
    v_mfma_f32_16x16x32_bf16 v[104:107], v[192:195], v[172:175], v[104:107]
    v_add_u32 v8, s33, v8
    v_mfma_f32_16x16x32_bf16 v[116:119], v[192:195], v[176:179], v[116:119]
    v_mfma_f32_16x16x32_bf16 v[128:131], v[192:195], v[180:183], v[128:131]
    v_mfma_f32_16x16x32_bf16 v[140:143], v[192:195], v[184:187], v[140:143]
    s_waitcnt lgkmcnt(0)
    s_barrier
    v_mfma_f32_16x16x32_bf16 v[72:75], v[196:199], v[160:163], v[72:75]
    ds_read_b64_tr_b16 v[192:193], v6 offset:0
    v_mfma_f32_16x16x32_bf16 v[84:87], v[196:199], v[164:167], v[84:87]
    ds_read_b64_tr_b16 v[194:195], v6 offset:768
    v_mfma_f32_16x16x32_bf16 v[96:99], v[196:199], v[168:171], v[96:99]
    ds_read_b128 v[160:163], v3 offset:3840
    v_mfma_f32_16x16x32_bf16 v[108:111], v[196:199], v[172:175], v[108:111]
    v_mfma_f32_16x16x32_bf16 v[120:123], v[196:199], v[176:179], v[120:123]
    v_mfma_f32_16x16x32_bf16 v[132:135], v[196:199], v[180:183], v[132:135]
    ds_read_b64_tr_b16 v[196:197], v7 offset:0
    v_mfma_f32_16x16x32_bf16 v[76:79], v[200:203], v[168:171], v[76:79]
    ds_read_b64_tr_b16 v[198:199], v7 offset:768
    v_mfma_f32_16x16x32_bf16 v[88:91], v[200:203], v[172:175], v[88:91]
    v_mfma_f32_16x16x32_bf16 v[68:71], v[204:207], v[164:167], v[68:71]
    v_mfma_f32_16x16x32_bf16 v[80:83], v[204:207], v[168:171], v[80:83]
    v_mfma_f32_16x16x32_bf16 v[92:95], v[204:207], v[172:175], v[92:95]
    v_mfma_f32_16x16x32_bf16 v[72:75], v[208:211], v[164:167], v[72:75]
    ds_read_b128 v[164:167], v2 offset:5120
    v_mfma_f32_16x16x32_bf16 v[84:87], v[208:211], v[168:171], v[84:87]
    ds_read_b128 v[168:171], v3 offset:6400
    v_mfma_f32_16x16x32_bf16 v[96:99], v[208:211], v[172:175], v[96:99]
    ds_read_b128 v[172:175], v2 offset:7680
    v_mfma_f32_16x16x32_bf16 v[100:103], v[200:203], v[176:179], v[100:103]
    v_mfma_f32_16x16x32_bf16 v[112:115], v[200:203], v[180:183], v[112:115]
    v_mfma_f32_16x16x32_bf16 v[124:127], v[200:203], v[184:187], v[124:127]
    v_mfma_f32_16x16x32_bf16 v[136:139], v[200:203], v[188:191], v[136:139]
    ds_read_b64_tr_b16 v[200:201], v8 offset:0
    v_mfma_f32_16x16x32_bf16 v[104:107], v[204:207], v[176:179], v[104:107]
    ds_read_b64_tr_b16 v[202:203], v8 offset:768
    v_mfma_f32_16x16x32_bf16 v[116:119], v[204:207], v[180:183], v[116:119]
    v_mfma_f32_16x16x32_bf16 v[128:131], v[204:207], v[184:187], v[128:131]
    v_mfma_f32_16x16x32_bf16 v[140:143], v[204:207], v[188:191], v[140:143]
    v_mfma_f32_16x16x32_bf16 v[108:111], v[208:211], v[176:179], v[108:111]
    v_mfma_f32_16x16x32_bf16 v[120:123], v[208:211], v[180:183], v[120:123]
    s_add_u32 s27, s27, 2
    v_mfma_f32_16x16x32_bf16 v[132:135], v[208:211], v[184:187], v[132:135]
    s_cmp_lt_u32 s27, 13
    s_cbranch_scc1 L_loop1
    ds_read_b64_tr_b16 v[176:177], v6 offset:6144
    ds_read_b64_tr_b16 v[178:179], v6 offset:6912
    s_waitcnt lgkmcnt(10)
    v_mfma_f32_16x16x32_bf16 v[76:79], v[192:195], v[152:155], v[76:79]
    ds_read_b64_tr_b16 v[180:181], v7 offset:6144
    ds_read_b64_tr_b16 v[182:183], v7 offset:6912
    v_mfma_f32_16x16x32_bf16 v[88:91], v[192:195], v[156:159], v[88:91]
    ds_read_b64_tr_b16 v[184:185], v8 offset:6144
    ds_read_b64_tr_b16 v[186:187], v8 offset:6912
    s_waitcnt lgkmcnt(11)
    v_mfma_f32_16x16x32_bf16 v[68:71], v[196:199], v[148:151], v[68:71]
    ds_read_b64_tr_b16 v[188:189], v6 offset:12288
    ds_read_b64_tr_b16 v[190:191], v6 offset:13056
    v_mfma_f32_16x16x32_bf16 v[80:83], v[196:199], v[152:155], v[80:83]
    ds_read_b64_tr_b16 v[204:205], v7 offset:12288
    v_mfma_f32_16x16x32_bf16 v[92:95], v[196:199], v[156:159], v[92:95]
    ds_read_b64_tr_b16 v[206:207], v7 offset:13056
    s_waitcnt lgkmcnt(10)
    v_mfma_f32_16x16x32_bf16 v[72:75], v[200:203], v[148:151], v[72:75]
    ds_read_b64_tr_b16 v[208:209], v8 offset:12288
    v_mfma_f32_16x16x32_bf16 v[84:87], v[200:203], v[152:155], v[84:87]
    ds_read_b64_tr_b16 v[210:211], v8 offset:13056
    v_mfma_f32_16x16x32_bf16 v[96:99], v[200:203], v[156:159], v[96:99]
    ds_read_b64_tr_b16 v[212:213], v6 offset:18432
    s_waitcnt lgkmcnt(11)
    v_mfma_f32_16x16x32_bf16 v[76:79], v[176:179], v[156:159], v[76:79]
    ds_read_b64_tr_b16 v[214:215], v6 offset:19200
    v_mfma_f32_16x16x32_bf16 v[88:91], v[176:179], v[160:163], v[88:91]
    ds_read_b64_tr_b16 v[216:217], v7 offset:18432
    s_waitcnt lgkmcnt(9)
    v_mfma_f32_16x16x32_bf16 v[68:71], v[180:183], v[152:155], v[68:71]
    ds_read_b64_tr_b16 v[218:219], v7 offset:19200
    v_mfma_f32_16x16x32_bf16 v[80:83], v[180:183], v[156:159], v[80:83]
    ds_read_b64_tr_b16 v[220:221], v8 offset:18432
    v_mfma_f32_16x16x32_bf16 v[92:95], v[180:183], v[160:163], v[92:95]
    ds_read_b64_tr_b16 v[222:223], v8 offset:19200
    v_mfma_f32_16x16x32_bf16 v[72:75], v[184:187], v[152:155], v[72:75]
    ds_read_b64_tr_b16 v[224:225], v6 offset:24576
    v_mfma_f32_16x16x32_bf16 v[84:87], v[184:187], v[156:159], v[84:87]
    ds_read_b64_tr_b16 v[226:227], v6 offset:25344
    v_mfma_f32_16x16x32_bf16 v[96:99], v[184:187], v[160:163], v[96:99]
    ds_read_b64_tr_b16 v[228:229], v7 offset:24576
    s_waitcnt lgkmcnt(8)
    v_mfma_f32_16x16x32_bf16 v[76:79], v[188:191], v[160:163], v[76:79]
    ds_read_b64_tr_b16 v[230:231], v7 offset:25344
    v_mfma_f32_16x16x32_bf16 v[88:91], v[188:191], v[164:167], v[88:91]
    ds_read_b64_tr_b16 v[232:233], v8 offset:24576
    v_mfma_f32_16x16x32_bf16 v[68:71], v[204:207], v[156:159], v[68:71]
    ds_read_b64_tr_b16 v[234:235], v8 offset:25344
    v_mfma_f32_16x16x32_bf16 v[80:83], v[204:207], v[160:163], v[80:83]
    ds_read_b64_tr_b16 v[236:237], v6 offset:30720
    v_mfma_f32_16x16x32_bf16 v[92:95], v[204:207], v[164:167], v[92:95]
    ds_read_b64_tr_b16 v[238:239], v6 offset:31488
    v_mfma_f32_16x16x32_bf16 v[72:75], v[208:211], v[156:159], v[72:75]
    ds_read_b128 v[240:243], v27 offset:1280
    v_mfma_f32_16x16x32_bf16 v[84:87], v[208:211], v[160:163], v[84:87]
    ds_read_b128 v[244:247], v26 offset:2560
    v_mfma_f32_16x16x32_bf16 v[96:99], v[208:211], v[164:167], v[96:99]
    ds_read_b64_tr_b16 v[248:249], v7 offset:30720
    s_waitcnt lgkmcnt(8)
    v_mfma_f32_16x16x32_bf16 v[76:79], v[212:215], v[164:167], v[76:79]
    ds_read_b64_tr_b16 v[250:251], v7 offset:31488
    v_mfma_f32_16x16x32_bf16 v[88:91], v[212:215], v[168:171], v[88:91]
    ds_read_b128 v[252:255], v26 offset:0
    v_mfma_f32_16x16x32_bf16 v[68:71], v[216:219], v[160:163], v[68:71]
    ds_read_b64_tr_b16 v[192:193], v8 offset:30720
    v_mfma_f32_16x16x32_bf16 v[80:83], v[216:219], v[164:167], v[80:83]
    ds_read_b64_tr_b16 v[194:195], v8 offset:31488
    v_mfma_f32_16x16x32_bf16 v[92:95], v[216:219], v[168:171], v[92:95]
    ds_read_b64_tr_b16 v[196:197], v6 offset:36864
    v_mfma_f32_16x16x32_bf16 v[72:75], v[220:223], v[160:163], v[72:75]
    ds_read_b64_tr_b16 v[198:199], v6 offset:37632
    v_mfma_f32_16x16x32_bf16 v[84:87], v[220:223], v[164:167], v[84:87]
    ds_read_b128 v[148:151], v27 offset:3840
    v_mfma_f32_16x16x32_bf16 v[96:99], v[220:223], v[168:171], v[96:99]
    ds_read_b64_tr_b16 v[200:201], v7 offset:36864
    v_mfma_f32_16x16x32_bf16 v[76:79], v[224:227], v[168:171], v[76:79]
    ds_read_b64_tr_b16 v[202:203], v7 offset:37632
    v_mfma_f32_16x16x32_bf16 v[88:91], v[224:227], v[172:175], v[88:91]
    ds_read_b64_tr_b16 v[176:177], v8 offset:36864
    s_waitcnt lgkmcnt(8)
    v_mfma_f32_16x16x32_bf16 v[68:71], v[228:231], v[164:167], v[68:71]
    ds_read_b64_tr_b16 v[178:179], v8 offset:37632
    v_mfma_f32_16x16x32_bf16 v[80:83], v[228:231], v[168:171], v[80:83]
    ds_read_b64_tr_b16 v[180:181], v6 offset:43008
    v_mfma_f32_16x16x32_bf16 v[92:95], v[228:231], v[172:175], v[92:95]
    ds_read_b64_tr_b16 v[182:183], v6 offset:43776
    v_mfma_f32_16x16x32_bf16 v[72:75], v[232:235], v[164:167], v[72:75]
    ds_read_b128 v[152:155], v26 offset:5120
    v_mfma_f32_16x16x32_bf16 v[84:87], v[232:235], v[168:171], v[84:87]
    ds_read_b64_tr_b16 v[184:185], v7 offset:43008
    v_mfma_f32_16x16x32_bf16 v[96:99], v[232:235], v[172:175], v[96:99]
    ds_read_b64_tr_b16 v[186:187], v7 offset:43776
    v_mfma_f32_16x16x32_bf16 v[76:79], v[236:239], v[240:243], v[76:79]
    ds_read_b64_tr_b16 v[188:189], v8 offset:43008
    v_mfma_f32_16x16x32_bf16 v[88:91], v[236:239], v[244:247], v[88:91]
    ds_read_b64_tr_b16 v[190:191], v8 offset:43776
    v_mfma_f32_16x16x32_bf16 v[68:71], v[248:251], v[252:255], v[68:71]
    ds_read_b64_tr_b16 v[204:205], v6 offset:49152
    v_mfma_f32_16x16x32_bf16 v[80:83], v[248:251], v[240:243], v[80:83]
    ds_read_b64_tr_b16 v[206:207], v6 offset:49920
    v_mfma_f32_16x16x32_bf16 v[92:95], v[248:251], v[244:247], v[92:95]
    ds_read_b128 v[156:159], v27 offset:6400
    s_waitcnt lgkmcnt(8)
    v_mfma_f32_16x16x32_bf16 v[72:75], v[192:195], v[252:255], v[72:75]
    ds_read_b64_tr_b16 v[208:209], v7 offset:49152
    v_mfma_f32_16x16x32_bf16 v[84:87], v[192:195], v[240:243], v[84:87]
    ds_read_b64_tr_b16 v[210:211], v7 offset:49920
    v_mfma_f32_16x16x32_bf16 v[96:99], v[192:195], v[244:247], v[96:99]
    ds_read_b64_tr_b16 v[212:213], v8 offset:49152
    v_mfma_f32_16x16x32_bf16 v[76:79], v[196:199], v[244:247], v[76:79]
    ds_read_b64_tr_b16 v[214:215], v8 offset:49920
    v_mfma_f32_16x16x32_bf16 v[88:91], v[196:199], v[148:151], v[88:91]
    ds_read_b64_tr_b16 v[216:217], v6 offset:55296
    v_mfma_f32_16x16x32_bf16 v[68:71], v[200:203], v[240:243], v[68:71]
    ds_read_b64_tr_b16 v[218:219], v6 offset:56064
    v_mfma_f32_16x16x32_bf16 v[80:83], v[200:203], v[244:247], v[80:83]
    ds_read_b128 v[160:163], v26 offset:7680
    v_mfma_f32_16x16x32_bf16 v[92:95], v[200:203], v[148:151], v[92:95]
    ds_read_b64_tr_b16 v[220:221], v7 offset:55296
    v_mfma_f32_16x16x32_bf16 v[72:75], v[176:179], v[240:243], v[72:75]
    ds_read_b64_tr_b16 v[222:223], v7 offset:56064
    v_mfma_f32_16x16x32_bf16 v[84:87], v[176:179], v[244:247], v[84:87]
    ds_read_b64_tr_b16 v[224:225], v8 offset:55296
    v_mfma_f32_16x16x32_bf16 v[96:99], v[176:179], v[148:151], v[96:99]
    ds_read_b64_tr_b16 v[226:227], v8 offset:56064
    v_mfma_f32_16x16x32_bf16 v[76:79], v[180:183], v[148:151], v[76:79]
    s_waitcnt lgkmcnt(7)
    v_mfma_f32_16x16x32_bf16 v[88:91], v[180:183], v[152:155], v[88:91]
    v_mfma_f32_16x16x32_bf16 v[68:71], v[184:187], v[244:247], v[68:71]
    ds_read_b128 v[228:231], v27 offset:8960
    v_mfma_f32_16x16x32_bf16 v[80:83], v[184:187], v[148:151], v[80:83]
    v_mfma_f32_16x16x32_bf16 v[92:95], v[184:187], v[152:155], v[92:95]
    v_mfma_f32_16x16x32_bf16 v[72:75], v[188:191], v[244:247], v[72:75]
    v_mfma_f32_16x16x32_bf16 v[84:87], v[188:191], v[148:151], v[84:87]
    v_mfma_f32_16x16x32_bf16 v[96:99], v[188:191], v[152:155], v[96:99]
    v_mfma_f32_16x16x32_bf16 v[76:79], v[204:207], v[152:155], v[76:79]
    ds_read_b128 v[164:167], v26 offset:10240
    v_mfma_f32_16x16x32_bf16 v[88:91], v[204:207], v[156:159], v[88:91]
    v_mfma_f32_16x16x32_bf16 v[68:71], v[208:211], v[148:151], v[68:71]
    v_mfma_f32_16x16x32_bf16 v[80:83], v[208:211], v[152:155], v[80:83]
    v_mfma_f32_16x16x32_bf16 v[92:95], v[208:211], v[156:159], v[92:95]
    v_mfma_f32_16x16x32_bf16 v[72:75], v[212:215], v[148:151], v[72:75]
    ds_read_b64_tr_b16 v[168:169], v6 offset:0
    ds_read_b64_tr_b16 v[170:171], v6 offset:768
    v_mfma_f32_16x16x32_bf16 v[84:87], v[212:215], v[152:155], v[84:87]
    ds_read_b128 v[172:175], v3 offset:3840
    ds_read_b128 v[232:235], v2 offset:5120
    v_mfma_f32_16x16x32_bf16 v[96:99], v[212:215], v[156:159], v[96:99]
    ds_read_b64_tr_b16 v[252:253], v7 offset:0
    ds_read_b64_tr_b16 v[254:255], v7 offset:768
    s_waitcnt lgkmcnt(7)
    v_mfma_f32_16x16x32_bf16 v[76:79], v[216:219], v[156:159], v[76:79]
    v_mfma_f32_16x16x32_bf16 v[88:91], v[216:219], v[160:163], v[88:91]
    ds_read_b64_tr_b16 v[240:241], v8 offset:0
    ds_read_b64_tr_b16 v[242:243], v8 offset:768
    v_mfma_f32_16x16x32_bf16 v[68:71], v[220:223], v[152:155], v[68:71]
    v_mfma_f32_16x16x32_bf16 v[80:83], v[220:223], v[156:159], v[80:83]
    ds_read_b64_tr_b16 v[244:245], v6 offset:6144
    ds_read_b64_tr_b16 v[246:247], v6 offset:6912
    v_mfma_f32_16x16x32_bf16 v[92:95], v[220:223], v[160:163], v[92:95]
    v_mfma_f32_16x16x32_bf16 v[72:75], v[224:227], v[152:155], v[72:75]
    v_mfma_f32_16x16x32_bf16 v[84:87], v[224:227], v[156:159], v[84:87]
    v_mfma_f32_16x16x32_bf16 v[96:99], v[224:227], v[160:163], v[96:99]
    v_mfma_f32_16x16x32_bf16 v[100:103], v[236:239], v[148:151], v[100:103]
    v_cvt_pk_bf16_f32 v76, v76, v77
    v_cvt_pk_bf16_f32 v77, v78, v79
    v_mfma_f32_16x16x32_bf16 v[112:115], v[236:239], v[152:155], v[112:115]
    ds_write_b64 v20, v[76:77] offset:3072
    v_cvt_pk_bf16_f32 v88, v88, v89
    v_mfma_f32_16x16x32_bf16 v[104:107], v[248:251], v[148:151], v[104:107]
    v_cvt_pk_bf16_f32 v89, v90, v91
    ds_write_b64 v20, v[88:89] offset:6144
    v_mfma_f32_16x16x32_bf16 v[116:119], v[248:251], v[152:155], v[116:119]
    v_cvt_pk_bf16_f32 v68, v68, v69
    v_cvt_pk_bf16_f32 v69, v70, v71
    v_mfma_f32_16x16x32_bf16 v[108:111], v[192:195], v[148:151], v[108:111]
    ds_write_b64 v20, v[68:69] offset:64
    v_mfma_f32_16x16x32_bf16 v[120:123], v[192:195], v[152:155], v[120:123]
    v_cvt_pk_bf16_f32 v80, v80, v81
    v_mfma_f32_16x16x32_bf16 v[100:103], v[196:199], v[152:155], v[100:103]
    v_cvt_pk_bf16_f32 v81, v82, v83
    v_mfma_f32_16x16x32_bf16 v[112:115], v[196:199], v[156:159], v[112:115]
    ds_write_b64 v20, v[80:81] offset:3136
    v_mfma_f32_16x16x32_bf16 v[104:107], v[200:203], v[152:155], v[104:107]
    v_cvt_pk_bf16_f32 v92, v92, v93
    v_mfma_f32_16x16x32_bf16 v[116:119], v[200:203], v[156:159], v[116:119]
    v_cvt_pk_bf16_f32 v93, v94, v95
    v_mfma_f32_16x16x32_bf16 v[108:111], v[176:179], v[152:155], v[108:111]
    ds_write_b64 v20, v[92:93] offset:6208
    v_mfma_f32_16x16x32_bf16 v[120:123], v[176:179], v[156:159], v[120:123]
    v_cvt_pk_bf16_f32 v72, v72, v73
    v_mfma_f32_16x16x32_bf16 v[100:103], v[180:183], v[156:159], v[100:103]
    v_cvt_pk_bf16_f32 v73, v74, v75
    v_mfma_f32_16x16x32_bf16 v[112:115], v[180:183], v[160:163], v[112:115]
    ds_write_b64 v20, v[72:73] offset:128
    v_mfma_f32_16x16x32_bf16 v[104:107], v[184:187], v[156:159], v[104:107]
    v_cvt_pk_bf16_f32 v84, v84, v85
    v_mfma_f32_16x16x32_bf16 v[116:119], v[184:187], v[160:163], v[116:119]
    v_cvt_pk_bf16_f32 v85, v86, v87
    v_mfma_f32_16x16x32_bf16 v[108:111], v[188:191], v[156:159], v[108:111]
    ds_read_b128 v[236:239], v3 offset:6400
    v_mfma_f32_16x16x32_bf16 v[120:123], v[188:191], v[160:163], v[120:123]
    ds_write_b64 v20, v[84:85] offset:3200
    v_mfma_f32_16x16x32_bf16 v[100:103], v[204:207], v[160:163], v[100:103]
    ds_read_b64_tr_b16 v[248:249], v7 offset:6144
    v_mfma_f32_16x16x32_bf16 v[112:115], v[204:207], v[228:231], v[112:115]
    ds_read_b64_tr_b16 v[250:251], v7 offset:6912
    v_mfma_f32_16x16x32_bf16 v[104:107], v[208:211], v[160:163], v[104:107]
    v_cvt_pk_bf16_f32 v96, v96, v97
    v_mfma_f32_16x16x32_bf16 v[116:119], v[208:211], v[228:231], v[116:119]
    v_cvt_pk_bf16_f32 v97, v98, v99
    v_mfma_f32_16x16x32_bf16 v[108:111], v[212:215], v[160:163], v[108:111]
    ds_read_b64_tr_b16 v[148:149], v8 offset:6144
    v_mfma_f32_16x16x32_bf16 v[120:123], v[212:215], v[228:231], v[120:123]
    ds_read_b64_tr_b16 v[150:151], v8 offset:6912
    v_mfma_f32_16x16x32_bf16 v[100:103], v[216:219], v[228:231], v[100:103]
    ds_write_b64 v20, v[96:97] offset:6272
    s_waitcnt lgkmcnt(6)
    v_mfma_f32_16x16x32_bf16 v[112:115], v[216:219], v[164:167], v[112:115]
    ds_read_b64_tr_b16 v[192:193], v6 offset:12288
    v_mfma_f32_16x16x32_bf16 v[104:107], v[220:223], v[228:231], v[104:107]
    ds_read_b64_tr_b16 v[194:195], v6 offset:13056
    v_mfma_f32_16x16x32_bf16 v[116:119], v[220:223], v[164:167], v[116:119]
    ds_read_b128 v[196:199], v2 offset:7680
    v_mfma_f32_16x16x32_bf16 v[108:111], v[224:227], v[228:231], v[108:111]
    ds_read_b64_tr_b16 v[200:201], v7 offset:12288
    v_mfma_f32_16x16x32_bf16 v[120:123], v[224:227], v[164:167], v[120:123]
    ds_read_b64_tr_b16 v[202:203], v7 offset:13056
    v_mfma_f32_16x16x32_bf16 v[100:103], v[168:171], v[172:175], v[100:103]
    ds_read_b64_tr_b16 v[152:153], v8 offset:12288
    v_mfma_f32_16x16x32_bf16 v[112:115], v[168:171], v[232:235], v[112:115]
    ds_read_b64_tr_b16 v[154:155], v8 offset:13056
    v_mfma_f32_16x16x32_bf16 v[104:107], v[252:255], v[172:175], v[104:107]
    ds_read_b64_tr_b16 v[176:177], v6 offset:18432
    v_mfma_f32_16x16x32_bf16 v[116:119], v[252:255], v[232:235], v[116:119]
    ds_read_b64_tr_b16 v[178:179], v6 offset:19200
    v_mfma_f32_16x16x32_bf16 v[108:111], v[240:243], v[172:175], v[108:111]
    s_waitcnt lgkmcnt(9)
    s_barrier
    ds_read_b128 v[180:183], v3 offset:8960
    v_mfma_f32_16x16x32_bf16 v[120:123], v[240:243], v[232:235], v[120:123]
    ds_read_b64_tr_b16 v[184:185], v7 offset:18432
    v_mfma_f32_16x16x32_bf16 v[100:103], v[244:247], v[232:235], v[100:103]
    ds_read_b64_tr_b16 v[186:187], v7 offset:19200
    v_mfma_f32_16x16x32_bf16 v[112:115], v[244:247], v[236:239], v[112:115]
    ds_read_b64_tr_b16 v[156:157], v8 offset:18432
    v_mfma_f32_16x16x32_bf16 v[104:107], v[248:251], v[232:235], v[104:107]
    ds_read_b64_tr_b16 v[158:159], v8 offset:19200
    v_mfma_f32_16x16x32_bf16 v[116:119], v[248:251], v[236:239], v[116:119]
    ds_read_b64_tr_b16 v[188:189], v6 offset:24576
    v_mfma_f32_16x16x32_bf16 v[108:111], v[148:151], v[232:235], v[108:111]
    ds_read_b64_tr_b16 v[190:191], v6 offset:25344
    v_mfma_f32_16x16x32_bf16 v[120:123], v[148:151], v[236:239], v[120:123]
    ds_read_b128 v[204:207], v2 offset:10240
    s_waitcnt lgkmcnt(8)
    v_mfma_f32_16x16x32_bf16 v[100:103], v[192:195], v[236:239], v[100:103]
    ds_read_b64_tr_b16 v[208:209], v7 offset:24576
    ds_read_b64_tr_b16 v[210:211], v7 offset:25344
    v_mfma_f32_16x16x32_bf16 v[112:115], v[192:195], v[196:199], v[112:115]
    ds_read_b64_tr_b16 v[160:161], v8 offset:24576
    v_mfma_f32_16x16x32_bf16 v[104:107], v[200:203], v[236:239], v[104:107]
    ds_read_b64_tr_b16 v[162:163], v8 offset:25344
    v_mfma_f32_16x16x32_bf16 v[116:119], v[200:203], v[196:199], v[116:119]
    ds_read_b128 v[212:215], v3 offset:11520
    v_mfma_f32_16x16x32_bf16 v[108:111], v[152:155], v[236:239], v[108:111]
    ds_read_b128 v[216:219], v2 offset:12800
    v_mfma_f32_16x16x32_bf16 v[120:123], v[152:155], v[196:199], v[120:123]
    ds_read_b64_tr_b16 v[220:221], v6 offset:30720
    v_mfma_f32_16x16x32_bf16 v[100:103], v[176:179], v[196:199], v[100:103]
    ds_read_b64_tr_b16 v[222:223], v6 offset:31488
    s_waitcnt lgkmcnt(9)
    v_mfma_f32_16x16x32_bf16 v[112:115], v[176:179], v[180:183], v[112:115]
    ds_read_b128 v[228:231], v27 offset:6400
    v_mfma_f32_16x16x32_bf16 v[104:107], v[184:187], v[196:199], v[104:107]
    ds_read_b128 v[164:167], v26 offset:7680
    v_mfma_f32_16x16x32_bf16 v[116:119], v[184:187], v[180:183], v[116:119]
    ds_read_b64_tr_b16 v[224:225], v7 offset:30720
    v_mfma_f32_16x16x32_bf16 v[108:111], v[156:159], v[196:199], v[108:111]
    ds_read_b64_tr_b16 v[226:227], v7 offset:31488
    v_mfma_f32_16x16x32_bf16 v[120:123], v[156:159], v[180:183], v[120:123]
    ds_read_b64_tr_b16 v[172:173], v8 offset:30720
    v_mfma_f32_16x16x32_bf16 v[100:103], v[188:191], v[180:183], v[100:103]
    ds_read_b64_tr_b16 v[174:175], v8 offset:31488
    s_waitcnt lgkmcnt(8)
    v_mfma_f32_16x16x32_bf16 v[112:115], v[188:191], v[204:207], v[112:115]
    ds_read_b64_tr_b16 v[232:233], v6 offset:36864
    v_mfma_f32_16x16x32_bf16 v[104:107], v[208:211], v[180:183], v[104:107]
    ds_read_b64_tr_b16 v[234:235], v6 offset:37632
    v_mfma_f32_16x16x32_bf16 v[116:119], v[208:211], v[204:207], v[116:119]
    v_mfma_f32_16x16x32_bf16 v[108:111], v[160:163], v[180:183], v[108:111]
    v_mfma_f32_16x16x32_bf16 v[120:123], v[160:163], v[204:207], v[120:123]
    v_mfma_f32_16x16x32_bf16 v[124:127], v[168:171], v[236:239], v[124:127]
    v_mfma_f32_16x16x32_bf16 v[136:139], v[168:171], v[196:199], v[136:139]
    ds_read_b128 v[168:171], v27 offset:8960
    v_mfma_f32_16x16x32_bf16 v[128:131], v[252:255], v[236:239], v[128:131]
    v_cvt_pk_bf16_f32 v100, v100, v101
    v_cvt_pk_bf16_f32 v101, v102, v103
    v_mfma_f32_16x16x32_bf16 v[140:143], v[252:255], v[196:199], v[140:143]
    ds_write_b64 v20, v[100:101] offset:9216
    v_cvt_pk_bf16_f32 v112, v112, v113
    v_mfma_f32_16x16x32_bf16 v[132:135], v[240:243], v[236:239], v[132:135]
    v_cvt_pk_bf16_f32 v113, v114, v115
    ds_write_b64 v20, v[112:113] offset:12288
    v_mfma_f32_16x16x32_bf16 v[124:127], v[244:247], v[196:199], v[124:127]
    v_cvt_pk_bf16_f32 v104, v104, v105
    v_mfma_f32_16x16x32_bf16 v[136:139], v[244:247], v[180:183], v[136:139]
    v_cvt_pk_bf16_f32 v105, v106, v107
    v_mfma_f32_16x16x32_bf16 v[128:131], v[248:251], v[196:199], v[128:131]
    ds_write_b64 v20, v[104:105] offset:9280
    v_mfma_f32_16x16x32_bf16 v[140:143], v[248:251], v[180:183], v[140:143]
    v_cvt_pk_bf16_f32 v116, v116, v117
    v_mfma_f32_16x16x32_bf16 v[132:135], v[148:151], v[196:199], v[132:135]
    v_cvt_pk_bf16_f32 v117, v118, v119
    v_mfma_f32_16x16x32_bf16 v[124:127], v[192:195], v[180:183], v[124:127]
    ds_write_b64 v20, v[116:117] offset:12352
    v_mfma_f32_16x16x32_bf16 v[136:139], v[192:195], v[204:207], v[136:139]
    v_cvt_pk_bf16_f32 v108, v108, v109
    v_mfma_f32_16x16x32_bf16 v[128:131], v[200:203], v[180:183], v[128:131]
    v_cvt_pk_bf16_f32 v109, v110, v111
    v_mfma_f32_16x16x32_bf16 v[140:143], v[200:203], v[204:207], v[140:143]
    ds_write_b64 v20, v[108:109] offset:9344
    v_mfma_f32_16x16x32_bf16 v[132:135], v[152:155], v[180:183], v[132:135]
    ds_read_b64_tr_b16 v[252:253], v7 offset:36864
    v_mfma_f32_16x16x32_bf16 v[124:127], v[176:179], v[204:207], v[124:127]
    ds_read_b64_tr_b16 v[254:255], v7 offset:37632
    v_mfma_f32_16x16x32_bf16 v[136:139], v[176:179], v[212:215], v[136:139]
    v_cvt_pk_bf16_f32 v120, v120, v121
    v_mfma_f32_16x16x32_bf16 v[128:131], v[184:187], v[204:207], v[128:131]
    v_cvt_pk_bf16_f32 v121, v122, v123
    v_mfma_f32_16x16x32_bf16 v[140:143], v[184:187], v[212:215], v[140:143]
    ds_read_b64_tr_b16 v[236:237], v8 offset:36864
    v_mfma_f32_16x16x32_bf16 v[132:135], v[156:159], v[204:207], v[132:135]
    ds_read_b64_tr_b16 v[238:239], v8 offset:37632
    v_mfma_f32_16x16x32_bf16 v[124:127], v[188:191], v[212:215], v[124:127]
    ds_write_b64 v20, v[120:121] offset:12416
    v_mfma_f32_16x16x32_bf16 v[136:139], v[188:191], v[216:219], v[136:139]
    ds_read_b64_tr_b16 v[240:241], v6 offset:43008
    ds_read_b64_tr_b16 v[242:243], v6 offset:43776
    v_mfma_f32_16x16x32_bf16 v[128:131], v[208:211], v[212:215], v[128:131]
    ds_read_b128 v[244:247], v26 offset:10240
    v_mfma_f32_16x16x32_bf16 v[140:143], v[208:211], v[216:219], v[140:143]
    ds_read_b64_tr_b16 v[248:249], v7 offset:43008
    ds_read_b64_tr_b16 v[250:251], v7 offset:43776
    v_mfma_f32_16x16x32_bf16 v[132:135], v[160:163], v[212:215], v[132:135]
    ds_read_b64_tr_b16 v[148:149], v8 offset:43008
    s_waitcnt lgkmcnt(9)
    v_mfma_f32_16x16x32_bf16 v[124:127], v[220:223], v[228:231], v[124:127]
    ds_read_b64_tr_b16 v[150:151], v8 offset:43776
    v_mfma_f32_16x16x32_bf16 v[136:139], v[220:223], v[164:167], v[136:139]
    ds_read_b64_tr_b16 v[196:197], v6 offset:49152
    ds_read_b64_tr_b16 v[198:199], v6 offset:49920
    v_mfma_f32_16x16x32_bf16 v[128:131], v[224:227], v[228:231], v[128:131]
    ds_read_b128 v[192:195], v27 offset:11520
    v_mfma_f32_16x16x32_bf16 v[140:143], v[224:227], v[164:167], v[140:143]
    s_waitcnt lgkmcnt(10)
    s_barrier
    ds_read_b64_tr_b16 v[200:201], v7 offset:49152
    v_mfma_f32_16x16x32_bf16 v[132:135], v[172:175], v[228:231], v[132:135]
    ds_read_b64_tr_b16 v[202:203], v7 offset:49920
    v_mfma_f32_16x16x32_bf16 v[124:127], v[232:235], v[164:167], v[124:127]
    ds_read_b64_tr_b16 v[152:153], v8 offset:49152
    ds_read_b64_tr_b16 v[154:155], v8 offset:49920
    v_mfma_f32_16x16x32_bf16 v[136:139], v[232:235], v[168:171], v[136:139]
    ds_read_b64_tr_b16 v[180:181], v6 offset:55296
    ds_read_b64_tr_b16 v[182:183], v6 offset:56064
    v_mfma_f32_16x16x32_bf16 v[128:131], v[252:255], v[164:167], v[128:131]
    ds_read_b128 v[176:179], v26 offset:12800
    v_mfma_f32_16x16x32_bf16 v[140:143], v[252:255], v[168:171], v[140:143]
    ds_read_b64_tr_b16 v[184:185], v7 offset:55296
    ds_read_b64_tr_b16 v[186:187], v7 offset:56064
    v_mfma_f32_16x16x32_bf16 v[132:135], v[236:239], v[164:167], v[132:135]
    ds_read_b64_tr_b16 v[156:157], v8 offset:55296
    s_waitcnt lgkmcnt(11)
    v_mfma_f32_16x16x32_bf16 v[124:127], v[240:243], v[168:171], v[124:127]
    ds_read_b64_tr_b16 v[158:159], v8 offset:56064
    v_mfma_f32_16x16x32_bf16 v[136:139], v[240:243], v[244:247], v[136:139]
    v_mfma_f32_16x16x32_bf16 v[128:131], v[248:251], v[168:171], v[128:131]
    v_mfma_f32_16x16x32_bf16 v[140:143], v[248:251], v[244:247], v[140:143]
    v_mfma_f32_16x16x32_bf16 v[132:135], v[148:151], v[168:171], v[132:135]
    v_mfma_f32_16x16x32_bf16 v[124:127], v[196:199], v[244:247], v[124:127]
    s_waitcnt lgkmcnt(4)
    v_mfma_f32_16x16x32_bf16 v[136:139], v[196:199], v[192:195], v[136:139]
    v_mfma_f32_16x16x32_bf16 v[128:131], v[200:203], v[244:247], v[128:131]
    v_mfma_f32_16x16x32_bf16 v[140:143], v[200:203], v[192:195], v[140:143]
    v_mfma_f32_16x16x32_bf16 v[132:135], v[152:155], v[244:247], v[132:135]
    v_mfma_f32_16x16x32_bf16 v[124:127], v[180:183], v[192:195], v[124:127]
    v_mfma_f32_16x16x32_bf16 v[136:139], v[180:183], v[176:179], v[136:139]
    s_waitcnt lgkmcnt(0)
    v_mfma_f32_16x16x32_bf16 v[128:131], v[184:187], v[192:195], v[128:131]
    v_mfma_f32_16x16x32_bf16 v[140:143], v[184:187], v[176:179], v[140:143]
    v_mfma_f32_16x16x32_bf16 v[132:135], v[156:159], v[192:195], v[132:135]
    s_nop 7
    v_cvt_pk_bf16_f32 v124, v124, v125
    v_cvt_pk_bf16_f32 v125, v126, v127
    ds_write_b64 v20, v[124:125] offset:15360
    v_cvt_pk_bf16_f32 v136, v136, v137
    v_cvt_pk_bf16_f32 v137, v138, v139
    ds_write_b64 v20, v[136:137] offset:18432
    v_cvt_pk_bf16_f32 v128, v128, v129
    v_cvt_pk_bf16_f32 v129, v130, v131
    ds_write_b64 v20, v[128:129] offset:15424
    v_cvt_pk_bf16_f32 v140, v140, v141
    v_cvt_pk_bf16_f32 v141, v142, v143
    ds_write_b64 v20, v[140:141] offset:18496
    v_cvt_pk_bf16_f32 v132, v132, v133
    v_cvt_pk_bf16_f32 v133, v134, v135
    ds_write_b64 v20, v[132:133] offset:15488
    s_waitcnt lgkmcnt(0)
    s_barrier
    s_branch L_store
L_cls2:
    s_waitcnt lgkmcnt(0)
    v_and_b32 v15, 15, v1
    v_lshrrev_b32 v17, 4, v1
    v_bfe_u32 v18, v1, 2, 2
    v_lshl_add_u32 v18, v17, 3, v18
    v_mul_u32_u24 v18, 192, v18
    v_and_b32 v19, 3, v1
    v_lshl_add_u32 v18, v19, 3, v18
    v_add_u32 v18, 69120, v18
    v_and_b32 v19, 1, v17
    v_lshlrev_b32 v19, 5, v19
    s_lshl_b32 s20, s17, 5
    s_add_u32 s21, s20, 64
    s_add_u32 s22, s20, 128
    v_xor_b32 v6, s20, v19
    v_add_u32 v6, v6, v18
    v_xor_b32 v7, s21, v19
    v_add_u32 v7, v7, v18
    v_xor_b32 v8, s22, v19
    v_add_u32 v8, v8, v18
    s_and_b32 s3, s18, 1
    s_lshl_b32 s3, s3, 1
    v_xor_b32 v16, s3, v17
    s_mul_i32 s25, s18, 1280
    v_lshrrev_b32 v18, 1, v15
    v_and_b32 v18, 2, v18
    v_xor_b32 v18, v18, v16
    v_lshlrev_b32 v18, 4, v18
    v_lshl_add_u32 v18, v15, 6, v18
    v_add_u32 v4, s25, v18
    v_xor_b32 v5, 32, v4
    s_barrier
    ds_read_b64_tr_b16 v[200:201], v8 offset:0
    ds_read_b64_tr_b16 v[202:203], v8 offset:768
    ds_read_b128 v[148:151], v4 offset:0
    ds_read_b64_tr_b16 v[192:193], v6 offset:0
    ds_read_b64_tr_b16 v[194:195], v6 offset:768
    ds_read_b64_tr_b16 v[196:197], v7 offset:0
    ds_read_b64_tr_b16 v[198:199], v7 offset:768
    s_waitcnt lgkmcnt(4)
    v_mfma_f32_16x16x32_bf16 v[72:75], v[200:203], v[148:151], 0
    v_add_u32 v19, 1, v15
    v_lshrrev_b32 v18, 1, v19
    v_and_b32 v18, 2, v18
    v_xor_b32 v18, v18, v16
    v_lshlrev_b32 v18, 4, v18
    v_lshl_add_u32 v18, v19, 6, v18
    v_add_u32 v2, s25, v18
    v_xor_b32 v3, 32, v2
    v_lshrrev_b32 v18, 1, v17
    s_lshl_b32 s3, s17, 1
    v_add_u32 v18, s3, v18
    v_bfe_u32 v19, v15, 1, 2
    s_barrier
    ds_read_b128 v[152:155], v5 offset:1280
    ds_read_b64_tr_b16 v[204:205], v8 offset:6144
    ds_read_b64_tr_b16 v[206:207], v8 offset:6912
    ds_read_b64_tr_b16 v[208:209], v6 offset:6144
    ds_read_b64_tr_b16 v[210:211], v6 offset:6912
    s_waitcnt lgkmcnt(4)
    v_mfma_f32_16x16x32_bf16 v[76:79], v[192:195], v[152:155], 0
    ds_read_b64_tr_b16 v[212:213], v7 offset:6144
    ds_read_b64_tr_b16 v[214:215], v7 offset:6912
    v_mfma_f32_16x16x32_bf16 v[80:83], v[196:199], v[152:155], 0
    v_mfma_f32_16x16x32_bf16 v[84:87], v[200:203], v[152:155], 0
    s_waitcnt lgkmcnt(4)
    v_mfma_f32_16x16x32_bf16 v[72:75], v[204:207], v[152:155], v[72:75]
    v_xor_b32 v18, v18, v19
    v_mul_u32_u24 v20, 192, v15
    v_lshl_add_u32 v20, v18, 4, v20
    v_and_b32 v19, 1, v17
    v_lshl_add_u32 v20, v19, 3, v20
    s_mul_i32 s3, s18, 3072
    v_add_u32 v20, s3, v20
    s_mov_b32 s24, 1
    s_mov_b32 s26, 30720
    s_mov_b32 s27, 1
    s_add_u32 s23, s25, 46080
    v_add_u32 v19, 4, v15
    s_barrier
    ds_read_b128 v[156:159], v4 offset:2560
    ds_read_b64_tr_b16 v[216:217], v8 offset:12288
    ds_read_b64_tr_b16 v[218:219], v8 offset:13056
    s_waitcnt lgkmcnt(2)
    v_mfma_f32_16x16x32_bf16 v[88:91], v[192:195], v[156:159], 0
    ds_read_b64_tr_b16 v[220:221], v6 offset:12288
    ds_read_b64_tr_b16 v[222:223], v6 offset:13056
    v_mfma_f32_16x16x32_bf16 v[92:95], v[196:199], v[156:159], 0
    ds_read_b64_tr_b16 v[224:225], v7 offset:12288
    ds_read_b64_tr_b16 v[226:227], v7 offset:13056
    v_mfma_f32_16x16x32_bf16 v[96:99], v[200:203], v[156:159], 0
    v_mfma_f32_16x16x32_bf16 v[76:79], v[208:211], v[156:159], v[76:79]
    v_mfma_f32_16x16x32_bf16 v[80:83], v[212:215], v[156:159], v[80:83]
    v_mfma_f32_16x16x32_bf16 v[84:87], v[204:207], v[156:159], v[84:87]
    s_waitcnt lgkmcnt(4)
    v_mfma_f32_16x16x32_bf16 v[72:75], v[216:219], v[156:159], v[72:75]
    v_lshrrev_b32 v18, 1, v19
    v_and_b32 v18, 2, v18
    v_xor_b32 v18, v18, v16
    v_lshlrev_b32 v18, 4, v18
    v_lshl_add_u32 v18, v19, 6, v18
    v_add_u32 v26, s23, v18
    v_xor_b32 v27, 32, v26
    v_lshlrev_b32 v46, 4, v1
    v_add_u32 v47, 0, v1
    v_mul_u32_u24 v48, 5462, v47
    v_lshrrev_b32 v48, 16, v48
    v_mul_u32_u24 v49, 12, v48
    s_barrier
    ds_read_b128 v[160:163], v5 offset:3840
    ds_read_b64_tr_b16 v[228:229], v8 offset:18432
    s_waitcnt lgkmcnt(1)
    v_mfma_f32_16x16x32_bf16 v[100:103], v[192:195], v[160:163], 0
    ds_read_b64_tr_b16 v[230:231], v8 offset:19200
    ds_read_b64_tr_b16 v[232:233], v6 offset:18432
    v_mfma_f32_16x16x32_bf16 v[104:107], v[196:199], v[160:163], 0
    ds_read_b64_tr_b16 v[234:235], v6 offset:19200
    ds_read_b64_tr_b16 v[236:237], v7 offset:18432
    v_mfma_f32_16x16x32_bf16 v[108:111], v[200:203], v[160:163], 0
    v_sub_u32 v49, v47, v49
    v_lshrrev_b32 v43, 2, v49
    v_bfe_u32 v50, v48, 1, 2
    v_xor_b32 v50, v50, v49
    v_and_b32 v50, 3, v50
    v_and_b32 v49, 12, v49
    v_or_b32 v49, v49, v50
    v_mul_u32_u24 v48, 192, v48
    v_lshl_add_u32 v40, v49, 4, v48
    v_add_u32 v47, 64, v1
    v_mul_u32_u24 v48, 5462, v47
    v_lshrrev_b32 v48, 16, v48
    s_barrier
    ds_read_b128 v[164:167], v4 offset:5120
    v_mfma_f32_16x16x32_bf16 v[88:91], v[208:211], v[160:163], v[88:91]
    ds_read_b64_tr_b16 v[238:239], v7 offset:19200
    ds_read_b64_tr_b16 v[240:241], v8 offset:24576
    v_mfma_f32_16x16x32_bf16 v[92:95], v[212:215], v[160:163], v[92:95]
    ds_read_b64_tr_b16 v[242:243], v8 offset:25344
    v_mfma_f32_16x16x32_bf16 v[96:99], v[204:207], v[160:163], v[96:99]
    ds_read_b64_tr_b16 v[244:245], v6 offset:24576
    v_mfma_f32_16x16x32_bf16 v[76:79], v[220:223], v[160:163], v[76:79]
    ds_read_b64_tr_b16 v[246:247], v6 offset:25344
    v_mfma_f32_16x16x32_bf16 v[80:83], v[224:227], v[160:163], v[80:83]
    ds_read_b64_tr_b16 v[248:249], v7 offset:24576
    v_mfma_f32_16x16x32_bf16 v[84:87], v[216:219], v[160:163], v[84:87]
    ds_read_b64_tr_b16 v[250:251], v7 offset:25344
    s_waitcnt lgkmcnt(10)
    v_mfma_f32_16x16x32_bf16 v[72:75], v[228:231], v[160:163], v[72:75]
    s_waitcnt lgkmcnt(7)
    v_mfma_f32_16x16x32_bf16 v[112:115], v[192:195], v[164:167], 0
    v_mfma_f32_16x16x32_bf16 v[116:119], v[196:199], v[164:167], 0
    v_mfma_f32_16x16x32_bf16 v[120:123], v[200:203], v[164:167], 0
    v_mfma_f32_16x16x32_bf16 v[100:103], v[208:211], v[164:167], v[100:103]
    v_mfma_f32_16x16x32_bf16 v[104:107], v[212:215], v[164:167], v[104:107]
    v_mfma_f32_16x16x32_bf16 v[108:111], v[204:207], v[164:167], v[108:111]
    v_mul_u32_u24 v49, 12, v48
    v_sub_u32 v49, v47, v49
    v_lshrrev_b32 v44, 2, v49
    v_bfe_u32 v50, v48, 1, 2
    v_xor_b32 v50, v50, v49
    v_and_b32 v50, 3, v50
    v_and_b32 v49, 12, v49
    v_or_b32 v49, v49, v50
    v_mul_u32_u24 v48, 192, v48
    v_lshl_add_u32 v41, v49, 4, v48
    v_add_u32 v47, 128, v1
    v_mul_u32_u24 v48, 5462, v47
    s_barrier
    ds_read_b128 v[168:171], v5 offset:6400
    v_mfma_f32_16x16x32_bf16 v[88:91], v[220:223], v[164:167], v[88:91]
    v_mfma_f32_16x16x32_bf16 v[92:95], v[224:227], v[164:167], v[92:95]
    v_mfma_f32_16x16x32_bf16 v[96:99], v[216:219], v[164:167], v[96:99]
    v_mfma_f32_16x16x32_bf16 v[76:79], v[232:235], v[164:167], v[76:79]
    s_waitcnt lgkmcnt(1)
    v_mfma_f32_16x16x32_bf16 v[80:83], v[236:239], v[164:167], v[80:83]
    v_mfma_f32_16x16x32_bf16 v[84:87], v[228:231], v[164:167], v[84:87]
    v_mfma_f32_16x16x32_bf16 v[72:75], v[240:243], v[164:167], v[72:75]
    s_waitcnt lgkmcnt(0)
    v_mfma_f32_16x16x32_bf16 v[124:127], v[192:195], v[168:171], 0
    v_mfma_f32_16x16x32_bf16 v[128:131], v[196:199], v[168:171], 0
    v_mfma_f32_16x16x32_bf16 v[132:135], v[200:203], v[168:171], 0
    v_mfma_f32_16x16x32_bf16 v[112:115], v[208:211], v[168:171], v[112:115]
    v_mfma_f32_16x16x32_bf16 v[116:119], v[212:215], v[168:171], v[116:119]
    v_mfma_f32_16x16x32_bf16 v[120:123], v[204:207], v[168:171], v[120:123]
    v_mfma_f32_16x16x32_bf16 v[100:103], v[220:223], v[168:171], v[100:103]
    v_mfma_f32_16x16x32_bf16 v[104:107], v[224:227], v[168:171], v[104:107]
    v_lshrrev_b32 v48, 16, v48
    v_mul_u32_u24 v49, 12, v48
    v_sub_u32 v49, v47, v49
    v_lshrrev_b32 v45, 2, v49
    v_bfe_u32 v50, v48, 1, 2
    v_xor_b32 v50, v50, v49
    v_and_b32 v50, 3, v50
    v_and_b32 v49, 12, v49
    v_or_b32 v49, v49, v50
    v_mul_u32_u24 v48, 192, v48
    v_lshl_add_u32 v42, v49, 4, v48
    s_mov_b32 s76, s8
    s_barrier
    ds_read_b128 v[172:175], v4 offset:7680
    v_mfma_f32_16x16x32_bf16 v[108:111], v[216:219], v[168:171], v[108:111]
    s_mov_b32 s77, s9
    s_mov_b32 s78, 9633792
    v_mfma_f32_16x16x32_bf16 v[88:91], v[232:235], v[168:171], v[88:91]
    s_mov_b32 s79, 0x20000
    s_mov_b32 s85, 3088
    v_mfma_f32_16x16x32_bf16 v[92:95], v[236:239], v[168:171], v[92:95]
    s_cmp_eq_u32 s14, 1
    s_cselect_b32 s85, 3330, s85
    v_mfma_f32_16x16x32_bf16 v[96:99], v[228:231], v[168:171], v[96:99]
    s_cmp_eq_u32 s14, 2
    s_cselect_b32 s85, 25377, s85
    v_mfma_f32_16x16x32_bf16 v[76:79], v[244:247], v[168:171], v[76:79]
    ds_read_b128 v[176:179], v5 offset:8960
    s_cmp_eq_u32 s14, 3
    v_mfma_f32_16x16x32_bf16 v[80:83], v[248:251], v[168:171], v[80:83]
    s_cselect_b32 s85, 2576, s85
    s_cmp_eq_u32 s14, 4
    v_mfma_f32_16x16x32_bf16 v[84:87], v[240:243], v[168:171], v[84:87]
    s_cselect_b32 s85, 2818, s85
    s_and_b32 s84, s85, 15
    s_waitcnt lgkmcnt(1)
    v_mfma_f32_16x16x32_bf16 v[136:139], v[192:195], v[172:175], 0
    s_bfe_u32 s86, s85, 0x40004
    s_lshr_b32 s85, s85, 8
    v_mfma_f32_16x16x32_bf16 v[140:143], v[196:199], v[172:175], 0
    s_mov_b32 s87, 4294751828
    s_cmp_eq_u32 s14, 1
    v_mfma_f32_16x16x32_bf16 v[144:147], v[200:203], v[172:175], 0
    s_cselect_b32 s87, 4292654682, s87
    s_cmp_eq_u32 s14, 2
    v_mfma_f32_16x16x32_bf16 v[124:127], v[208:211], v[172:175], v[124:127]
    s_cselect_b32 s87, 4294751834, s87
    ds_read_b128 v[180:183], v4 offset:10240
    v_mfma_f32_16x16x32_bf16 v[128:131], v[212:215], v[172:175], v[128:131]
    s_cmp_eq_u32 s14, 3
    s_cselect_b32 s87, 4294945108, s87
    v_mfma_f32_16x16x32_bf16 v[132:135], v[204:207], v[172:175], v[132:135]
    s_cmp_eq_u32 s14, 4
    s_cselect_b32 s87, 4294949460, s87
    v_mfma_f32_16x16x32_bf16 v[112:115], v[220:223], v[172:175], v[112:115]
    s_lshl_b32 s3, s16, 2
    s_lshr_b32 s87, s87, s3
    v_mfma_f32_16x16x32_bf16 v[116:119], v[224:227], v[172:175], v[116:119]
    s_and_b32 s87, s87, 15
    s_add_u32 s80, s15, s87
    v_mfma_f32_16x16x32_bf16 v[120:123], v[216:219], v[172:175], v[120:123]
    s_mul_i32 s80, s80, 43008
    s_mul_i32 s3, s12, 192
    v_mfma_f32_16x16x32_bf16 v[100:103], v[232:235], v[172:175], v[100:103]
    ds_read_b128 v[184:187], v5 offset:11520
    s_add_u32 s80, s80, s3
    v_mfma_f32_16x16x32_bf16 v[104:107], v[236:239], v[172:175], v[104:107]
    s_mul_i32 s81, s87, 3072
    v_add_u32 v47, s81, v40
    v_mfma_f32_16x16x32_bf16 v[108:111], v[228:231], v[172:175], v[108:111]
    v_add_u32 v48, s81, v41
    v_add_u32 v49, s81, v42
    v_mfma_f32_16x16x32_bf16 v[88:91], v[244:247], v[172:175], v[88:91]
    s_cmp_eq_u32 s87, 0
    ds_read_b128 v[188:191], v4 offset:12800
    v_mfma_f32_16x16x32_bf16 v[92:95], v[248:251], v[172:175], v[92:95]
    s_cselect_b32 s82, s84, 0
    v_mfma_f32_16x16x32_bf16 v[96:99], v[240:243], v[172:175], v[96:99]
    s_cmp_eq_u32 s87, s85
    s_waitcnt lgkmcnt(2)
    v_mfma_f32_16x16x32_bf16 v[136:139], v[208:211], v[176:179], v[136:139]
    s_cselect_b32 s83, s86, 2
    v_mfma_f32_16x16x32_bf16 v[140:143], v[212:215], v[176:179], v[140:143]
    v_cmp_le_u32 vcc, s82, v43
    v_mfma_f32_16x16x32_bf16 v[144:147], v[204:207], v[176:179], v[144:147]
    v_cmp_ge_u32 s[64:65], s83, v43
    v_mfma_f32_16x16x32_bf16 v[124:127], v[220:223], v[176:179], v[124:127]
    s_barrier
    ds_read_b128 v[148:151], v2 offset:0
    v_mfma_f32_16x16x32_bf16 v[128:131], v[224:227], v[176:179], v[128:131]
    ds_read_b128 v[152:155], v3 offset:1280
    v_mfma_f32_16x16x32_bf16 v[132:135], v[216:219], v[176:179], v[132:135]
    ds_read_b128 v[156:159], v2 offset:2560
    v_mfma_f32_16x16x32_bf16 v[112:115], v[232:235], v[176:179], v[112:115]
    ds_read_b64_tr_b16 v[192:193], v6 offset:30720
    v_mfma_f32_16x16x32_bf16 v[116:119], v[236:239], v[176:179], v[116:119]
    ds_read_b64_tr_b16 v[194:195], v6 offset:31488
    v_mfma_f32_16x16x32_bf16 v[120:123], v[228:231], v[176:179], v[120:123]
    ds_read_b128 v[160:163], v3 offset:3840
    v_mfma_f32_16x16x32_bf16 v[100:103], v[244:247], v[176:179], v[100:103]
    ds_read_b64_tr_b16 v[196:197], v7 offset:30720
    v_mfma_f32_16x16x32_bf16 v[104:107], v[248:251], v[176:179], v[104:107]
    ds_read_b64_tr_b16 v[198:199], v7 offset:31488
    v_mfma_f32_16x16x32_bf16 v[108:111], v[240:243], v[176:179], v[108:111]
    ds_read_b128 v[164:167], v2 offset:5120
    v_mfma_f32_16x16x32_bf16 v[136:139], v[220:223], v[180:183], v[136:139]
    ds_read_b128 v[168:171], v3 offset:6400
    v_mfma_f32_16x16x32_bf16 v[140:143], v[224:227], v[180:183], v[140:143]
    ds_read_b128 v[172:175], v2 offset:7680
    v_mfma_f32_16x16x32_bf16 v[144:147], v[216:219], v[180:183], v[144:147]
    ds_read_b64_tr_b16 v[200:201], v8 offset:30720
    ds_read_b64_tr_b16 v[202:203], v8 offset:31488
    v_mfma_f32_16x16x32_bf16 v[124:127], v[232:235], v[180:183], v[124:127]
    s_nop 0
    v_mfma_f32_16x16x32_bf16 v[128:131], v[236:239], v[180:183], v[128:131]
    s_and_b64 s[64:65], s[64:65], vcc
    v_mfma_f32_16x16x32_bf16 v[132:135], v[228:231], v[180:183], v[132:135]
    v_cmp_le_u32 vcc, s82, v44
    v_mfma_f32_16x16x32_bf16 v[112:115], v[244:247], v[180:183], v[112:115]
    v_cmp_ge_u32 s[66:67], s83, v44
    v_mfma_f32_16x16x32_bf16 v[116:119], v[248:251], v[180:183], v[116:119]
    s_nop 0
    v_mfma_f32_16x16x32_bf16 v[120:123], v[240:243], v[180:183], v[120:123]
    s_and_b64 s[66:67], s[66:67], vcc
    s_waitcnt lgkmcnt(3)
    v_mfma_f32_16x16x32_bf16 v[136:139], v[232:235], v[184:187], v[136:139]
    v_cmp_le_u32 vcc, s82, v45
    v_cmp_ge_u32 s[68:69], s83, v45
    v_mfma_f32_16x16x32_bf16 v[140:143], v[236:239], v[184:187], v[140:143]
    s_nop 0
    s_and_b64 s[68:69], s[68:69], vcc
    v_mfma_f32_16x16x32_bf16 v[144:147], v[228:231], v[184:187], v[144:147]
    v_add_u32 v6, 30720, v6
    v_add_u32 v7, 30720, v7
    v_mfma_f32_16x16x32_bf16 v[124:127], v[244:247], v[184:187], v[124:127]
    v_add_u32 v8, 30720, v8
    v_mfma_f32_16x16x32_bf16 v[128:131], v[248:251], v[184:187], v[128:131]
    v_mfma_f32_16x16x32_bf16 v[132:135], v[240:243], v[184:187], v[132:135]
    v_mfma_f32_16x16x32_bf16 v[136:139], v[244:247], v[188:191], v[136:139]
    v_mfma_f32_16x16x32_bf16 v[140:143], v[248:251], v[188:191], v[140:143]
    v_mfma_f32_16x16x32_bf16 v[144:147], v[240:243], v[188:191], v[144:147]
    s_waitcnt lgkmcnt(0)
    s_waitcnt vmcnt(0)
L_loop2:
    ds_read_b64_tr_b16 v[204:205], v6 offset:6144
    s_waitcnt lgkmcnt(2)
    v_mfma_f32_16x16x32_bf16 v[76:79], v[192:195], v[152:155], v[76:79]
    ds_read_b64_tr_b16 v[206:207], v6 offset:6912
    v_mfma_f32_16x16x32_bf16 v[88:91], v[192:195], v[156:159], v[88:91]
    ds_read_b128 v[176:179], v3 offset:8960
    v_mfma_f32_16x16x32_bf16 v[100:103], v[192:195], v[160:163], v[100:103]
    ds_read_b64_tr_b16 v[208:209], v7 offset:6144
    v_mfma_f32_16x16x32_bf16 v[80:83], v[196:199], v[152:155], v[80:83]
    ds_read_b64_tr_b16 v[210:211], v7 offset:6912
    v_mfma_f32_16x16x32_bf16 v[92:95], v[196:199], v[156:159], v[92:95]
    ds_read_b128 v[180:183], v2 offset:10240
    v_mfma_f32_16x16x32_bf16 v[104:107], v[196:199], v[160:163], v[104:107]
    ds_read_b128 v[184:187], v3 offset:11520
    s_waitcnt lgkmcnt(7)
    v_mfma_f32_16x16x32_bf16 v[72:75], v[200:203], v[148:151], v[72:75]
    ds_read_b128 v[188:191], v2 offset:12800
    v_mfma_f32_16x16x32_bf16 v[84:87], v[200:203], v[152:155], v[84:87]
    s_add_u32 s24, s24, 1
    v_mfma_f32_16x16x32_bf16 v[96:99], v[200:203], v[156:159], v[96:99]
    s_cmp_eq_u32 s24, 5
    v_mfma_f32_16x16x32_bf16 v[108:111], v[200:203], v[160:163], v[108:111]
    s_cselect_b32 s3, 23040, 0
    v_mfma_f32_16x16x32_bf16 v[112:115], v[192:195], v[164:167], v[112:115]
    s_cselect_b32 s24, 0, s24
    v_mfma_f32_16x16x32_bf16 v[124:127], v[192:195], v[168:171], v[124:127]
    s_add_u32 s25, s25, s3
    v_mfma_f32_16x16x32_bf16 v[136:139], v[192:195], v[172:175], v[136:139]
    ds_read_b64_tr_b16 v[192:193], v8 offset:6144
    v_mfma_f32_16x16x32_bf16 v[116:119], v[196:199], v[164:167], v[116:119]
    ds_read_b64_tr_b16 v[194:195], v8 offset:6912
    v_mfma_f32_16x16x32_bf16 v[128:131], v[196:199], v[168:171], v[128:131]
    v_add_u32 v17, s24, v15
    v_mfma_f32_16x16x32_bf16 v[140:143], v[196:199], v[172:175], v[140:143]
    ds_read_b64_tr_b16 v[196:197], v6 offset:12288
    v_mfma_f32_16x16x32_bf16 v[120:123], v[200:203], v[164:167], v[120:123]
    ds_read_b64_tr_b16 v[198:199], v6 offset:13056
    v_mfma_f32_16x16x32_bf16 v[132:135], v[200:203], v[168:171], v[132:135]
    v_lshrrev_b32 v18, 1, v17
    v_mfma_f32_16x16x32_bf16 v[144:147], v[200:203], v[172:175], v[144:147]
    ds_read_b64_tr_b16 v[200:201], v7 offset:12288
    s_waitcnt lgkmcnt(5)
    v_mfma_f32_16x16x32_bf16 v[76:79], v[204:207], v[156:159], v[76:79]
    ds_read_b64_tr_b16 v[202:203], v7 offset:13056
    v_mfma_f32_16x16x32_bf16 v[88:91], v[204:207], v[160:163], v[88:91]
    v_and_b32 v18, 2, v18
    v_mfma_f32_16x16x32_bf16 v[100:103], v[204:207], v[164:167], v[100:103]
    v_xor_b32 v18, v18, v16
    v_mfma_f32_16x16x32_bf16 v[112:115], v[204:207], v[168:171], v[112:115]
    v_lshlrev_b32 v18, 4, v18
    v_mfma_f32_16x16x32_bf16 v[124:127], v[204:207], v[172:175], v[124:127]
    v_lshl_add_u32 v18, v17, 6, v18
    v_mfma_f32_16x16x32_bf16 v[136:139], v[204:207], v[176:179], v[136:139]
    ds_read_b64_tr_b16 v[204:205], v8 offset:12288
    v_mfma_f32_16x16x32_bf16 v[80:83], v[208:211], v[156:159], v[80:83]
    ds_read_b64_tr_b16 v[206:207], v8 offset:13056
    v_mfma_f32_16x16x32_bf16 v[92:95], v[208:211], v[160:163], v[92:95]
    v_add_u32 v2, s25, v18
    v_mfma_f32_16x16x32_bf16 v[104:107], v[208:211], v[164:167], v[104:107]
    v_xor_b32 v3, 32, v2
    v_mfma_f32_16x16x32_bf16 v[116:119], v[208:211], v[168:171], v[116:119]
    ds_read_b128 v[148:151], v2 offset:0
    v_mfma_f32_16x16x32_bf16 v[128:131], v[208:211], v[172:175], v[128:131]
    v_mfma_f32_16x16x32_bf16 v[140:143], v[208:211], v[176:179], v[140:143]
    ds_read_b64_tr_b16 v[208:209], v6 offset:18432
    s_waitcnt lgkmcnt(4)
    v_mfma_f32_16x16x32_bf16 v[72:75], v[192:195], v[152:155], v[72:75]
    ds_read_b64_tr_b16 v[210:211], v6 offset:19200
    v_mfma_f32_16x16x32_bf16 v[84:87], v[192:195], v[156:159], v[84:87]
    ds_read_b128 v[152:155], v3 offset:1280
    v_mfma_f32_16x16x32_bf16 v[96:99], v[192:195], v[160:163], v[96:99]
    v_mfma_f32_16x16x32_bf16 v[108:111], v[192:195], v[164:167], v[108:111]
    v_mfma_f32_16x16x32_bf16 v[120:123], v[192:195], v[168:171], v[120:123]
    v_mfma_f32_16x16x32_bf16 v[132:135], v[192:195], v[172:175], v[132:135]
    v_mfma_f32_16x16x32_bf16 v[144:147], v[192:195], v[176:179], v[144:147]
    ds_read_b64_tr_b16 v[192:193], v7 offset:18432
    v_mfma_f32_16x16x32_bf16 v[76:79], v[196:199], v[160:163], v[76:79]
    ds_read_b64_tr_b16 v[194:195], v7 offset:19200
    v_mfma_f32_16x16x32_bf16 v[88:91], v[196:199], v[164:167], v[88:91]
    v_mfma_f32_16x16x32_bf16 v[100:103], v[196:199], v[168:171], v[100:103]
    v_mfma_f32_16x16x32_bf16 v[112:115], v[196:199], v[172:175], v[112:115]
    v_mfma_f32_16x16x32_bf16 v[124:127], v[196:199], v[176:179], v[124:127]
    v_mfma_f32_16x16x32_bf16 v[136:139], v[196:199], v[180:183], v[136:139]
    ds_read_b64_tr_b16 v[196:197], v8 offset:18432
    v_mfma_f32_16x16x32_bf16 v[80:83], v[200:203], v[160:163], v[80:83]
    ds_read_b64_tr_b16 v[198:199], v8 offset:19200
    v_mfma_f32_16x16x32_bf16 v[92:95], v[200:203], v[164:167], v[92:95]
    v_mfma_f32_16x16x32_bf16 v[104:107], v[200:203], v[168:171], v[104:107]
    v_mfma_f32_16x16x32_bf16 v[116:119], v[200:203], v[172:175], v[116:119]
    v_mfma_f32_16x16x32_bf16 v[128:131], v[200:203], v[176:179], v[128:131]
    v_mfma_f32_16x16x32_bf16 v[140:143], v[200:203], v[180:183], v[140:143]
    ds_read_b64_tr_b16 v[200:201], v6 offset:24576
    s_waitcnt lgkmcnt(3)
    v_mfma_f32_16x16x32_bf16 v[72:75], v[204:207], v[156:159], v[72:75]
    ds_read_b64_tr_b16 v[202:203], v6 offset:25344
    v_mfma_f32_16x16x32_bf16 v[84:87], v[204:207], v[160:163], v[84:87]
    s_add_u32 s26, s26, 30720
    v_mfma_f32_16x16x32_bf16 v[96:99], v[204:207], v[164:167], v[96:99]
    s_cmp_eq_u32 s26, 92160
    v_mfma_f32_16x16x32_bf16 v[108:111], v[204:207], v[168:171], v[108:111]
    s_cselect_b32 s33, 4294875136, 0
    v_mfma_f32_16x16x32_bf16 v[120:123], v[204:207], v[172:175], v[120:123]
    s_cselect_b32 s26, 0, s26
    v_mfma_f32_16x16x32_bf16 v[132:135], v[204:207], v[176:179], v[132:135]
    s_add_u32 s33, s33, 30720
    v_mfma_f32_16x16x32_bf16 v[144:147], v[204:207], v[180:183], v[144:147]
    ds_read_b64_tr_b16 v[204:205], v7 offset:24576
    v_mfma_f32_16x16x32_bf16 v[76:79], v[208:211], v[164:167], v[76:79]
    ds_read_b64_tr_b16 v[206:207], v7 offset:25344
    v_mfma_f32_16x16x32_bf16 v[88:91], v[208:211], v[168:171], v[88:91]
    ds_read_b128 v[156:159], v2 offset:2560
    v_mfma_f32_16x16x32_bf16 v[100:103], v[208:211], v[172:175], v[100:103]
    v_mfma_f32_16x16x32_bf16 v[112:115], v[208:211], v[176:179], v[112:115]
    v_mfma_f32_16x16x32_bf16 v[124:127], v[208:211], v[180:183], v[124:127]
    v_mfma_f32_16x16x32_bf16 v[136:139], v[208:211], v[184:187], v[136:139]
    ds_read_b64_tr_b16 v[208:209], v8 offset:24576
    v_mfma_f32_16x16x32_bf16 v[80:83], v[192:195], v[164:167], v[80:83]
    ds_read_b64_tr_b16 v[210:211], v8 offset:25344
    v_mfma_f32_16x16x32_bf16 v[92:95], v[192:195], v[168:171], v[92:95]
    v_add_u32 v6, s33, v6
    v_mfma_f32_16x16x32_bf16 v[104:107], v[192:195], v[172:175], v[104:107]
    v_add_u32 v7, s33, v7
    v_mfma_f32_16x16x32_bf16 v[116:119], v[192:195], v[176:179], v[116:119]
    v_add_u32 v8, s33, v8
    v_mfma_f32_16x16x32_bf16 v[128:131], v[192:195], v[180:183], v[128:131]
    v_mfma_f32_16x16x32_bf16 v[140:143], v[192:195], v[184:187], v[140:143]
    s_waitcnt lgkmcnt(2)
    v_mfma_f32_16x16x32_bf16 v[72:75], v[196:199], v[160:163], v[72:75]
    s_waitcnt lgkmcnt(0)
    s_barrier
    v_mfma_f32_16x16x32_bf16 v[84:87], v[196:199], v[164:167], v[84:87]
    ds_read_b64_tr_b16 v[192:193], v6 offset:0
    v_mfma_f32_16x16x32_bf16 v[96:99], v[196:199], v[168:171], v[96:99]
    ds_read_b64_tr_b16 v[194:195], v6 offset:768
    v_mfma_f32_16x16x32_bf16 v[108:111], v[196:199], v[172:175], v[108:111]
    ds_read_b128 v[160:163], v3 offset:3840
    v_mfma_f32_16x16x32_bf16 v[120:123], v[196:199], v[176:179], v[120:123]
    v_mfma_f32_16x16x32_bf16 v[132:135], v[196:199], v[180:183], v[132:135]
    v_mfma_f32_16x16x32_bf16 v[144:147], v[196:199], v[184:187], v[144:147]
    ds_read_b64_tr_b16 v[196:197], v7 offset:0
    v_mfma_f32_16x16x32_bf16 v[76:79], v[200:203], v[168:171], v[76:79]
    ds_read_b64_tr_b16 v[198:199], v7 offset:768
    v_mfma_f32_16x16x32_bf16 v[88:91], v[200:203], v[172:175], v[88:91]
    v_mfma_f32_16x16x32_bf16 v[80:83], v[204:207], v[168:171], v[80:83]
    v_mfma_f32_16x16x32_bf16 v[92:95], v[204:207], v[172:175], v[92:95]
    v_mfma_f32_16x16x32_bf16 v[72:75], v[208:211], v[164:167], v[72:75]
    ds_read_b128 v[164:167], v2 offset:5120
    v_mfma_f32_16x16x32_bf16 v[84:87], v[208:211], v[168:171], v[84:87]
    ds_read_b128 v[168:171], v3 offset:6400
    v_mfma_f32_16x16x32_bf16 v[96:99], v[208:211], v[172:175], v[96:99]
    ds_read_b128 v[172:175], v2 offset:7680
    v_mfma_f32_16x16x32_bf16 v[100:103], v[200:203], v[176:179], v[100:103]
    v_mfma_f32_16x16x32_bf16 v[112:115], v[200:203], v[180:183], v[112:115]
    v_mfma_f32_16x16x32_bf16 v[124:127], v[200:203], v[184:187], v[124:127]
    v_mfma_f32_16x16x32_bf16 v[136:139], v[200:203], v[188:191], v[136:139]
    ds_read_b64_tr_b16 v[200:201], v8 offset:0
    v_mfma_f32_16x16x32_bf16 v[104:107], v[204:207], v[176:179], v[104:107]
    ds_read_b64_tr_b16 v[202:203], v8 offset:768
    v_mfma_f32_16x16x32_bf16 v[116:119], v[204:207], v[180:183], v[116:119]
    v_mfma_f32_16x16x32_bf16 v[128:131], v[204:207], v[184:187], v[128:131]
    v_mfma_f32_16x16x32_bf16 v[140:143], v[204:207], v[188:191], v[140:143]
    v_mfma_f32_16x16x32_bf16 v[108:111], v[208:211], v[176:179], v[108:111]
    v_mfma_f32_16x16x32_bf16 v[120:123], v[208:211], v[180:183], v[120:123]
    v_mfma_f32_16x16x32_bf16 v[132:135], v[208:211], v[184:187], v[132:135]
    v_mfma_f32_16x16x32_bf16 v[144:147], v[208:211], v[188:191], v[144:147]
    ds_read_b64_tr_b16 v[204:205], v6 offset:6144
    s_waitcnt lgkmcnt(2)
    v_mfma_f32_16x16x32_bf16 v[76:79], v[192:195], v[152:155], v[76:79]
    ds_read_b64_tr_b16 v[206:207], v6 offset:6912
    v_mfma_f32_16x16x32_bf16 v[88:91], v[192:195], v[156:159], v[88:91]
    ds_read_b128 v[176:179], v3 offset:8960
    v_mfma_f32_16x16x32_bf16 v[100:103], v[192:195], v[160:163], v[100:103]
    ds_read_b64_tr_b16 v[208:209], v7 offset:6144
    v_mfma_f32_16x16x32_bf16 v[80:83], v[196:199], v[152:155], v[80:83]
    ds_read_b64_tr_b16 v[210:211], v7 offset:6912
    v_mfma_f32_16x16x32_bf16 v[92:95], v[196:199], v[156:159], v[92:95]
    ds_read_b128 v[180:183], v2 offset:10240
    v_mfma_f32_16x16x32_bf16 v[104:107], v[196:199], v[160:163], v[104:107]
    ds_read_b128 v[184:187], v3 offset:11520
    s_waitcnt lgkmcnt(7)
    v_mfma_f32_16x16x32_bf16 v[72:75], v[200:203], v[148:151], v[72:75]
    ds_read_b128 v[188:191], v2 offset:12800
    v_mfma_f32_16x16x32_bf16 v[84:87], v[200:203], v[152:155], v[84:87]
    s_add_u32 s24, s24, 1
    v_mfma_f32_16x16x32_bf16 v[96:99], v[200:203], v[156:159], v[96:99]
    s_cmp_eq_u32 s24, 5
    v_mfma_f32_16x16x32_bf16 v[108:111], v[200:203], v[160:163], v[108:111]
    s_cselect_b32 s3, 23040, 0
    v_mfma_f32_16x16x32_bf16 v[112:115], v[192:195], v[164:167], v[112:115]
    s_cselect_b32 s24, 0, s24
    v_mfma_f32_16x16x32_bf16 v[124:127], v[192:195], v[168:171], v[124:127]
    s_add_u32 s25, s25, s3
    v_mfma_f32_16x16x32_bf16 v[136:139], v[192:195], v[172:175], v[136:139]
    ds_read_b64_tr_b16 v[192:193], v8 offset:6144
    v_mfma_f32_16x16x32_bf16 v[116:119], v[196:199], v[164:167], v[116:119]
    ds_read_b64_tr_b16 v[194:195], v8 offset:6912
    v_mfma_f32_16x16x32_bf16 v[128:131], v[196:199], v[168:171], v[128:131]
    v_add_u32 v17, s24, v15
    v_mfma_f32_16x16x32_bf16 v[140:143], v[196:199], v[172:175], v[140:143]
    ds_read_b64_tr_b16 v[196:197], v6 offset:12288
    v_mfma_f32_16x16x32_bf16 v[120:123], v[200:203], v[164:167], v[120:123]
    ds_read_b64_tr_b16 v[198:199], v6 offset:13056
    v_mfma_f32_16x16x32_bf16 v[132:135], v[200:203], v[168:171], v[132:135]
    v_lshrrev_b32 v18, 1, v17
    v_mfma_f32_16x16x32_bf16 v[144:147], v[200:203], v[172:175], v[144:147]
    ds_read_b64_tr_b16 v[200:201], v7 offset:12288
    s_waitcnt lgkmcnt(5)
    v_mfma_f32_16x16x32_bf16 v[76:79], v[204:207], v[156:159], v[76:79]
    ds_read_b64_tr_b16 v[202:203], v7 offset:13056
    v_mfma_f32_16x16x32_bf16 v[88:91], v[204:207], v[160:163], v[88:91]
    v_and_b32 v18, 2, v18
    v_mfma_f32_16x16x32_bf16 v[100:103], v[204:207], v[164:167], v[100:103]
    v_xor_b32 v18, v18, v16
    v_mfma_f32_16x16x32_bf16 v[112:115], v[204:207], v[168:171], v[112:115]
    v_lshlrev_b32 v18, 4, v18
    v_mfma_f32_16x16x32_bf16 v[124:127], v[204:207], v[172:175], v[124:127]
    v_lshl_add_u32 v18, v17, 6, v18
    v_mfma_f32_16x16x32_bf16 v[136:139], v[204:207], v[176:179], v[136:139]
    ds_read_b64_tr_b16 v[204:205], v8 offset:12288
    v_mfma_f32_16x16x32_bf16 v[80:83], v[208:211], v[156:159], v[80:83]
    ds_read_b64_tr_b16 v[206:207], v8 offset:13056
    v_mfma_f32_16x16x32_bf16 v[92:95], v[208:211], v[160:163], v[92:95]
    v_add_u32 v2, s25, v18
    v_mfma_f32_16x16x32_bf16 v[104:107], v[208:211], v[164:167], v[104:107]
    v_xor_b32 v3, 32, v2
    v_mfma_f32_16x16x32_bf16 v[116:119], v[208:211], v[168:171], v[116:119]
    ds_read_b128 v[148:151], v2 offset:0
    v_mfma_f32_16x16x32_bf16 v[128:131], v[208:211], v[172:175], v[128:131]
    v_mfma_f32_16x16x32_bf16 v[140:143], v[208:211], v[176:179], v[140:143]
    ds_read_b64_tr_b16 v[208:209], v6 offset:18432
    s_waitcnt lgkmcnt(4)
    v_mfma_f32_16x16x32_bf16 v[72:75], v[192:195], v[152:155], v[72:75]
    ds_read_b64_tr_b16 v[210:211], v6 offset:19200
    v_mfma_f32_16x16x32_bf16 v[84:87], v[192:195], v[156:159], v[84:87]
    ds_read_b128 v[152:155], v3 offset:1280
    v_mfma_f32_16x16x32_bf16 v[96:99], v[192:195], v[160:163], v[96:99]
    v_mfma_f32_16x16x32_bf16 v[108:111], v[192:195], v[164:167], v[108:111]
    v_mfma_f32_16x16x32_bf16 v[120:123], v[192:195], v[168:171], v[120:123]
    v_mfma_f32_16x16x32_bf16 v[132:135], v[192:195], v[172:175], v[132:135]
    v_mfma_f32_16x16x32_bf16 v[144:147], v[192:195], v[176:179], v[144:147]
    ds_read_b64_tr_b16 v[192:193], v7 offset:18432
    v_mfma_f32_16x16x32_bf16 v[76:79], v[196:199], v[160:163], v[76:79]
    ds_read_b64_tr_b16 v[194:195], v7 offset:19200
    v_mfma_f32_16x16x32_bf16 v[88:91], v[196:199], v[164:167], v[88:91]
    v_mfma_f32_16x16x32_bf16 v[100:103], v[196:199], v[168:171], v[100:103]
    v_mfma_f32_16x16x32_bf16 v[112:115], v[196:199], v[172:175], v[112:115]
    v_mfma_f32_16x16x32_bf16 v[124:127], v[196:199], v[176:179], v[124:127]
    v_mfma_f32_16x16x32_bf16 v[136:139], v[196:199], v[180:183], v[136:139]
    ds_read_b64_tr_b16 v[196:197], v8 offset:18432
    v_mfma_f32_16x16x32_bf16 v[80:83], v[200:203], v[160:163], v[80:83]
    ds_read_b64_tr_b16 v[198:199], v8 offset:19200
    v_mfma_f32_16x16x32_bf16 v[92:95], v[200:203], v[164:167], v[92:95]
    v_mfma_f32_16x16x32_bf16 v[104:107], v[200:203], v[168:171], v[104:107]
    v_mfma_f32_16x16x32_bf16 v[116:119], v[200:203], v[172:175], v[116:119]
    v_mfma_f32_16x16x32_bf16 v[128:131], v[200:203], v[176:179], v[128:131]
    v_mfma_f32_16x16x32_bf16 v[140:143], v[200:203], v[180:183], v[140:143]
    ds_read_b64_tr_b16 v[200:201], v6 offset:24576
    s_waitcnt lgkmcnt(3)
    v_mfma_f32_16x16x32_bf16 v[72:75], v[204:207], v[156:159], v[72:75]
    ds_read_b64_tr_b16 v[202:203], v6 offset:25344
    v_mfma_f32_16x16x32_bf16 v[84:87], v[204:207], v[160:163], v[84:87]
    s_add_u32 s26, s26, 30720
    v_mfma_f32_16x16x32_bf16 v[96:99], v[204:207], v[164:167], v[96:99]
    s_cmp_eq_u32 s26, 92160
    v_mfma_f32_16x16x32_bf16 v[108:111], v[204:207], v[168:171], v[108:111]
    s_cselect_b32 s33, 4294875136, 0
    v_mfma_f32_16x16x32_bf16 v[120:123], v[204:207], v[172:175], v[120:123]
    s_cselect_b32 s26, 0, s26
    v_mfma_f32_16x16x32_bf16 v[132:135], v[204:207], v[176:179], v[132:135]
    s_add_u32 s33, s33, 30720
    v_mfma_f32_16x16x32_bf16 v[144:147], v[204:207], v[180:183], v[144:147]
    ds_read_b64_tr_b16 v[204:205], v7 offset:24576
    v_mfma_f32_16x16x32_bf16 v[76:79], v[208:211], v[164:167], v[76:79]
    ds_read_b64_tr_b16 v[206:207], v7 offset:25344
    v_mfma_f32_16x16x32_bf16 v[88:91], v[208:211], v[168:171], v[88:91]
    ds_read_b128 v[156:159], v2 offset:2560
    v_mfma_f32_16x16x32_bf16 v[100:103], v[208:211], v[172:175], v[100:103]
    v_mfma_f32_16x16x32_bf16 v[112:115], v[208:211], v[176:179], v[112:115]
    v_mfma_f32_16x16x32_bf16 v[124:127], v[208:211], v[180:183], v[124:127]
    v_mfma_f32_16x16x32_bf16 v[136:139], v[208:211], v[184:187], v[136:139]
    ds_read_b64_tr_b16 v[208:209], v8 offset:24576
    v_mfma_f32_16x16x32_bf16 v[80:83], v[192:195], v[164:167], v[80:83]
    ds_read_b64_tr_b16 v[210:211], v8 offset:25344
    v_mfma_f32_16x16x32_bf16 v[92:95], v[192:195], v[168:171], v[92:95]
    v_add_u32 v6, s33, v6
    v_mfma_f32_16x16x32_bf16 v[104:107], v[192:195], v[172:175], v[104:107]
    v_add_u32 v7, s33, v7
    v_mfma_f32_16x16x32_bf16 v[116:119], v[192:195], v[176:179], v[116:119]
    v_add_u32 v8, s33, v8
    v_mfma_f32_16x16x32_bf16 v[128:131], v[192:195], v[180:183], v[128:131]
    v_mfma_f32_16x16x32_bf16 v[140:143], v[192:195], v[184:187], v[140:143]
    s_waitcnt lgkmcnt(2)
    v_mfma_f32_16x16x32_bf16 v[72:75], v[196:199], v[160:163], v[72:75]
    s_waitcnt lgkmcnt(0)
    s_barrier
    v_mfma_f32_16x16x32_bf16 v[84:87], v[196:199], v[164:167], v[84:87]
    ds_read_b64_tr_b16 v[192:193], v6 offset:0
    v_mfma_f32_16x16x32_bf16 v[96:99], v[196:199], v[168:171], v[96:99]
    ds_read_b64_tr_b16 v[194:195], v6 offset:768
    v_mfma_f32_16x16x32_bf16 v[108:111], v[196:199], v[172:175], v[108:111]
    ds_read_b128 v[160:163], v3 offset:3840
    v_mfma_f32_16x16x32_bf16 v[120:123], v[196:199], v[176:179], v[120:123]
    v_mfma_f32_16x16x32_bf16 v[132:135], v[196:199], v[180:183], v[132:135]
    v_mfma_f32_16x16x32_bf16 v[144:147], v[196:199], v[184:187], v[144:147]
    ds_read_b64_tr_b16 v[196:197], v7 offset:0
    v_mfma_f32_16x16x32_bf16 v[76:79], v[200:203], v[168:171], v[76:79]
    ds_read_b64_tr_b16 v[198:199], v7 offset:768
    v_mfma_f32_16x16x32_bf16 v[88:91], v[200:203], v[172:175], v[88:91]
    v_mfma_f32_16x16x32_bf16 v[80:83], v[204:207], v[168:171], v[80:83]
    v_mfma_f32_16x16x32_bf16 v[92:95], v[204:207], v[172:175], v[92:95]
    v_mfma_f32_16x16x32_bf16 v[72:75], v[208:211], v[164:167], v[72:75]
    ds_read_b128 v[164:167], v2 offset:5120
    v_mfma_f32_16x16x32_bf16 v[84:87], v[208:211], v[168:171], v[84:87]
    ds_read_b128 v[168:171], v3 offset:6400
    v_mfma_f32_16x16x32_bf16 v[96:99], v[208:211], v[172:175], v[96:99]
    ds_read_b128 v[172:175], v2 offset:7680
    v_mfma_f32_16x16x32_bf16 v[100:103], v[200:203], v[176:179], v[100:103]
    v_mfma_f32_16x16x32_bf16 v[112:115], v[200:203], v[180:183], v[112:115]
    v_mfma_f32_16x16x32_bf16 v[124:127], v[200:203], v[184:187], v[124:127]
    v_mfma_f32_16x16x32_bf16 v[136:139], v[200:203], v[188:191], v[136:139]
    ds_read_b64_tr_b16 v[200:201], v8 offset:0
    v_mfma_f32_16x16x32_bf16 v[104:107], v[204:207], v[176:179], v[104:107]
    ds_read_b64_tr_b16 v[202:203], v8 offset:768
    v_mfma_f32_16x16x32_bf16 v[116:119], v[204:207], v[180:183], v[116:119]
    v_mfma_f32_16x16x32_bf16 v[128:131], v[204:207], v[184:187], v[128:131]
    v_mfma_f32_16x16x32_bf16 v[140:143], v[204:207], v[188:191], v[140:143]
    v_mfma_f32_16x16x32_bf16 v[108:111], v[208:211], v[176:179], v[108:111]
    v_mfma_f32_16x16x32_bf16 v[120:123], v[208:211], v[180:183], v[120:123]
    v_mfma_f32_16x16x32_bf16 v[132:135], v[208:211], v[184:187], v[132:135]
    s_add_u32 s27, s27, 2
    v_mfma_f32_16x16x32_bf16 v[144:147], v[208:211], v[188:191], v[144:147]
    s_cmp_lt_u32 s27, 13
    s_cbranch_scc1 L_loop2
    ds_read_b64_tr_b16 v[176:177], v6 offset:6144
    ds_read_b64_tr_b16 v[178:179], v6 offset:6912
    ds_read_b64_tr_b16 v[180:181], v7 offset:6144
    s_waitcnt lgkmcnt(11)
    v_mfma_f32_16x16x32_bf16 v[76:79], v[192:195], v[152:155], v[76:79]
    ds_read_b64_tr_b16 v[182:183], v7 offset:6912
    ds_read_b64_tr_b16 v[184:185], v8 offset:6144
    v_mfma_f32_16x16x32_bf16 v[88:91], v[192:195], v[156:159], v[88:91]
    ds_read_b64_tr_b16 v[186:187], v8 offset:6912
    ds_read_b64_tr_b16 v[188:189], v6 offset:12288
    s_waitcnt lgkmcnt(12)
    v_mfma_f32_16x16x32_bf16 v[80:83], v[196:199], v[152:155], v[80:83]
    ds_read_b64_tr_b16 v[190:191], v6 offset:13056
    ds_read_b64_tr_b16 v[204:205], v7 offset:12288
    v_mfma_f32_16x16x32_bf16 v[92:95], v[196:199], v[156:159], v[92:95]
    ds_read_b64_tr_b16 v[206:207], v7 offset:13056
    s_waitcnt lgkmcnt(10)
    v_mfma_f32_16x16x32_bf16 v[72:75], v[200:203], v[148:151], v[72:75]
    ds_read_b64_tr_b16 v[208:209], v8 offset:12288
    ds_read_b64_tr_b16 v[210:211], v8 offset:13056
    v_mfma_f32_16x16x32_bf16 v[84:87], v[200:203], v[152:155], v[84:87]
    ds_read_b64_tr_b16 v[212:213], v6 offset:18432
    v_mfma_f32_16x16x32_bf16 v[96:99], v[200:203], v[156:159], v[96:99]
    ds_read_b64_tr_b16 v[214:215], v6 offset:19200
    s_waitcnt lgkmcnt(12)
    v_mfma_f32_16x16x32_bf16 v[76:79], v[176:179], v[156:159], v[76:79]
    ds_read_b64_tr_b16 v[216:217], v7 offset:18432
    v_mfma_f32_16x16x32_bf16 v[88:91], v[176:179], v[160:163], v[88:91]
    ds_read_b64_tr_b16 v[218:219], v7 offset:19200
    s_waitcnt lgkmcnt(11)
    v_mfma_f32_16x16x32_bf16 v[80:83], v[180:183], v[156:159], v[80:83]
    ds_read_b64_tr_b16 v[220:221], v8 offset:18432
    v_mfma_f32_16x16x32_bf16 v[92:95], v[180:183], v[160:163], v[92:95]
    ds_read_b64_tr_b16 v[222:223], v8 offset:19200
    s_waitcnt lgkmcnt(9)
    v_mfma_f32_16x16x32_bf16 v[72:75], v[184:187], v[152:155], v[72:75]
    ds_read_b64_tr_b16 v[224:225], v6 offset:24576
    v_mfma_f32_16x16x32_bf16 v[84:87], v[184:187], v[156:159], v[84:87]
    ds_read_b64_tr_b16 v[226:227], v6 offset:25344
    v_mfma_f32_16x16x32_bf16 v[96:99], v[184:187], v[160:163], v[96:99]
    ds_read_b64_tr_b16 v[228:229], v7 offset:24576
    v_mfma_f32_16x16x32_bf16 v[76:79], v[188:191], v[160:163], v[76:79]
    ds_read_b64_tr_b16 v[230:231], v7 offset:25344
    v_mfma_f32_16x16x32_bf16 v[88:91], v[188:191], v[164:167], v[88:91]
    ds_read_b64_tr_b16 v[232:233], v8 offset:24576
    s_waitcnt lgkmcnt(8)
    v_mfma_f32_16x16x32_bf16 v[80:83], v[204:207], v[160:163], v[80:83]
    ds_read_b64_tr_b16 v[234:235], v8 offset:25344
    v_mfma_f32_16x16x32_bf16 v[92:95], v[204:207], v[164:167], v[92:95]
    ds_read_b64_tr_b16 v[236:237], v6 offset:30720
    v_mfma_f32_16x16x32_bf16 v[72:75], v[208:211], v[156:159], v[72:75]
    ds_read_b64_tr_b16 v[238:239], v6 offset:31488
    v_mfma_f32_16x16x32_bf16 v[84:87], v[208:211], v[160:163], v[84:87]
    ds_read_b128 v[240:243], v27 offset:1280
    v_mfma_f32_16x16x32_bf16 v[96:99], v[208:211], v[164:167], v[96:99]
    ds_read_b128 v[244:247], v26 offset:2560
    v_mfma_f32_16x16x32_bf16 v[76:79], v[212:215], v[164:167], v[76:79]
    ds_read_b64_tr_b16 v[248:249], v7 offset:30720
    v_mfma_f32_16x16x32_bf16 v[88:91], v[212:215], v[168:171], v[88:91]
    ds_read_b64_tr_b16 v[250:251], v7 offset:31488
    s_waitcnt lgkmcnt(8)
    v_mfma_f32_16x16x32_bf16 v[80:83], v[216:219], v[164:167], v[80:83]
    ds_read_b64_tr_b16 v[252:253], v8 offset:30720
    v_mfma_f32_16x16x32_bf16 v[92:95], v[216:219], v[168:171], v[92:95]
    ds_read_b64_tr_b16 v[254:255], v8 offset:31488
    v_mfma_f32_16x16x32_bf16 v[72:75], v[220:223], v[160:163], v[72:75]
    ds_read_b128 v[192:195], v26 offset:0
    v_mfma_f32_16x16x32_bf16 v[84:87], v[220:223], v[164:167], v[84:87]
    ds_read_b64_tr_b16 v[196:197], v6 offset:36864
    v_mfma_f32_16x16x32_bf16 v[96:99], v[220:223], v[168:171], v[96:99]
    ds_read_b64_tr_b16 v[198:199], v6 offset:37632
    v_mfma_f32_16x16x32_bf16 v[76:79], v[224:227], v[168:171], v[76:79]
    ds_read_b128 v[148:151], v27 offset:3840
    v_mfma_f32_16x16x32_bf16 v[88:91], v[224:227], v[172:175], v[88:91]
    ds_read_b64_tr_b16 v[200:201], v7 offset:36864
    v_mfma_f32_16x16x32_bf16 v[80:83], v[228:231], v[168:171], v[80:83]
    ds_read_b64_tr_b16 v[202:203], v7 offset:37632
    v_mfma_f32_16x16x32_bf16 v[92:95], v[228:231], v[172:175], v[92:95]
    ds_read_b64_tr_b16 v[176:177], v8 offset:36864
    s_waitcnt lgkmcnt(8)
    v_mfma_f32_16x16x32_bf16 v[72:75], v[232:235], v[164:167], v[72:75]
    ds_read_b64_tr_b16 v[178:179], v8 offset:37632
    v_mfma_f32_16x16x32_bf16 v[84:87], v[232:235], v[168:171], v[84:87]
    ds_read_b64_tr_b16 v[180:181], v6 offset:43008
    v_mfma_f32_16x16x32_bf16 v[96:99], v[232:235], v[172:175], v[96:99]
    ds_read_b64_tr_b16 v[182:183], v6 offset:43776
    v_mfma_f32_16x16x32_bf16 v[76:79], v[236:239], v[240:243], v[76:79]
    ds_read_b128 v[152:155], v26 offset:5120
    v_mfma_f32_16x16x32_bf16 v[88:91], v[236:239], v[244:247], v[88:91]
    ds_read_b64_tr_b16 v[184:185], v7 offset:43008
    v_mfma_f32_16x16x32_bf16 v[80:83], v[248:251], v[240:243], v[80:83]
    ds_read_b64_tr_b16 v[186:187], v7 offset:43776
    v_mfma_f32_16x16x32_bf16 v[92:95], v[248:251], v[244:247], v[92:95]
    ds_read_b64_tr_b16 v[188:189], v8 offset:43008
    s_waitcnt lgkmcnt(8)
    v_mfma_f32_16x16x32_bf16 v[72:75], v[252:255], v[192:195], v[72:75]
    ds_read_b64_tr_b16 v[190:191], v8 offset:43776
    v_mfma_f32_16x16x32_bf16 v[84:87], v[252:255], v[240:243], v[84:87]
    ds_read_b64_tr_b16 v[204:205], v6 offset:49152
    v_mfma_f32_16x16x32_bf16 v[96:99], v[252:255], v[244:247], v[96:99]
    ds_read_b64_tr_b16 v[206:207], v6 offset:49920
    v_mfma_f32_16x16x32_bf16 v[76:79], v[196:199], v[244:247], v[76:79]
    ds_read_b128 v[156:159], v27 offset:6400
    v_mfma_f32_16x16x32_bf16 v[88:91], v[196:199], v[148:151], v[88:91]
    ds_read_b64_tr_b16 v[208:209], v7 offset:49152
    v_mfma_f32_16x16x32_bf16 v[80:83], v[200:203], v[244:247], v[80:83]
    ds_read_b64_tr_b16 v[210:211], v7 offset:49920
    v_mfma_f32_16x16x32_bf16 v[92:95], v[200:203], v[148:151], v[92:95]
    ds_read_b64_tr_b16 v[212:213], v8 offset:49152
    s_waitcnt lgkmcnt(8)
    v_mfma_f32_16x16x32_bf16 v[72:75], v[176:179], v[240:243], v[72:75]
    ds_read_b64_tr_b16 v[214:215], v8 offset:49920
    v_mfma_f32_16x16x32_bf16 v[84:87], v[176:179], v[244:247], v[84:87]
    ds_read_b64_tr_b16 v[216:217], v6 offset:55296
    v_mfma_f32_16x16x32_bf16 v[96:99], v[176:179], v[148:151], v[96:99]
    ds_read_b64_tr_b16 v[218:219], v6 offset:56064
    v_mfma_f32_16x16x32_bf16 v[76:79], v[180:183], v[148:151], v[76:79]
    ds_read_b128 v[160:163], v26 offset:7680
    v_mfma_f32_16x16x32_bf16 v[88:91], v[180:183], v[152:155], v[88:91]
    ds_read_b64_tr_b16 v[220:221], v7 offset:55296
    v_mfma_f32_16x16x32_bf16 v[80:83], v[184:187], v[148:151], v[80:83]
    ds_read_b64_tr_b16 v[222:223], v7 offset:56064
    v_mfma_f32_16x16x32_bf16 v[92:95], v[184:187], v[152:155], v[92:95]
    ds_read_b64_tr_b16 v[224:225], v8 offset:55296
    s_waitcnt lgkmcnt(8)
    v_mfma_f32_16x16x32_bf16 v[72:75], v[188:191], v[244:247], v[72:75]
    ds_read_b64_tr_b16 v[226:227], v8 offset:56064
    v_mfma_f32_16x16x32_bf16 v[84:87], v[188:191], v[148:151], v[84:87]
    ds_read_b128 v[228:231], v27 offset:8960
    v_mfma_f32_16x16x32_bf16 v[96:99], v[188:191], v[152:155], v[96:99]
    ds_read_b128 v[164:167], v26 offset:10240
    v_mfma_f32_16x16x32_bf16 v[76:79], v[204:207], v[152:155], v[76:79]
    v_mfma_f32_16x16x32_bf16 v[88:91], v[204:207], v[156:159], v[88:91]
    v_mfma_f32_16x16x32_bf16 v[80:83], v[208:211], v[152:155], v[80:83]
    v_mfma_f32_16x16x32_bf16 v[92:95], v[208:211], v[156:159], v[92:95]
    ds_read_b64_tr_b16 v[168:169], v6 offset:0
    s_waitcnt lgkmcnt(5)
    v_mfma_f32_16x16x32_bf16 v[72:75], v[212:215], v[148:151], v[72:75]
    ds_read_b64_tr_b16 v[170:171], v6 offset:768
    v_mfma_f32_16x16x32_bf16 v[84:87], v[212:215], v[152:155], v[84:87]
    ds_read_b128 v[172:175], v3 offset:3840
    v_mfma_f32_16x16x32_bf16 v[96:99], v[212:215], v[156:159], v[96:99]
    ds_read_b128 v[232:235], v2 offset:5120
    v_mfma_f32_16x16x32_bf16 v[76:79], v[216:219], v[156:159], v[76:79]
    ds_read_b64_tr_b16 v[192:193], v7 offset:0
    v_mfma_f32_16x16x32_bf16 v[88:91], v[216:219], v[160:163], v[88:91]
    ds_read_b64_tr_b16 v[194:195], v7 offset:768
    v_mfma_f32_16x16x32_bf16 v[80:83], v[220:223], v[156:159], v[80:83]
    ds_read_b64_tr_b16 v[240:241], v8 offset:0
    v_mfma_f32_16x16x32_bf16 v[92:95], v[220:223], v[160:163], v[92:95]
    ds_read_b64_tr_b16 v[242:243], v8 offset:768
    s_waitcnt lgkmcnt(8)
    v_mfma_f32_16x16x32_bf16 v[72:75], v[224:227], v[152:155], v[72:75]
    ds_read_b64_tr_b16 v[244:245], v6 offset:6144
    v_mfma_f32_16x16x32_bf16 v[84:87], v[224:227], v[156:159], v[84:87]
    ds_read_b64_tr_b16 v[246:247], v6 offset:6912
    v_mfma_f32_16x16x32_bf16 v[96:99], v[224:227], v[160:163], v[96:99]
    v_mfma_f32_16x16x32_bf16 v[100:103], v[236:239], v[148:151], v[100:103]
    v_mfma_f32_16x16x32_bf16 v[112:115], v[236:239], v[152:155], v[112:115]
    v_cvt_pk_bf16_f32 v76, v76, v77
    v_mfma_f32_16x16x32_bf16 v[104:107], v[248:251], v[148:151], v[104:107]
    v_cvt_pk_bf16_f32 v77, v78, v79
    v_mfma_f32_16x16x32_bf16 v[116:119], v[248:251], v[152:155], v[116:119]
    ds_write_b64 v20, v[76:77] offset:3072
    v_mfma_f32_16x16x32_bf16 v[108:111], v[252:255], v[148:151], v[108:111]
    v_cvt_pk_bf16_f32 v88, v88, v89
    v_mfma_f32_16x16x32_bf16 v[120:123], v[252:255], v[152:155], v[120:123]
    v_cvt_pk_bf16_f32 v89, v90, v91
    v_mfma_f32_16x16x32_bf16 v[100:103], v[196:199], v[152:155], v[100:103]
    ds_write_b64 v20, v[88:89] offset:6144
    v_mfma_f32_16x16x32_bf16 v[112:115], v[196:199], v[156:159], v[112:115]
    v_cvt_pk_bf16_f32 v80, v80, v81
    v_mfma_f32_16x16x32_bf16 v[104:107], v[200:203], v[152:155], v[104:107]
    ds_read_b128 v[236:239], v3 offset:6400
    v_mfma_f32_16x16x32_bf16 v[116:119], v[200:203], v[156:159], v[116:119]
    v_cvt_pk_bf16_f32 v81, v82, v83
    v_mfma_f32_16x16x32_bf16 v[108:111], v[176:179], v[152:155], v[108:111]
    ds_read_b64_tr_b16 v[248:249], v7 offset:6144
    v_mfma_f32_16x16x32_bf16 v[120:123], v[176:179], v[156:159], v[120:123]
    ds_read_b64_tr_b16 v[250:251], v7 offset:6912
    v_mfma_f32_16x16x32_bf16 v[100:103], v[180:183], v[156:159], v[100:103]
    ds_write_b64 v20, v[80:81] offset:3136
    v_mfma_f32_16x16x32_bf16 v[112:115], v[180:183], v[160:163], v[112:115]
    v_cvt_pk_bf16_f32 v92, v92, v93
    v_mfma_f32_16x16x32_bf16 v[104:107], v[184:187], v[156:159], v[104:107]
    ds_read_b64_tr_b16 v[148:149], v8 offset:6144
    v_mfma_f32_16x16x32_bf16 v[116:119], v[184:187], v[160:163], v[116:119]
    ds_read_b64_tr_b16 v[150:151], v8 offset:6912
    v_mfma_f32_16x16x32_bf16 v[108:111], v[188:191], v[156:159], v[108:111]
    v_cvt_pk_bf16_f32 v93, v94, v95
    v_mfma_f32_16x16x32_bf16 v[120:123], v[188:191], v[160:163], v[120:123]
    ds_write_b64 v20, v[92:93] offset:6208
    v_mfma_f32_16x16x32_bf16 v[100:103], v[204:207], v[160:163], v[100:103]
    ds_read_b64_tr_b16 v[252:253], v6 offset:12288
    v_mfma_f32_16x16x32_bf16 v[112:115], v[204:207], v[228:231], v[112:115]
    ds_read_b64_tr_b16 v[254:255], v6 offset:13056
    v_mfma_f32_16x16x32_bf16 v[104:107], v[208:211], v[160:163], v[104:107]
    v_cvt_pk_bf16_f32 v72, v72, v73
    v_mfma_f32_16x16x32_bf16 v[116:119], v[208:211], v[228:231], v[116:119]
    ds_read_b128 v[196:199], v2 offset:7680
    v_mfma_f32_16x16x32_bf16 v[108:111], v[212:215], v[160:163], v[108:111]
    v_cvt_pk_bf16_f32 v73, v74, v75
    v_mfma_f32_16x16x32_bf16 v[120:123], v[212:215], v[228:231], v[120:123]
    ds_read_b64_tr_b16 v[200:201], v7 offset:12288
    v_mfma_f32_16x16x32_bf16 v[100:103], v[216:219], v[228:231], v[100:103]
    ds_read_b64_tr_b16 v[202:203], v7 offset:13056
    v_mfma_f32_16x16x32_bf16 v[112:115], v[216:219], v[164:167], v[112:115]
    ds_write_b64 v20, v[72:73] offset:128
    v_mfma_f32_16x16x32_bf16 v[104:107], v[220:223], v[228:231], v[104:107]
    v_cvt_pk_bf16_f32 v84, v84, v85
    v_mfma_f32_16x16x32_bf16 v[116:119], v[220:223], v[164:167], v[116:119]
    ds_read_b64_tr_b16 v[152:153], v8 offset:12288
    v_mfma_f32_16x16x32_bf16 v[108:111], v[224:227], v[228:231], v[108:111]
    ds_read_b64_tr_b16 v[154:155], v8 offset:13056
    v_mfma_f32_16x16x32_bf16 v[120:123], v[224:227], v[164:167], v[120:123]
    v_cvt_pk_bf16_f32 v85, v86, v87
    s_waitcnt lgkmcnt(5)
    v_mfma_f32_16x16x32_bf16 v[100:103], v[168:171], v[172:175], v[100:103]
    ds_write_b64 v20, v[84:85] offset:3200
    v_mfma_f32_16x16x32_bf16 v[112:115], v[168:171], v[232:235], v[112:115]
    ds_read_b64_tr_b16 v[176:177], v6 offset:18432
    v_mfma_f32_16x16x32_bf16 v[104:107], v[192:195], v[172:175], v[104:107]
    ds_read_b64_tr_b16 v[178:179], v6 offset:19200
    v_mfma_f32_16x16x32_bf16 v[116:119], v[192:195], v[232:235], v[116:119]
    v_cvt_pk_bf16_f32 v96, v96, v97
    v_mfma_f32_16x16x32_bf16 v[108:111], v[240:243], v[172:175], v[108:111]
    ds_read_b128 v[180:183], v3 offset:8960
    v_mfma_f32_16x16x32_bf16 v[120:123], v[240:243], v[232:235], v[120:123]
    v_cvt_pk_bf16_f32 v97, v98, v99
    v_mfma_f32_16x16x32_bf16 v[100:103], v[244:247], v[232:235], v[100:103]
    ds_read_b64_tr_b16 v[184:185], v7 offset:18432
    ds_read_b64_tr_b16 v[186:187], v7 offset:19200
    v_mfma_f32_16x16x32_bf16 v[112:115], v[244:247], v[236:239], v[112:115]
    ds_write_b64 v20, v[96:97] offset:6272
    v_mfma_f32_16x16x32_bf16 v[104:107], v[248:251], v[232:235], v[104:107]
    ds_read_b64_tr_b16 v[156:157], v8 offset:18432
    ds_read_b64_tr_b16 v[158:159], v8 offset:19200
    v_mfma_f32_16x16x32_bf16 v[116:119], v[248:251], v[236:239], v[116:119]
    ds_read_b64_tr_b16 v[188:189], v6 offset:24576
    v_mfma_f32_16x16x32_bf16 v[108:111], v[148:151], v[232:235], v[108:111]
    ds_read_b64_tr_b16 v[190:191], v6 offset:25344
    v_mfma_f32_16x16x32_bf16 v[120:123], v[148:151], v[236:239], v[120:123]
    ds_read_b128 v[204:207], v2 offset:10240
    v_mfma_f32_16x16x32_bf16 v[100:103], v[252:255], v[236:239], v[100:103]
    ds_read_b64_tr_b16 v[208:209], v7 offset:24576
    ds_read_b64_tr_b16 v[210:211], v7 offset:25344
    v_mfma_f32_16x16x32_bf16 v[112:115], v[252:255], v[196:199], v[112:115]
    ds_read_b64_tr_b16 v[160:161], v8 offset:24576
    s_waitcnt lgkmcnt(11)
    v_mfma_f32_16x16x32_bf16 v[104:107], v[200:203], v[236:239], v[104:107]
    s_waitcnt lgkmcnt(8)
    s_barrier
    ds_read_b64_tr_b16 v[162:163], v8 offset:25344
    v_mfma_f32_16x16x32_bf16 v[116:119], v[200:203], v[196:199], v[116:119]
    ds_read_b128 v[212:215], v3 offset:11520
    v_mfma_f32_16x16x32_bf16 v[108:111], v[152:155], v[236:239], v[108:111]
    ds_read_b128 v[216:219], v2 offset:12800
    v_mfma_f32_16x16x32_bf16 v[120:123], v[152:155], v[196:199], v[120:123]
    v_mfma_f32_16x16x32_bf16 v[100:103], v[176:179], v[196:199], v[100:103]
    v_mfma_f32_16x16x32_bf16 v[112:115], v[176:179], v[180:183], v[112:115]
    ds_read_b64_tr_b16 v[220:221], v6 offset:30720
    v_mfma_f32_16x16x32_bf16 v[104:107], v[184:187], v[196:199], v[104:107]
    ds_read_b64_tr_b16 v[222:223], v6 offset:31488
    v_mfma_f32_16x16x32_bf16 v[116:119], v[184:187], v[180:183], v[116:119]
    ds_read_b128 v[228:231], v27 offset:6400
    s_waitcnt lgkmcnt(6)
    v_mfma_f32_16x16x32_bf16 v[108:111], v[156:159], v[196:199], v[108:111]
    ds_read_b128 v[164:167], v26 offset:7680
    v_mfma_f32_16x16x32_bf16 v[120:123], v[156:159], v[180:183], v[120:123]
    ds_read_b64_tr_b16 v[224:225], v7 offset:30720
    v_mfma_f32_16x16x32_bf16 v[100:103], v[188:191], v[180:183], v[100:103]
    ds_read_b64_tr_b16 v[226:227], v7 offset:31488
    v_mfma_f32_16x16x32_bf16 v[112:115], v[188:191], v[204:207], v[112:115]
    ds_read_b64_tr_b16 v[172:173], v8 offset:30720
    v_mfma_f32_16x16x32_bf16 v[104:107], v[208:211], v[180:183], v[104:107]
    ds_read_b64_tr_b16 v[174:175], v8 offset:31488
    v_mfma_f32_16x16x32_bf16 v[116:119], v[208:211], v[204:207], v[116:119]
    ds_read_b64_tr_b16 v[232:233], v6 offset:36864
    s_waitcnt lgkmcnt(8)
    v_mfma_f32_16x16x32_bf16 v[108:111], v[160:163], v[180:183], v[108:111]
    ds_read_b64_tr_b16 v[234:235], v6 offset:37632
    v_mfma_f32_16x16x32_bf16 v[120:123], v[160:163], v[204:207], v[120:123]
    v_mfma_f32_16x16x32_bf16 v[124:127], v[168:171], v[236:239], v[124:127]
    v_mfma_f32_16x16x32_bf16 v[136:139], v[168:171], v[196:199], v[136:139]
    ds_read_b128 v[168:171], v27 offset:8960
    v_mfma_f32_16x16x32_bf16 v[128:131], v[192:195], v[236:239], v[128:131]
    v_cvt_pk_bf16_f32 v100, v100, v101
    v_mfma_f32_16x16x32_bf16 v[140:143], v[192:195], v[196:199], v[140:143]
    v_cvt_pk_bf16_f32 v101, v102, v103
    v_mfma_f32_16x16x32_bf16 v[132:135], v[240:243], v[236:239], v[132:135]
    ds_write_b64 v20, v[100:101] offset:9216
    v_mfma_f32_16x16x32_bf16 v[144:147], v[240:243], v[196:199], v[144:147]
    v_cvt_pk_bf16_f32 v112, v112, v113
    v_mfma_f32_16x16x32_bf16 v[124:127], v[244:247], v[196:199], v[124:127]
    v_cvt_pk_bf16_f32 v113, v114, v115
    v_mfma_f32_16x16x32_bf16 v[136:139], v[244:247], v[180:183], v[136:139]
    ds_write_b64 v20, v[112:113] offset:12288
    v_mfma_f32_16x16x32_bf16 v[128:131], v[248:251], v[196:199], v[128:131]
    v_cvt_pk_bf16_f32 v104, v104, v105
    v_mfma_f32_16x16x32_bf16 v[140:143], v[248:251], v[180:183], v[140:143]
    v_cvt_pk_bf16_f32 v105, v106, v107
    v_mfma_f32_16x16x32_bf16 v[132:135], v[148:151], v[196:199], v[132:135]
    ds_write_b64 v20, v[104:105] offset:9280
    v_mfma_f32_16x16x32_bf16 v[144:147], v[148:151], v[180:183], v[144:147]
    v_cvt_pk_bf16_f32 v116, v116, v117
    v_mfma_f32_16x16x32_bf16 v[124:127], v[252:255], v[180:183], v[124:127]
    v_cvt_pk_bf16_f32 v117, v118, v119
    v_mfma_f32_16x16x32_bf16 v[136:139], v[252:255], v[204:207], v[136:139]
    ds_read_b64_tr_b16 v[192:193], v7 offset:36864
    v_mfma_f32_16x16x32_bf16 v[128:131], v[200:203], v[180:183], v[128:131]
    ds_read_b64_tr_b16 v[194:195], v7 offset:37632
    v_mfma_f32_16x16x32_bf16 v[140:143], v[200:203], v[204:207], v[140:143]
    ds_write_b64 v20, v[116:117] offset:12352
    v_mfma_f32_16x16x32_bf16 v[132:135], v[152:155], v[180:183], v[132:135]
    v_cvt_pk_bf16_f32 v108, v108, v109
    v_mfma_f32_16x16x32_bf16 v[144:147], v[152:155], v[204:207], v[144:147]
    ds_read_b64_tr_b16 v[236:237], v8 offset:36864
    v_mfma_f32_16x16x32_bf16 v[124:127], v[176:179], v[204:207], v[124:127]
    ds_read_b64_tr_b16 v[238:239], v8 offset:37632
    v_mfma_f32_16x16x32_bf16 v[136:139], v[176:179], v[212:215], v[136:139]
    v_cvt_pk_bf16_f32 v109, v110, v111
    v_mfma_f32_16x16x32_bf16 v[128:131], v[184:187], v[204:207], v[128:131]
    ds_write_b64 v20, v[108:109] offset:9344
    v_mfma_f32_16x16x32_bf16 v[140:143], v[184:187], v[212:215], v[140:143]
    ds_read_b64_tr_b16 v[240:241], v6 offset:43008
    v_mfma_f32_16x16x32_bf16 v[132:135], v[156:159], v[204:207], v[132:135]
    ds_read_b64_tr_b16 v[242:243], v6 offset:43776
    v_mfma_f32_16x16x32_bf16 v[144:147], v[156:159], v[212:215], v[144:147]
    v_cvt_pk_bf16_f32 v120, v120, v121
    v_mfma_f32_16x16x32_bf16 v[124:127], v[188:191], v[212:215], v[124:127]
    ds_read_b128 v[244:247], v26 offset:10240
    v_mfma_f32_16x16x32_bf16 v[136:139], v[188:191], v[216:219], v[136:139]
    v_cvt_pk_bf16_f32 v121, v122, v123
    v_mfma_f32_16x16x32_bf16 v[128:131], v[208:211], v[212:215], v[128:131]
    ds_read_b64_tr_b16 v[248:249], v7 offset:43008
    v_mfma_f32_16x16x32_bf16 v[140:143], v[208:211], v[216:219], v[140:143]
    ds_read_b64_tr_b16 v[250:251], v7 offset:43776
    v_mfma_f32_16x16x32_bf16 v[132:135], v[160:163], v[212:215], v[132:135]
    ds_write_b64 v20, v[120:121] offset:12416
    v_mfma_f32_16x16x32_bf16 v[144:147], v[160:163], v[216:219], v[144:147]
    ds_read_b64_tr_b16 v[196:197], v8 offset:43008
    s_waitcnt lgkmcnt(6)
    v_mfma_f32_16x16x32_bf16 v[124:127], v[220:223], v[228:231], v[124:127]
    ds_read_b64_tr_b16 v[198:199], v8 offset:43776
    v_mfma_f32_16x16x32_bf16 v[136:139], v[220:223], v[164:167], v[136:139]
    ds_read_b64_tr_b16 v[148:149], v6 offset:49152
    v_mfma_f32_16x16x32_bf16 v[128:131], v[224:227], v[228:231], v[128:131]
    ds_read_b64_tr_b16 v[150:151], v6 offset:49920
    v_mfma_f32_16x16x32_bf16 v[140:143], v[224:227], v[164:167], v[140:143]
    ds_read_b128 v[252:255], v27 offset:11520
    v_mfma_f32_16x16x32_bf16 v[132:135], v[172:175], v[228:231], v[132:135]
    ds_read_b64_tr_b16 v[200:201], v7 offset:49152
    v_mfma_f32_16x16x32_bf16 v[144:147], v[172:175], v[164:167], v[144:147]
    ds_read_b64_tr_b16 v[202:203], v7 offset:49920
    v_mfma_f32_16x16x32_bf16 v[124:127], v[232:235], v[164:167], v[124:127]
    ds_read_b64_tr_b16 v[180:181], v8 offset:49152
    v_mfma_f32_16x16x32_bf16 v[136:139], v[232:235], v[168:171], v[136:139]
    ds_read_b64_tr_b16 v[182:183], v8 offset:49920
    v_mfma_f32_16x16x32_bf16 v[128:131], v[192:195], v[164:167], v[128:131]
    s_waitcnt lgkmcnt(9)
    s_barrier
    v_mfma_f32_16x16x32_bf16 v[140:143], v[192:195], v[168:171], v[140:143]
    ds_read_b64_tr_b16 v[152:153], v6 offset:55296
    v_mfma_f32_16x16x32_bf16 v[132:135], v[236:239], v[164:167], v[132:135]
    ds_read_b64_tr_b16 v[154:155], v6 offset:56064
    v_mfma_f32_16x16x32_bf16 v[144:147], v[236:239], v[168:171], v[144:147]
    ds_read_b128 v[176:179], v26 offset:12800
    v_mfma_f32_16x16x32_bf16 v[124:127], v[240:243], v[168:171], v[124:127]
    ds_read_b64_tr_b16 v[184:185], v7 offset:55296
    ds_read_b64_tr_b16 v[186:187], v7 offset:56064
    v_mfma_f32_16x16x32_bf16 v[136:139], v[240:243], v[244:247], v[136:139]
    ds_read_b64_tr_b16 v[204:205], v8 offset:55296
    v_mfma_f32_16x16x32_bf16 v[128:131], v[248:251], v[168:171], v[128:131]
    ds_read_b64_tr_b16 v[206:207], v8 offset:56064
    v_mfma_f32_16x16x32_bf16 v[140:143], v[248:251], v[244:247], v[140:143]
    s_waitcnt lgkmcnt(7)
    v_mfma_f32_16x16x32_bf16 v[132:135], v[196:199], v[168:171], v[132:135]
    v_mfma_f32_16x16x32_bf16 v[144:147], v[196:199], v[244:247], v[144:147]
    v_mfma_f32_16x16x32_bf16 v[124:127], v[148:151], v[244:247], v[124:127]
    v_mfma_f32_16x16x32_bf16 v[136:139], v[148:151], v[252:255], v[136:139]
    v_mfma_f32_16x16x32_bf16 v[128:131], v[200:203], v[244:247], v[128:131]
    v_mfma_f32_16x16x32_bf16 v[140:143], v[200:203], v[252:255], v[140:143]
    v_mfma_f32_16x16x32_bf16 v[132:135], v[180:183], v[244:247], v[132:135]
    v_mfma_f32_16x16x32_bf16 v[144:147], v[180:183], v[252:255], v[144:147]
    s_waitcnt lgkmcnt(0)
    v_mfma_f32_16x16x32_bf16 v[124:127], v[152:155], v[252:255], v[124:127]
    v_mfma_f32_16x16x32_bf16 v[136:139], v[152:155], v[176:179], v[136:139]
    v_mfma_f32_16x16x32_bf16 v[128:131], v[184:187], v[252:255], v[128:131]
    v_mfma_f32_16x16x32_bf16 v[140:143], v[184:187], v[176:179], v[140:143]
    v_mfma_f32_16x16x32_bf16 v[132:135], v[204:207], v[252:255], v[132:135]
    v_mfma_f32_16x16x32_bf16 v[144:147], v[204:207], v[176:179], v[144:147]
    s_nop 7
    v_cvt_pk_bf16_f32 v124, v124, v125
    v_cvt_pk_bf16_f32 v125, v126, v127
    ds_write_b64 v20, v[124:125] offset:15360
    v_cvt_pk_bf16_f32 v136, v136, v137
    v_cvt_pk_bf16_f32 v137, v138, v139
    ds_write_b64 v20, v[136:137] offset:18432
    v_cvt_pk_bf16_f32 v128, v128, v129
    v_cvt_pk_bf16_f32 v129, v130, v131
    ds_write_b64 v20, v[128:129] offset:15424
    v_cvt_pk_bf16_f32 v140, v140, v141
    v_cvt_pk_bf16_f32 v141, v142, v143
    ds_write_b64 v20, v[140:141] offset:18496
    v_cvt_pk_bf16_f32 v132, v132, v133
    v_cvt_pk_bf16_f32 v133, v134, v135
    ds_write_b64 v20, v[132:133] offset:15488
    v_cvt_pk_bf16_f32 v144, v144, v145
    v_cvt_pk_bf16_f32 v145, v146, v147
    ds_write_b64 v20, v[144:145] offset:18560
    s_waitcnt lgkmcnt(0)
    s_barrier
    s_branch L_store
L_cls3:
    s_waitcnt lgkmcnt(0)
    v_and_b32 v15, 15, v1
    v_lshrrev_b32 v17, 4, v1
    v_bfe_u32 v18, v1, 2, 2
    v_lshl_add_u32 v18, v17, 3, v18
    v_mul_u32_u24 v18, 192, v18
    v_and_b32 v19, 3, v1
    v_lshl_add_u32 v18, v19, 3, v18
    v_add_u32 v18, 69120, v18
    v_and_b32 v19, 1, v17
    v_lshlrev_b32 v19, 5, v19
    s_lshl_b32 s20, s17, 5
    s_add_u32 s21, s20, 64
    s_add_u32 s22, s20, 128
    v_xor_b32 v6, s20, v19
    v_add_u32 v6, v6, v18
    v_xor_b32 v7, s21, v19
    v_add_u32 v7, v7, v18
    v_xor_b32 v8, s22, v19
    v_add_u32 v8, v8, v18
    s_and_b32 s3, s18, 1
    s_lshl_b32 s3, s3, 1
    v_xor_b32 v16, s3, v17
    s_mul_i32 s25, s18, 1280
    v_lshrrev_b32 v18, 1, v15
    v_and_b32 v18, 2, v18
    v_xor_b32 v18, v18, v16
    v_lshlrev_b32 v18, 4, v18
    v_lshl_add_u32 v18, v15, 6, v18
    v_add_u32 v4, s25, v18
    v_xor_b32 v5, 32, v4
    s_barrier
    ds_read_b64_tr_b16 v[192:193], v6 offset:0
    ds_read_b64_tr_b16 v[194:195], v6 offset:768
    ds_read_b128 v[148:151], v4 offset:0
    ds_read_b64_tr_b16 v[196:197], v7 offset:0
    ds_read_b64_tr_b16 v[198:199], v7 offset:768
    ds_read_b64_tr_b16 v[200:201], v8 offset:0
    ds_read_b64_tr_b16 v[202:203], v8 offset:768
    s_waitcnt lgkmcnt(4)
    v_mfma_f32_16x16x32_bf16 v[64:67], v[192:195], v[148:151], 0
    s_waitcnt lgkmcnt(2)
    v_mfma_f32_16x16x32_bf16 v[68:71], v[196:199], v[148:151], 0
    s_waitcnt lgkmcnt(0)
    v_mfma_f32_16x16x32_bf16 v[72:75], v[200:203], v[148:151], 0
    v_add_u32 v19, 1, v15
    v_lshrrev_b32 v18, 1, v19
    v_and_b32 v18, 2, v18
    v_xor_b32 v18, v18, v16
    v_lshlrev_b32 v18, 4, v18
    v_lshl_add_u32 v18, v19, 6, v18
    v_add_u32 v2, s25, v18
    v_xor_b32 v3, 32, v2
    v_lshrrev_b32 v18, 1, v17
    s_lshl_b32 s3, s17, 1
    v_add_u32 v18, s3, v18
    v_bfe_u32 v19, v15, 1, 2
    s_barrier
    ds_read_b128 v[152:155], v5 offset:1280
    ds_read_b64_tr_b16 v[188:189], v6 offset:6144
    ds_read_b64_tr_b16 v[190:191], v6 offset:6912
    ds_read_b64_tr_b16 v[204:205], v7 offset:6144
    ds_read_b64_tr_b16 v[206:207], v7 offset:6912
    ds_read_b64_tr_b16 v[208:209], v8 offset:6144
    ds_read_b64_tr_b16 v[210:211], v8 offset:6912
    s_waitcnt lgkmcnt(6)
    v_mfma_f32_16x16x32_bf16 v[76:79], v[192:195], v[152:155], 0
    v_mfma_f32_16x16x32_bf16 v[80:83], v[196:199], v[152:155], 0
    v_mfma_f32_16x16x32_bf16 v[84:87], v[200:203], v[152:155], 0
    s_waitcnt lgkmcnt(4)
    v_mfma_f32_16x16x32_bf16 v[64:67], v[188:191], v[152:155], v[64:67]
    s_waitcnt lgkmcnt(2)
    v_mfma_f32_16x16x32_bf16 v[68:71], v[204:207], v[152:155], v[68:71]
    s_waitcnt lgkmcnt(0)
    v_mfma_f32_16x16x32_bf16 v[72:75], v[208:211], v[152:155], v[72:75]
    v_xor_b32 v18, v18, v19
    v_mul_u32_u24 v20, 192, v15
    v_lshl_add_u32 v20, v18, 4, v20
    v_and_b32 v19, 1, v17
    v_lshl_add_u32 v20, v19, 3, v20
    s_mul_i32 s3, s18, 3072
    v_add_u32 v20, s3, v20
    s_mov_b32 s24, 1
    s_mov_b32 s26, 30720
    s_mov_b32 s27, 1
    s_add_u32 s23, s25, 46080
    v_add_u32 v19, 4, v15
    s_barrier
    ds_read_b128 v[156:159], v4 offset:2560
    ds_read_b64_tr_b16 v[212:213], v6 offset:12288
    ds_read_b64_tr_b16 v[214:215], v6 offset:13056
    ds_read_b64_tr_b16 v[216:217], v7 offset:12288
    ds_read_b64_tr_b16 v[218:219], v7 offset:13056
    s_waitcnt lgkmcnt(4)
    v_mfma_f32_16x16x32_bf16 v[88:91], v[192:195], v[156:159], 0
    ds_read_b64_tr_b16 v[220:221], v8 offset:12288
    ds_read_b64_tr_b16 v[222:223], v8 offset:13056
    v_mfma_f32_16x16x32_bf16 v[92:95], v[196:199], v[156:159], 0
    v_mfma_f32_16x16x32_bf16 v[96:99], v[200:203], v[156:159], 0
    v_mfma_f32_16x16x32_bf16 v[76:79], v[188:191], v[156:159], v[76:79]
    v_mfma_f32_16x16x32_bf16 v[80:83], v[204:207], v[156:159], v[80:83]
    v_mfma_f32_16x16x32_bf16 v[84:87], v[208:211], v[156:159], v[84:87]
    s_waitcnt lgkmcnt(4)
    v_mfma_f32_16x16x32_bf16 v[64:67], v[212:215], v[156:159], v[64:67]
    s_waitcnt lgkmcnt(2)
    v_mfma_f32_16x16x32_bf16 v[68:71], v[216:219], v[156:159], v[68:71]
    s_waitcnt lgkmcnt(0)
    v_mfma_f32_16x16x32_bf16 v[72:75], v[220:223], v[156:159], v[72:75]
    v_lshrrev_b32 v18, 1, v19
    v_and_b32 v18, 2, v18
    v_xor_b32 v18, v18, v16
    v_lshlrev_b32 v18, 4, v18
    v_lshl_add_u32 v18, v19, 6, v18
    v_add_u32 v26, s23, v18
    v_xor_b32 v27, 32, v26
    v_lshlrev_b32 v46, 4, v1
    v_add_u32 v47, 0, v1
    v_mul_u32_u24 v48, 5462, v47
    v_lshrrev_b32 v48, 16, v48
    v_mul_u32_u24 v49, 12, v48
    s_barrier
    ds_read_b128 v[160:163], v5 offset:3840
    ds_read_b64_tr_b16 v[224:225], v6 offset:18432
    s_waitcnt lgkmcnt(1)
    v_mfma_f32_16x16x32_bf16 v[100:103], v[192:195], v[160:163], 0
    ds_read_b64_tr_b16 v[226:227], v6 offset:19200
    ds_read_b64_tr_b16 v[228:229], v7 offset:18432
    ds_read_b64_tr_b16 v[230:231], v7 offset:19200
    v_mfma_f32_16x16x32_bf16 v[104:107], v[196:199], v[160:163], 0
    ds_read_b64_tr_b16 v[232:233], v8 offset:18432
    ds_read_b64_tr_b16 v[234:235], v8 offset:19200
    v_mfma_f32_16x16x32_bf16 v[108:111], v[200:203], v[160:163], 0
    v_mfma_f32_16x16x32_bf16 v[88:91], v[188:191], v[160:163], v[88:91]
    v_mfma_f32_16x16x32_bf16 v[92:95], v[204:207], v[160:163], v[92:95]
    v_sub_u32 v49, v47, v49
    v_lshrrev_b32 v43, 2, v49
    v_bfe_u32 v50, v48, 1, 2
    v_xor_b32 v50, v50, v49
    v_and_b32 v50, 3, v50
    v_and_b32 v49, 12, v49
    v_or_b32 v49, v49, v50
    v_mul_u32_u24 v48, 192, v48
    v_lshl_add_u32 v40, v49, 4, v48
    v_add_u32 v47, 64, v1
    v_mul_u32_u24 v48, 5462, v47
    v_lshrrev_b32 v48, 16, v48
    s_barrier
    ds_read_b128 v[164:167], v4 offset:5120
    v_mfma_f32_16x16x32_bf16 v[96:99], v[208:211], v[160:163], v[96:99]
    ds_read_b64_tr_b16 v[236:237], v6 offset:24576
    ds_read_b64_tr_b16 v[238:239], v6 offset:25344
    v_mfma_f32_16x16x32_bf16 v[76:79], v[212:215], v[160:163], v[76:79]
    ds_read_b64_tr_b16 v[240:241], v7 offset:24576
    ds_read_b64_tr_b16 v[242:243], v7 offset:25344
    v_mfma_f32_16x16x32_bf16 v[80:83], v[216:219], v[160:163], v[80:83]
    ds_read_b64_tr_b16 v[244:245], v8 offset:24576
    ds_read_b64_tr_b16 v[246:247], v8 offset:25344
    v_mfma_f32_16x16x32_bf16 v[84:87], v[220:223], v[160:163], v[84:87]
    s_waitcnt lgkmcnt(9)
    v_mfma_f32_16x16x32_bf16 v[64:67], v[224:227], v[160:163], v[64:67]
    v_mfma_f32_16x16x32_bf16 v[68:71], v[228:231], v[160:163], v[68:71]
    s_waitcnt lgkmcnt(7)
    v_mfma_f32_16x16x32_bf16 v[72:75], v[232:235], v[160:163], v[72:75]
    s_waitcnt lgkmcnt(6)
    v_mfma_f32_16x16x32_bf16 v[112:115], v[192:195], v[164:167], 0
    v_mfma_f32_16x16x32_bf16 v[116:119], v[196:199], v[164:167], 0
    v_mfma_f32_16x16x32_bf16 v[120:123], v[200:203], v[164:167], 0
    v_mfma_f32_16x16x32_bf16 v[100:103], v[188:191], v[164:167], v[100:103]
    v_mfma_f32_16x16x32_bf16 v[104:107], v[204:207], v[164:167], v[104:107]
    v_mfma_f32_16x16x32_bf16 v[108:111], v[208:211], v[164:167], v[108:111]
    v_mfma_f32_16x16x32_bf16 v[88:91], v[212:215], v[164:167], v[88:91]
    v_mfma_f32_16x16x32_bf16 v[92:95], v[216:219], v[164:167], v[92:95]
    v_mul_u32_u24 v49, 12, v48
    v_sub_u32 v49, v47, v49
    v_lshrrev_b32 v44, 2, v49
    v_bfe_u32 v50, v48, 1, 2
    v_xor_b32 v50, v50, v49
    v_and_b32 v50, 3, v50
    v_and_b32 v49, 12, v49
    v_or_b32 v49, v49, v50
    v_mul_u32_u24 v48, 192, v48
    v_lshl_add_u32 v41, v49, 4, v48
    v_add_u32 v47, 128, v1
    v_mul_u32_u24 v48, 5462, v47
    s_barrier
    ds_read_b128 v[168:171], v5 offset:6400
    v_mfma_f32_16x16x32_bf16 v[96:99], v[220:223], v[164:167], v[96:99]
    v_mfma_f32_16x16x32_bf16 v[76:79], v[224:227], v[164:167], v[76:79]
    v_mfma_f32_16x16x32_bf16 v[80:83], v[228:231], v[164:167], v[80:83]
    v_mfma_f32_16x16x32_bf16 v[84:87], v[232:235], v[164:167], v[84:87]
    s_waitcnt lgkmcnt(1)
    v_mfma_f32_16x16x32_bf16 v[64:67], v[236:239], v[164:167], v[64:67]
    v_mfma_f32_16x16x32_bf16 v[68:71], v[240:243], v[164:167], v[68:71]
    v_mfma_f32_16x16x32_bf16 v[72:75], v[244:247], v[164:167], v[72:75]
    s_waitcnt lgkmcnt(0)
    v_mfma_f32_16x16x32_bf16 v[124:127], v[192:195], v[168:171], 0
    v_mfma_f32_16x16x32_bf16 v[112:115], v[188:191], v[168:171], v[112:115]
    v_mfma_f32_16x16x32_bf16 v[116:119], v[204:207], v[168:171], v[116:119]
    v_mfma_f32_16x16x32_bf16 v[120:123], v[208:211], v[168:171], v[120:123]
    v_mfma_f32_16x16x32_bf16 v[100:103], v[212:215], v[168:171], v[100:103]
    v_mfma_f32_16x16x32_bf16 v[104:107], v[216:219], v[168:171], v[104:107]
    v_lshrrev_b32 v48, 16, v48
    v_mul_u32_u24 v49, 12, v48
    v_sub_u32 v49, v47, v49
    v_lshrrev_b32 v45, 2, v49
    v_bfe_u32 v50, v48, 1, 2
    v_xor_b32 v50, v50, v49
    v_and_b32 v50, 3, v50
    v_and_b32 v49, 12, v49
    v_or_b32 v49, v49, v50
    v_mul_u32_u24 v48, 192, v48
    v_lshl_add_u32 v42, v49, 4, v48
    s_mov_b32 s76, s8
    s_barrier
    ds_read_b128 v[172:175], v4 offset:7680
    v_mfma_f32_16x16x32_bf16 v[108:111], v[220:223], v[168:171], v[108:111]
    s_mov_b32 s77, s9
    s_mov_b32 s78, 9633792
    v_mfma_f32_16x16x32_bf16 v[88:91], v[224:227], v[168:171], v[88:91]
    s_mov_b32 s79, 0x20000
    s_mov_b32 s85, 3088
    v_mfma_f32_16x16x32_bf16 v[92:95], v[228:231], v[168:171], v[92:95]
    s_barrier
    s_cmp_eq_u32 s14, 1
    v_mfma_f32_16x16x32_bf16 v[96:99], v[232:235], v[168:171], v[96:99]
    ds_read_b128 v[176:179], v5 offset:8960
    s_cselect_b32 s85, 3330, s85
    v_mfma_f32_16x16x32_bf16 v[76:79], v[236:239], v[168:171], v[76:79]
    s_cmp_eq_u32 s14, 2
    s_cselect_b32 s85, 25377, s85
    v_mfma_f32_16x16x32_bf16 v[80:83], v[240:243], v[168:171], v[80:83]
    s_cmp_eq_u32 s14, 3
    s_cselect_b32 s85, 2576, s85
    v_mfma_f32_16x16x32_bf16 v[84:87], v[244:247], v[168:171], v[84:87]
    s_cmp_eq_u32 s14, 4
    s_cselect_b32 s85, 2818, s85
    s_waitcnt lgkmcnt(1)
    v_mfma_f32_16x16x32_bf16 v[124:127], v[188:191], v[172:175], v[124:127]
    s_and_b32 s84, s85, 15
    s_bfe_u32 s86, s85, 0x40004
    v_mfma_f32_16x16x32_bf16 v[112:115], v[212:215], v[172:175], v[112:115]
    s_lshr_b32 s85, s85, 8
    s_mov_b32 s87, 4294751828
    v_mfma_f32_16x16x32_bf16 v[116:119], v[216:219], v[172:175], v[116:119]
    s_cmp_eq_u32 s14, 1
    s_cselect_b32 s87, 4292654682, s87
    v_mfma_f32_16x16x32_bf16 v[120:123], v[220:223], v[172:175], v[120:123]
    s_cmp_eq_u32 s14, 2
    ds_read_b128 v[180:183], v4 offset:10240
    v_mfma_f32_16x16x32_bf16 v[100:103], v[224:227], v[172:175], v[100:103]
    s_cselect_b32 s87, 4294751834, s87
    s_cmp_eq_u32 s14, 3
    v_mfma_f32_16x16x32_bf16 v[104:107], v[228:231], v[172:175], v[104:107]
    s_cselect_b32 s87, 4294945108, s87
    s_cmp_eq_u32 s14, 4
    v_mfma_f32_16x16x32_bf16 v[108:111], v[232:235], v[172:175], v[108:111]
    s_cselect_b32 s87, 4294949460, s87
    s_lshl_b32 s3, s16, 2
    v_mfma_f32_16x16x32_bf16 v[88:91], v[236:239], v[172:175], v[88:91]
    ds_read_b128 v[148:151], v2 offset:0
    ds_read_b128 v[152:155], v3 offset:1280
    v_mfma_f32_16x16x32_bf16 v[92:95], v[240:243], v[172:175], v[92:95]
    ds_read_b128 v[156:159], v2 offset:2560
    ds_read_b128 v[160:163], v3 offset:3840
    v_mfma_f32_16x16x32_bf16 v[96:99], v[244:247], v[172:175], v[96:99]
    ds_read_b64_tr_b16 v[192:193], v6 offset:30720
    ds_read_b64_tr_b16 v[194:195], v6 offset:31488
    s_waitcnt lgkmcnt(7)
    v_mfma_f32_16x16x32_bf16 v[124:127], v[212:215], v[176:179], v[124:127]
    ds_read_b64_tr_b16 v[196:197], v7 offset:30720
    ds_read_b64_tr_b16 v[198:199], v7 offset:31488
    ds_read_b128 v[164:167], v2 offset:5120
    v_mfma_f32_16x16x32_bf16 v[112:115], v[224:227], v[176:179], v[112:115]
    ds_read_b128 v[168:171], v3 offset:6400
    ds_read_b128 v[172:175], v2 offset:7680
    ds_read_b64_tr_b16 v[200:201], v8 offset:30720
    v_mfma_f32_16x16x32_bf16 v[116:119], v[228:231], v[176:179], v[116:119]
    ds_read_b64_tr_b16 v[202:203], v8 offset:31488
    s_lshr_b32 s87, s87, s3
    s_and_b32 s87, s87, 15
    v_mfma_f32_16x16x32_bf16 v[120:123], v[232:235], v[176:179], v[120:123]
    ds_read_b128 v[184:187], v5 offset:11520
    s_add_u32 s80, s15, s87
    s_mul_i32 s80, s80, 43008
    v_mfma_f32_16x16x32_bf16 v[100:103], v[236:239], v[176:179], v[100:103]
    s_mul_i32 s3, s12, 192
    s_add_u32 s80, s80, s3
    s_mul_i32 s81, s87, 3072
    v_mfma_f32_16x16x32_bf16 v[104:107], v[240:243], v[176:179], v[104:107]
    v_add_u32 v47, s81, v40
    v_add_u32 v48, s81, v41
    v_add_u32 v49, s81, v42
    v_mfma_f32_16x16x32_bf16 v[108:111], v[244:247], v[176:179], v[108:111]
    s_cmp_eq_u32 s87, 0
    s_cselect_b32 s82, s84, 0
    s_cmp_eq_u32 s87, s85
    s_waitcnt lgkmcnt(10)
    v_mfma_f32_16x16x32_bf16 v[124:127], v[224:227], v[180:183], v[124:127]
    s_cselect_b32 s83, s86, 2
    v_cmp_le_u32 vcc, s82, v43
    v_cmp_ge_u32 s[64:65], s83, v43
    v_mfma_f32_16x16x32_bf16 v[112:115], v[236:239], v[180:183], v[112:115]
    s_nop 0
    s_and_b64 s[64:65], s[64:65], vcc
    v_cmp_le_u32 vcc, s82, v44
    v_mfma_f32_16x16x32_bf16 v[116:119], v[240:243], v[180:183], v[116:119]
    v_cmp_ge_u32 s[66:67], s83, v44
    s_nop 0
    s_and_b64 s[66:67], s[66:67], vcc
    v_cmp_le_u32 vcc, s82, v45
    v_cmp_ge_u32 s[68:69], s83, v45
    s_nop 0
    s_and_b64 s[68:69], s[68:69], vcc
    v_mfma_f32_16x16x32_bf16 v[120:123], v[244:247], v[180:183], v[120:123]
    v_add_u32 v6, 30720, v6
    v_add_u32 v7, 30720, v7
    v_add_u32 v8, 30720, v8
    s_waitcnt lgkmcnt(0)
    v_mfma_f32_16x16x32_bf16 v[124:127], v[236:239], v[184:187], v[124:127]
    s_waitcnt lgkmcnt(0)
    s_waitcnt vmcnt(0)
L_loop3:
    ds_read_b64_tr_b16 v[204:205], v6 offset:6144
    s_waitcnt lgkmcnt(4)
    v_mfma_f32_16x16x32_bf16 v[64:67], v[192:195], v[148:151], v[64:67]
    ds_read_b64_tr_b16 v[206:207], v6 offset:6912
    v_mfma_f32_16x16x32_bf16 v[76:79], v[192:195], v[152:155], v[76:79]
    ds_read_b64_tr_b16 v[208:209], v7 offset:6144
    v_mfma_f32_16x16x32_bf16 v[88:91], v[192:195], v[156:159], v[88:91]
    ds_read_b64_tr_b16 v[210:211], v7 offset:6912
    v_mfma_f32_16x16x32_bf16 v[100:103], v[192:195], v[160:163], v[100:103]
    ds_read_b128 v[176:179], v3 offset:8960
    v_mfma_f32_16x16x32_bf16 v[68:71], v[196:199], v[148:151], v[68:71]
    ds_read_b128 v[180:183], v2 offset:10240
    v_mfma_f32_16x16x32_bf16 v[80:83], v[196:199], v[152:155], v[80:83]
    ds_read_b128 v[184:187], v3 offset:11520
    v_mfma_f32_16x16x32_bf16 v[92:95], v[196:199], v[156:159], v[92:95]
    s_add_u32 s24, s24, 1
    v_mfma_f32_16x16x32_bf16 v[104:107], v[196:199], v[160:163], v[104:107]
    s_cmp_eq_u32 s24, 5
    s_waitcnt lgkmcnt(6)
    v_mfma_f32_16x16x32_bf16 v[72:75], v[200:203], v[148:151], v[72:75]
    s_cselect_b32 s3, 23040, 0
    v_mfma_f32_16x16x32_bf16 v[84:87], v[200:203], v[152:155], v[84:87]
    s_cselect_b32 s24, 0, s24
    v_mfma_f32_16x16x32_bf16 v[96:99], v[200:203], v[156:159], v[96:99]
    s_add_u32 s25, s25, s3
    v_mfma_f32_16x16x32_bf16 v[108:111], v[200:203], v[160:163], v[108:111]
    v_add_u32 v17, s24, v15
    v_mfma_f32_16x16x32_bf16 v[112:115], v[192:195], v[164:167], v[112:115]
    v_lshrrev_b32 v18, 1, v17
    v_mfma_f32_16x16x32_bf16 v[124:127], v[192:195], v[168:171], v[124:127]
    ds_read_b64_tr_b16 v[192:193], v8 offset:6144
    v_mfma_f32_16x16x32_bf16 v[116:119], v[196:199], v[164:167], v[116:119]
    ds_read_b64_tr_b16 v[194:195], v8 offset:6912
    v_mfma_f32_16x16x32_bf16 v[120:123], v[200:203], v[164:167], v[120:123]
    ds_read_b64_tr_b16 v[196:197], v6 offset:12288
    s_waitcnt lgkmcnt(3)
    v_mfma_f32_16x16x32_bf16 v[64:67], v[204:207], v[152:155], v[64:67]
    ds_read_b64_tr_b16 v[198:199], v6 offset:13056
    v_mfma_f32_16x16x32_bf16 v[76:79], v[204:207], v[156:159], v[76:79]
    ds_read_b64_tr_b16 v[200:201], v7 offset:12288
    v_mfma_f32_16x16x32_bf16 v[88:91], v[204:207], v[160:163], v[88:91]
    ds_read_b64_tr_b16 v[202:203], v7 offset:13056
    v_mfma_f32_16x16x32_bf16 v[100:103], v[204:207], v[164:167], v[100:103]
    v_and_b32 v18, 2, v18
    v_mfma_f32_16x16x32_bf16 v[112:115], v[204:207], v[168:171], v[112:115]
    v_xor_b32 v18, v18, v16
    v_mfma_f32_16x16x32_bf16 v[124:127], v[204:207], v[172:175], v[124:127]
    ds_read_b64_tr_b16 v[204:205], v8 offset:12288
    v_mfma_f32_16x16x32_bf16 v[68:71], v[208:211], v[152:155], v[68:71]
    ds_read_b64_tr_b16 v[206:207], v8 offset:13056
    v_mfma_f32_16x16x32_bf16 v[80:83], v[208:211], v[156:159], v[80:83]
    v_lshlrev_b32 v18, 4, v18
    v_mfma_f32_16x16x32_bf16 v[92:95], v[208:211], v[160:163], v[92:95]
    v_lshl_add_u32 v18, v17, 6, v18
    v_mfma_f32_16x16x32_bf16 v[104:107], v[208:211], v[164:167], v[104:107]
    v_add_u32 v2, s25, v18
    v_mfma_f32_16x16x32_bf16 v[116:119], v[208:211], v[168:171], v[116:119]
    ds_read_b64_tr_b16 v[208:209], v6 offset:18432
    s_waitcnt lgkmcnt(3)
    v_mfma_f32_16x16x32_bf16 v[72:75], v[192:195], v[152:155], v[72:75]
    ds_read_b64_tr_b16 v[210:211], v6 offset:19200
    v_mfma_f32_16x16x32_bf16 v[84:87], v[192:195], v[156:159], v[84:87]
    v_xor_b32 v3, 32, v2
    v_mfma_f32_16x16x32_bf16 v[96:99], v[192:195], v[160:163], v[96:99]
    ds_read_b128 v[148:151], v2 offset:0
    v_mfma_f32_16x16x32_bf16 v[108:111], v[192:195], v[164:167], v[108:111]
    ds_read_b128 v[152:155], v3 offset:1280
    v_mfma_f32_16x16x32_bf16 v[120:123], v[192:195], v[168:171], v[120:123]
    ds_read_b64_tr_b16 v[192:193], v7 offset:18432
    v_mfma_f32_16x16x32_bf16 v[64:67], v[196:199], v[156:159], v[64:67]
    ds_read_b64_tr_b16 v[194:195], v7 offset:19200
    v_mfma_f32_16x16x32_bf16 v[76:79], v[196:199], v[160:163], v[76:79]
    v_mfma_f32_16x16x32_bf16 v[88:91], v[196:199], v[164:167], v[88:91]
    v_mfma_f32_16x16x32_bf16 v[100:103], v[196:199], v[168:171], v[100:103]
    v_mfma_f32_16x16x32_bf16 v[112:115], v[196:199], v[172:175], v[112:115]
    v_mfma_f32_16x16x32_bf16 v[124:127], v[196:199], v[176:179], v[124:127]
    ds_read_b64_tr_b16 v[196:197], v8 offset:18432
    v_mfma_f32_16x16x32_bf16 v[68:71], v[200:203], v[156:159], v[68:71]
    ds_read_b64_tr_b16 v[198:199], v8 offset:19200
    v_mfma_f32_16x16x32_bf16 v[80:83], v[200:203], v[160:163], v[80:83]
    v_mfma_f32_16x16x32_bf16 v[92:95], v[200:203], v[164:167], v[92:95]
    v_mfma_f32_16x16x32_bf16 v[104:107], v[200:203], v[168:171], v[104:107]
    v_mfma_f32_16x16x32_bf16 v[116:119], v[200:203], v[172:175], v[116:119]
    ds_read_b64_tr_b16 v[200:201], v6 offset:24576
    s_waitcnt lgkmcnt(3)
    v_mfma_f32_16x16x32_bf16 v[72:75], v[204:207], v[156:159], v[72:75]
    ds_read_b64_tr_b16 v[202:203], v6 offset:25344
    v_mfma_f32_16x16x32_bf16 v[84:87], v[204:207], v[160:163], v[84:87]
    s_add_u32 s26, s26, 30720
    v_mfma_f32_16x16x32_bf16 v[96:99], v[204:207], v[164:167], v[96:99]
    s_cmp_eq_u32 s26, 92160
    v_mfma_f32_16x16x32_bf16 v[108:111], v[204:207], v[168:171], v[108:111]
    s_cselect_b32 s33, 4294875136, 0
    v_mfma_f32_16x16x32_bf16 v[120:123], v[204:207], v[172:175], v[120:123]
    ds_read_b64_tr_b16 v[204:205], v7 offset:24576
    v_mfma_f32_16x16x32_bf16 v[64:67], v[208:211], v[160:163], v[64:67]
    ds_read_b64_tr_b16 v[206:207], v7 offset:25344
    v_mfma_f32_16x16x32_bf16 v[76:79], v[208:211], v[164:167], v[76:79]
    s_cselect_b32 s26, 0, s26
    v_mfma_f32_16x16x32_bf16 v[88:91], v[208:211], v[168:171], v[88:91]
    s_add_u32 s33, s33, 30720
    v_mfma_f32_16x16x32_bf16 v[100:103], v[208:211], v[172:175], v[100:103]
    ds_read_b128 v[156:159], v2 offset:2560
    v_mfma_f32_16x16x32_bf16 v[112:115], v[208:211], v[176:179], v[112:115]
    v_mfma_f32_16x16x32_bf16 v[124:127], v[208:211], v[180:183], v[124:127]
    ds_read_b64_tr_b16 v[208:209], v8 offset:24576
    v_mfma_f32_16x16x32_bf16 v[68:71], v[192:195], v[160:163], v[68:71]
    ds_read_b64_tr_b16 v[210:211], v8 offset:25344
    v_mfma_f32_16x16x32_bf16 v[80:83], v[192:195], v[164:167], v[80:83]
    v_add_u32 v6, s33, v6
    v_mfma_f32_16x16x32_bf16 v[92:95], v[192:195], v[168:171], v[92:95]
    v_add_u32 v7, s33, v7
    v_mfma_f32_16x16x32_bf16 v[104:107], v[192:195], v[172:175], v[104:107]
    v_add_u32 v8, s33, v8
    v_mfma_f32_16x16x32_bf16 v[116:119], v[192:195], v[176:179], v[116:119]
    s_waitcnt lgkmcnt(3)
    v_mfma_f32_16x16x32_bf16 v[72:75], v[196:199], v[160:163], v[72:75]
    ds_read_b128 v[160:163], v3 offset:3840
    v_mfma_f32_16x16x32_bf16 v[84:87], v[196:199], v[164:167], v[84:87]
    s_waitcnt lgkmcnt(1)
    s_barrier
    v_mfma_f32_16x16x32_bf16 v[96:99], v[196:199], v[168:171], v[96:99]
    ds_read_b64_tr_b16 v[192:193], v6 offset:0
    v_mfma_f32_16x16x32_bf16 v[108:111], v[196:199], v[172:175], v[108:111]
    ds_read_b64_tr_b16 v[194:195], v6 offset:768
    v_mfma_f32_16x16x32_bf16 v[120:123], v[196:199], v[176:179], v[120:123]
    ds_read_b64_tr_b16 v[196:197], v7 offset:0
    v_mfma_f32_16x16x32_bf16 v[64:67], v[200:203], v[164:167], v[64:67]
    ds_read_b64_tr_b16 v[198:199], v7 offset:768
    v_mfma_f32_16x16x32_bf16 v[76:79], v[200:203], v[168:171], v[76:79]
    v_mfma_f32_16x16x32_bf16 v[88:91], v[200:203], v[172:175], v[88:91]
    v_mfma_f32_16x16x32_bf16 v[68:71], v[204:207], v[164:167], v[68:71]
    v_mfma_f32_16x16x32_bf16 v[80:83], v[204:207], v[168:171], v[80:83]
    v_mfma_f32_16x16x32_bf16 v[92:95], v[204:207], v[172:175], v[92:95]
    v_mfma_f32_16x16x32_bf16 v[72:75], v[208:211], v[164:167], v[72:75]
    ds_read_b128 v[164:167], v2 offset:5120
    v_mfma_f32_16x16x32_bf16 v[84:87], v[208:211], v[168:171], v[84:87]
    ds_read_b128 v[168:171], v3 offset:6400
    v_mfma_f32_16x16x32_bf16 v[96:99], v[208:211], v[172:175], v[96:99]
    ds_read_b128 v[172:175], v2 offset:7680
    v_mfma_f32_16x16x32_bf16 v[100:103], v[200:203], v[176:179], v[100:103]
    v_mfma_f32_16x16x32_bf16 v[112:115], v[200:203], v[180:183], v[112:115]
    v_mfma_f32_16x16x32_bf16 v[124:127], v[200:203], v[184:187], v[124:127]
    ds_read_b64_tr_b16 v[200:201], v8 offset:0
    v_mfma_f32_16x16x32_bf16 v[104:107], v[204:207], v[176:179], v[104:107]
    ds_read_b64_tr_b16 v[202:203], v8 offset:768
    v_mfma_f32_16x16x32_bf16 v[116:119], v[204:207], v[180:183], v[116:119]
    v_mfma_f32_16x16x32_bf16 v[108:111], v[208:211], v[176:179], v[108:111]
    v_mfma_f32_16x16x32_bf16 v[120:123], v[208:211], v[180:183], v[120:123]
    ds_read_b64_tr_b16 v[204:205], v6 offset:6144
    s_waitcnt lgkmcnt(4)
    v_mfma_f32_16x16x32_bf16 v[64:67], v[192:195], v[148:151], v[64:67]
    ds_read_b64_tr_b16 v[206:207], v6 offset:6912
    v_mfma_f32_16x16x32_bf16 v[76:79], v[192:195], v[152:155], v[76:79]
    ds_read_b64_tr_b16 v[208:209], v7 offset:6144
    v_mfma_f32_16x16x32_bf16 v[88:91], v[192:195], v[156:159], v[88:91]
    ds_read_b64_tr_b16 v[210:211], v7 offset:6912
    v_mfma_f32_16x16x32_bf16 v[100:103], v[192:195], v[160:163], v[100:103]
    ds_read_b128 v[176:179], v3 offset:8960
    v_mfma_f32_16x16x32_bf16 v[68:71], v[196:199], v[148:151], v[68:71]
    ds_read_b128 v[180:183], v2 offset:10240
    v_mfma_f32_16x16x32_bf16 v[80:83], v[196:199], v[152:155], v[80:83]
    ds_read_b128 v[184:187], v3 offset:11520
    v_mfma_f32_16x16x32_bf16 v[92:95], v[196:199], v[156:159], v[92:95]
    s_add_u32 s24, s24, 1
    v_mfma_f32_16x16x32_bf16 v[104:107], v[196:199], v[160:163], v[104:107]
    s_cmp_eq_u32 s24, 5
    s_waitcnt lgkmcnt(6)
    v_mfma_f32_16x16x32_bf16 v[72:75], v[200:203], v[148:151], v[72:75]
    s_cselect_b32 s3, 23040, 0
    v_mfma_f32_16x16x32_bf16 v[84:87], v[200:203], v[152:155], v[84:87]
    s_cselect_b32 s24, 0, s24
    v_mfma_f32_16x16x32_bf16 v[96:99], v[200:203], v[156:159], v[96:99]
    s_add_u32 s25, s25, s3
    v_mfma_f32_16x16x32_bf16 v[108:111], v[200:203], v[160:163], v[108:111]
    v_add_u32 v17, s24, v15
    v_mfma_f32_16x16x32_bf16 v[112:115], v[192:195], v[164:167], v[112:115]
    v_lshrrev_b32 v18, 1, v17
    v_mfma_f32_16x16x32_bf16 v[124:127], v[192:195], v[168:171], v[124:127]
    ds_read_b64_tr_b16 v[192:193], v8 offset:6144
    v_mfma_f32_16x16x32_bf16 v[116:119], v[196:199], v[164:167], v[116:119]
    ds_read_b64_tr_b16 v[194:195], v8 offset:6912
    v_mfma_f32_16x16x32_bf16 v[120:123], v[200:203], v[164:167], v[120:123]
    ds_read_b64_tr_b16 v[196:197], v6 offset:12288
    s_waitcnt lgkmcnt(3)
    v_mfma_f32_16x16x32_bf16 v[64:67], v[204:207], v[152:155], v[64:67]
    ds_read_b64_tr_b16 v[198:199], v6 offset:13056
    v_mfma_f32_16x16x32_bf16 v[76:79], v[204:207], v[156:159], v[76:79]
    ds_read_b64_tr_b16 v[200:201], v7 offset:12288
    v_mfma_f32_16x16x32_bf16 v[88:91], v[204:207], v[160:163], v[88:91]
    ds_read_b64_tr_b16 v[202:203], v7 offset:13056
    v_mfma_f32_16x16x32_bf16 v[100:103], v[204:207], v[164:167], v[100:103]
    v_and_b32 v18, 2, v18
    v_mfma_f32_16x16x32_bf16 v[112:115], v[204:207], v[168:171], v[112:115]
    v_xor_b32 v18, v18, v16
    v_mfma_f32_16x16x32_bf16 v[124:127], v[204:207], v[172:175], v[124:127]
    ds_read_b64_tr_b16 v[204:205], v8 offset:12288
    v_mfma_f32_16x16x32_bf16 v[68:71], v[208:211], v[152:155], v[68:71]
    ds_read_b64_tr_b16 v[206:207], v8 offset:13056
    v_mfma_f32_16x16x32_bf16 v[80:83], v[208:211], v[156:159], v[80:83]
    v_lshlrev_b32 v18, 4, v18
    v_mfma_f32_16x16x32_bf16 v[92:95], v[208:211], v[160:163], v[92:95]
    v_lshl_add_u32 v18, v17, 6, v18
    v_mfma_f32_16x16x32_bf16 v[104:107], v[208:211], v[164:167], v[104:107]
    v_add_u32 v2, s25, v18
    v_mfma_f32_16x16x32_bf16 v[116:119], v[208:211], v[168:171], v[116:119]
    ds_read_b64_tr_b16 v[208:209], v6 offset:18432
    s_waitcnt lgkmcnt(3)
    v_mfma_f32_16x16x32_bf16 v[72:75], v[192:195], v[152:155], v[72:75]
    ds_read_b64_tr_b16 v[210:211], v6 offset:19200
    v_mfma_f32_16x16x32_bf16 v[84:87], v[192:195], v[156:159], v[84:87]
    v_xor_b32 v3, 32, v2
    v_mfma_f32_16x16x32_bf16 v[96:99], v[192:195], v[160:163], v[96:99]
    ds_read_b128 v[148:151], v2 offset:0
    v_mfma_f32_16x16x32_bf16 v[108:111], v[192:195], v[164:167], v[108:111]
    ds_read_b128 v[152:155], v3 offset:1280
    v_mfma_f32_16x16x32_bf16 v[120:123], v[192:195], v[168:171], v[120:123]
    ds_read_b64_tr_b16 v[192:193], v7 offset:18432
    v_mfma_f32_16x16x32_bf16 v[64:67], v[196:199], v[156:159], v[64:67]
    ds_read_b64_tr_b16 v[194:195], v7 offset:19200
    v_mfma_f32_16x16x32_bf16 v[76:79], v[196:199], v[160:163], v[76:79]
    v_mfma_f32_16x16x32_bf16 v[88:91], v[196:199], v[164:167], v[88:91]
    v_mfma_f32_16x16x32_bf16 v[100:103], v[196:199], v[168:171], v[100:103]
    v_mfma_f32_16x16x32_bf16 v[112:115], v[196:199], v[172:175], v[112:115]
    v_mfma_f32_16x16x32_bf16 v[124:127], v[196:199], v[176:179], v[124:127]
    ds_read_b64_tr_b16 v[196:197], v8 offset:18432
    v_mfma_f32_16x16x32_bf16 v[68:71], v[200:203], v[156:159], v[68:71]
    ds_read_b64_tr_b16 v[198:199], v8 offset:19200
    v_mfma_f32_16x16x32_bf16 v[80:83], v[200:203], v[160:163], v[80:83]
    v_mfma_f32_16x16x32_bf16 v[92:95], v[200:203], v[164:167], v[92:95]
    v_mfma_f32_16x16x32_bf16 v[104:107], v[200:203], v[168:171], v[104:107]
    v_mfma_f32_16x16x32_bf16 v[116:119], v[200:203], v[172:175], v[116:119]
    ds_read_b64_tr_b16 v[200:201], v6 offset:24576
    s_waitcnt lgkmcnt(3)
    v_mfma_f32_16x16x32_bf16 v[72:75], v[204:207], v[156:159], v[72:75]
    ds_read_b64_tr_b16 v[202:203], v6 offset:25344
    v_mfma_f32_16x16x32_bf16 v[84:87], v[204:207], v[160:163], v[84:87]
    s_add_u32 s26, s26, 30720
    v_mfma_f32_16x16x32_bf16 v[96:99], v[204:207], v[164:167], v[96:99]
    s_cmp_eq_u32 s26, 92160
    v_mfma_f32_16x16x32_bf16 v[108:111], v[204:207], v[168:171], v[108:111]
    s_cselect_b32 s33, 4294875136, 0
    v_mfma_f32_16x16x32_bf16 v[120:123], v[204:207], v[172:175], v[120:123]
    ds_read_b64_tr_b16 v[204:205], v7 offset:24576
    v_mfma_f32_16x16x32_bf16 v[64:67], v[208:211], v[160:163], v[64:67]
    ds_read_b64_tr_b16 v[206:207], v7 offset:25344
    v_mfma_f32_16x16x32_bf16 v[76:79], v[208:211], v[164:167], v[76:79]
    s_cselect_b32 s26, 0, s26
    v_mfma_f32_16x16x32_bf16 v[88:91], v[208:211], v[168:171], v[88:91]
    s_add_u32 s33, s33, 30720
    v_mfma_f32_16x16x32_bf16 v[100:103], v[208:211], v[172:175], v[100:103]
    ds_read_b128 v[156:159], v2 offset:2560
    v_mfma_f32_16x16x32_bf16 v[112:115], v[208:211], v[176:179], v[112:115]
    v_mfma_f32_16x16x32_bf16 v[124:127], v[208:211], v[180:183], v[124:127]
    ds_read_b64_tr_b16 v[208:209], v8 offset:24576
    v_mfma_f32_16x16x32_bf16 v[68:71], v[192:195], v[160:163], v[68:71]
    ds_read_b64_tr_b16 v[210:211], v8 offset:25344
    v_mfma_f32_16x16x32_bf16 v[80:83], v[192:195], v[164:167], v[80:83]
    v_add_u32 v6, s33, v6
    v_mfma_f32_16x16x32_bf16 v[92:95], v[192:195], v[168:171], v[92:95]
    v_add_u32 v7, s33, v7
    v_mfma_f32_16x16x32_bf16 v[104:107], v[192:195], v[172:175], v[104:107]
    v_add_u32 v8, s33, v8
    v_mfma_f32_16x16x32_bf16 v[116:119], v[192:195], v[176:179], v[116:119]
    s_waitcnt lgkmcnt(3)
    v_mfma_f32_16x16x32_bf16 v[72:75], v[196:199], v[160:163], v[72:75]
    ds_read_b128 v[160:163], v3 offset:3840
    v_mfma_f32_16x16x32_bf16 v[84:87], v[196:199], v[164:167], v[84:87]
    s_waitcnt lgkmcnt(1)
    s_barrier
    v_mfma_f32_16x16x32_bf16 v[96:99], v[196:199], v[168:171], v[96:99]
    ds_read_b64_tr_b16 v[192:193], v6 offset:0
    v_mfma_f32_16x16x32_bf16 v[108:111], v[196:199], v[172:175], v[108:111]
    ds_read_b64_tr_b16 v[194:195], v6 offset:768
    v_mfma_f32_16x16x32_bf16 v[120:123], v[196:199], v[176:179], v[120:123]
    ds_read_b64_tr_b16 v[196:197], v7 offset:0
    v_mfma_f32_16x16x32_bf16 v[64:67], v[200:203], v[164:167], v[64:67]
    ds_read_b64_tr_b16 v[198:199], v7 offset:768
    v_mfma_f32_16x16x32_bf16 v[76:79], v[200:203], v[168:171], v[76:79]
    v_mfma_f32_16x16x32_bf16 v[88:91], v[200:203], v[172:175], v[88:91]
    v_mfma_f32_16x16x32_bf16 v[68:71], v[204:207], v[164:167], v[68:71]
    v_mfma_f32_16x16x32_bf16 v[80:83], v[204:207], v[168:171], v[80:83]
    v_mfma_f32_16x16x32_bf16 v[92:95], v[204:207], v[172:175], v[92:95]
    v_mfma_f32_16x16x32_bf16 v[72:75], v[208:211], v[164:167], v[72:75]
    ds_read_b128 v[164:167], v2 offset:5120
    v_mfma_f32_16x16x32_bf16 v[84:87], v[208:211], v[168:171], v[84:87]
    ds_read_b128 v[168:171], v3 offset:6400
    v_mfma_f32_16x16x32_bf16 v[96:99], v[208:211], v[172:175], v[96:99]
    ds_read_b128 v[172:175], v2 offset:7680
    v_mfma_f32_16x16x32_bf16 v[100:103], v[200:203], v[176:179], v[100:103]
    v_mfma_f32_16x16x32_bf16 v[112:115], v[200:203], v[180:183], v[112:115]
    v_mfma_f32_16x16x32_bf16 v[124:127], v[200:203], v[184:187], v[124:127]
    ds_read_b64_tr_b16 v[200:201], v8 offset:0
    v_mfma_f32_16x16x32_bf16 v[104:107], v[204:207], v[176:179], v[104:107]
    ds_read_b64_tr_b16 v[202:203], v8 offset:768
    v_mfma_f32_16x16x32_bf16 v[116:119], v[204:207], v[180:183], v[116:119]
    v_mfma_f32_16x16x32_bf16 v[108:111], v[208:211], v[176:179], v[108:111]
    s_add_u32 s27, s27, 2
    v_mfma_f32_16x16x32_bf16 v[120:123], v[208:211], v[180:183], v[120:123]
    s_cmp_lt_u32 s27, 13
    s_cbranch_scc1 L_loop3
    ds_read_b64_tr_b16 v[172:173], v6 offset:6144
    ds_read_b64_tr_b16 v[174:175], v6 offset:6912
    ds_read_b64_tr_b16 v[176:177], v7 offset:6144
    s_waitcnt lgkmcnt(10)
    v_mfma_f32_16x16x32_bf16 v[64:67], v[192:195], v[148:151], v[64:67]
    ds_read_b64_tr_b16 v[178:179], v7 offset:6912
    ds_read_b64_tr_b16 v[180:181], v8 offset:6144
    ds_read_b64_tr_b16 v[182:183], v8 offset:6912
    v_mfma_f32_16x16x32_bf16 v[76:79], v[192:195], v[152:155], v[76:79]
    ds_read_b64_tr_b16 v[184:185], v6 offset:12288
    ds_read_b64_tr_b16 v[186:187], v6 offset:13056
    s_waitcnt lgkmcnt(13)
    v_mfma_f32_16x16x32_bf16 v[68:71], v[196:199], v[148:151], v[68:71]
    ds_read_b64_tr_b16 v[188:189], v7 offset:12288
    ds_read_b64_tr_b16 v[190:191], v7 offset:13056
    v_mfma_f32_16x16x32_bf16 v[80:83], v[196:199], v[152:155], v[80:83]
    ds_read_b64_tr_b16 v[204:205], v8 offset:12288
    ds_read_b64_tr_b16 v[206:207], v8 offset:13056
    s_waitcnt lgkmcnt(12)
    v_mfma_f32_16x16x32_bf16 v[72:75], v[200:203], v[148:151], v[72:75]
    ds_read_b64_tr_b16 v[208:209], v6 offset:18432
    ds_read_b64_tr_b16 v[210:211], v6 offset:19200
    v_mfma_f32_16x16x32_bf16 v[84:87], v[200:203], v[152:155], v[84:87]
    ds_read_b64_tr_b16 v[212:213], v7 offset:18432
    ds_read_b64_tr_b16 v[214:215], v7 offset:19200
    s_waitcnt lgkmcnt(14)
    v_mfma_f32_16x16x32_bf16 v[64:67], v[172:175], v[152:155], v[64:67]
    ds_read_b64_tr_b16 v[216:217], v8 offset:18432
    ds_read_b64_tr_b16 v[218:219], v8 offset:19200
    v_mfma_f32_16x16x32_bf16 v[76:79], v[172:175], v[156:159], v[76:79]
    ds_read_b64_tr_b16 v[220:221], v6 offset:24576
    ds_read_b64_tr_b16 v[222:223], v6 offset:25344
    s_waitcnt lgkmcnt(15)
    v_mfma_f32_16x16x32_bf16 v[68:71], v[176:179], v[152:155], v[68:71]
    ds_read_b64_tr_b16 v[224:225], v7 offset:24576
    ds_read_b64_tr_b16 v[226:227], v7 offset:25344
    v_mfma_f32_16x16x32_bf16 v[80:83], v[176:179], v[156:159], v[80:83]
    ds_read_b64_tr_b16 v[228:229], v8 offset:24576
    ds_read_b64_tr_b16 v[230:231], v8 offset:25344
    s_waitcnt lgkmcnt(15)
    v_mfma_f32_16x16x32_bf16 v[72:75], v[180:183], v[152:155], v[72:75]
    ds_read_b64_tr_b16 v[232:233], v6 offset:30720
    ds_read_b64_tr_b16 v[234:235], v6 offset:31488
    v_mfma_f32_16x16x32_bf16 v[84:87], v[180:183], v[156:159], v[84:87]
    ds_read_b128 v[236:239], v26 offset:0
    ds_read_b128 v[240:243], v27 offset:1280
    v_mfma_f32_16x16x32_bf16 v[64:67], v[184:187], v[156:159], v[64:67]
    ds_read_b64_tr_b16 v[244:245], v7 offset:30720
    ds_read_b64_tr_b16 v[246:247], v7 offset:31488
    v_mfma_f32_16x16x32_bf16 v[76:79], v[184:187], v[160:163], v[76:79]
    ds_read_b64_tr_b16 v[248:249], v8 offset:30720
    ds_read_b64_tr_b16 v[250:251], v8 offset:31488
    s_waitcnt lgkmcnt(15)
    v_mfma_f32_16x16x32_bf16 v[68:71], v[188:191], v[156:159], v[68:71]
    ds_read_b64_tr_b16 v[252:253], v6 offset:36864
    ds_read_b64_tr_b16 v[254:255], v6 offset:37632
    v_mfma_f32_16x16x32_bf16 v[80:83], v[188:191], v[160:163], v[80:83]
    ds_read_b128 v[192:195], v26 offset:2560
    ds_read_b64_tr_b16 v[196:197], v7 offset:36864
    v_mfma_f32_16x16x32_bf16 v[72:75], v[204:207], v[156:159], v[72:75]
    ds_read_b64_tr_b16 v[198:199], v7 offset:37632
    v_mfma_f32_16x16x32_bf16 v[84:87], v[204:207], v[160:163], v[84:87]
    ds_read_b64_tr_b16 v[148:149], v8 offset:36864
    v_mfma_f32_16x16x32_bf16 v[64:67], v[208:211], v[160:163], v[64:67]
    ds_read_b64_tr_b16 v[150:151], v8 offset:37632
    v_mfma_f32_16x16x32_bf16 v[76:79], v[208:211], v[164:167], v[76:79]
    ds_read_b64_tr_b16 v[200:201], v6 offset:43008
    v_mfma_f32_16x16x32_bf16 v[68:71], v[212:215], v[160:163], v[68:71]
    ds_read_b64_tr_b16 v[202:203], v6 offset:43776
    v_mfma_f32_16x16x32_bf16 v[80:83], v[212:215], v[164:167], v[80:83]
    ds_read_b128 v[172:175], v27 offset:3840
    s_waitcnt lgkmcnt(10)
    v_mfma_f32_16x16x32_bf16 v[72:75], v[216:219], v[160:163], v[72:75]
    ds_read_b64_tr_b16 v[176:177], v7 offset:43008
    v_mfma_f32_16x16x32_bf16 v[84:87], v[216:219], v[164:167], v[84:87]
    ds_read_b64_tr_b16 v[178:179], v7 offset:43776
    v_mfma_f32_16x16x32_bf16 v[64:67], v[220:223], v[164:167], v[64:67]
    ds_read_b64_tr_b16 v[152:153], v8 offset:43008
    v_mfma_f32_16x16x32_bf16 v[76:79], v[220:223], v[168:171], v[76:79]
    ds_read_b64_tr_b16 v[154:155], v8 offset:43776
    v_mfma_f32_16x16x32_bf16 v[68:71], v[224:227], v[164:167], v[68:71]
    ds_read_b64_tr_b16 v[180:181], v6 offset:49152
    v_mfma_f32_16x16x32_bf16 v[80:83], v[224:227], v[168:171], v[80:83]
    ds_read_b64_tr_b16 v[182:183], v6 offset:49920
    v_mfma_f32_16x16x32_bf16 v[72:75], v[228:231], v[164:167], v[72:75]
    ds_read_b128 v[184:187], v26 offset:5120
    v_mfma_f32_16x16x32_bf16 v[84:87], v[228:231], v[168:171], v[84:87]
    ds_read_b64_tr_b16 v[188:189], v7 offset:49152
    v_mfma_f32_16x16x32_bf16 v[64:67], v[232:235], v[236:239], v[64:67]
    ds_read_b64_tr_b16 v[190:191], v7 offset:49920
    v_mfma_f32_16x16x32_bf16 v[76:79], v[232:235], v[240:243], v[76:79]
    ds_read_b64_tr_b16 v[156:157], v8 offset:49152
    v_mfma_f32_16x16x32_bf16 v[68:71], v[244:247], v[236:239], v[68:71]
    ds_read_b64_tr_b16 v[158:159], v8 offset:49920
    v_mfma_f32_16x16x32_bf16 v[80:83], v[244:247], v[240:243], v[80:83]
    ds_read_b64_tr_b16 v[204:205], v6 offset:55296
    v_mfma_f32_16x16x32_bf16 v[72:75], v[248:251], v[236:239], v[72:75]
    ds_read_b64_tr_b16 v[206:207], v6 offset:56064
    v_mfma_f32_16x16x32_bf16 v[84:87], v[248:251], v[240:243], v[84:87]
    ds_read_b128 v[208:211], v27 offset:6400
    s_waitcnt lgkmcnt(8)
    v_mfma_f32_16x16x32_bf16 v[64:67], v[252:255], v[240:243], v[64:67]
    ds_read_b64_tr_b16 v[212:213], v7 offset:55296
    v_mfma_f32_16x16x32_bf16 v[76:79], v[252:255], v[192:195], v[76:79]
    ds_read_b64_tr_b16 v[214:215], v7 offset:56064
    v_mfma_f32_16x16x32_bf16 v[68:71], v[196:199], v[240:243], v[68:71]
    ds_read_b64_tr_b16 v[160:161], v8 offset:55296
    v_mfma_f32_16x16x32_bf16 v[80:83], v[196:199], v[192:195], v[80:83]
    ds_read_b64_tr_b16 v[162:163], v8 offset:56064
    v_mfma_f32_16x16x32_bf16 v[72:75], v[148:151], v[240:243], v[72:75]
    ds_read_b128 v[216:219], v26 offset:7680
    v_mfma_f32_16x16x32_bf16 v[84:87], v[148:151], v[192:195], v[84:87]
    v_mfma_f32_16x16x32_bf16 v[64:67], v[200:203], v[192:195], v[64:67]
    v_mfma_f32_16x16x32_bf16 v[76:79], v[200:203], v[172:175], v[76:79]
    v_mfma_f32_16x16x32_bf16 v[68:71], v[176:179], v[192:195], v[68:71]
    ds_read_b128 v[220:223], v27 offset:8960
    v_mfma_f32_16x16x32_bf16 v[80:83], v[176:179], v[172:175], v[80:83]
    v_mfma_f32_16x16x32_bf16 v[72:75], v[152:155], v[192:195], v[72:75]
    v_mfma_f32_16x16x32_bf16 v[84:87], v[152:155], v[172:175], v[84:87]
    v_mfma_f32_16x16x32_bf16 v[64:67], v[180:183], v[172:175], v[64:67]
    s_waitcnt lgkmcnt(1)
    v_mfma_f32_16x16x32_bf16 v[76:79], v[180:183], v[184:187], v[76:79]
    ds_read_b64_tr_b16 v[224:225], v6 offset:0
    ds_read_b64_tr_b16 v[226:227], v6 offset:768
    v_mfma_f32_16x16x32_bf16 v[68:71], v[188:191], v[172:175], v[68:71]
    ds_read_b128 v[164:167], v2 offset:2560
    ds_read_b128 v[168:171], v3 offset:3840
    v_mfma_f32_16x16x32_bf16 v[80:83], v[188:191], v[184:187], v[80:83]
    ds_read_b64_tr_b16 v[228:229], v7 offset:0
    ds_read_b64_tr_b16 v[230:231], v7 offset:768
    v_mfma_f32_16x16x32_bf16 v[72:75], v[156:159], v[172:175], v[72:75]
    v_mfma_f32_16x16x32_bf16 v[84:87], v[156:159], v[184:187], v[84:87]
    ds_read_b64_tr_b16 v[236:237], v8 offset:0
    ds_read_b64_tr_b16 v[238:239], v8 offset:768
    v_mfma_f32_16x16x32_bf16 v[64:67], v[204:207], v[184:187], v[64:67]
    v_mfma_f32_16x16x32_bf16 v[76:79], v[204:207], v[208:211], v[76:79]
    ds_read_b64_tr_b16 v[240:241], v6 offset:6144
    ds_read_b64_tr_b16 v[242:243], v6 offset:6912
    v_mfma_f32_16x16x32_bf16 v[68:71], v[212:215], v[184:187], v[68:71]
    v_mfma_f32_16x16x32_bf16 v[80:83], v[212:215], v[208:211], v[80:83]
    v_mfma_f32_16x16x32_bf16 v[72:75], v[160:163], v[184:187], v[72:75]
    v_mfma_f32_16x16x32_bf16 v[84:87], v[160:163], v[208:211], v[84:87]
    v_mfma_f32_16x16x32_bf16 v[88:91], v[232:235], v[192:195], v[88:91]
    v_mfma_f32_16x16x32_bf16 v[100:103], v[232:235], v[172:175], v[100:103]
    ds_read_b128 v[232:235], v2 offset:5120
    v_mfma_f32_16x16x32_bf16 v[92:95], v[244:247], v[192:195], v[92:95]
    v_cvt_pk_bf16_f32 v64, v64, v65
    v_cvt_pk_bf16_f32 v65, v66, v67
    v_mfma_f32_16x16x32_bf16 v[104:107], v[244:247], v[172:175], v[104:107]
    ds_read_b64_tr_b16 v[244:245], v7 offset:6144
    ds_read_b64_tr_b16 v[246:247], v7 offset:6912
    v_mfma_f32_16x16x32_bf16 v[96:99], v[248:251], v[192:195], v[96:99]
    ds_read_b64_tr_b16 v[192:193], v8 offset:6144
    ds_read_b64_tr_b16 v[194:195], v8 offset:6912
    v_mfma_f32_16x16x32_bf16 v[108:111], v[248:251], v[172:175], v[108:111]
    ds_read_b64_tr_b16 v[248:249], v6 offset:12288
    ds_read_b64_tr_b16 v[250:251], v6 offset:13056
    v_mfma_f32_16x16x32_bf16 v[88:91], v[252:255], v[172:175], v[88:91]
    ds_write_b64 v20, v[64:65] offset:0
    v_cvt_pk_bf16_f32 v76, v76, v77
    v_mfma_f32_16x16x32_bf16 v[100:103], v[252:255], v[184:187], v[100:103]
    ds_read_b128 v[252:255], v3 offset:6400
    v_cvt_pk_bf16_f32 v77, v78, v79
    v_mfma_f32_16x16x32_bf16 v[92:95], v[196:199], v[172:175], v[92:95]
    ds_write_b64 v20, v[76:77] offset:3072
    v_cvt_pk_bf16_f32 v68, v68, v69
    v_mfma_f32_16x16x32_bf16 v[104:107], v[196:199], v[184:187], v[104:107]
    ds_read_b64_tr_b16 v[196:197], v7 offset:12288
    ds_read_b64_tr_b16 v[198:199], v7 offset:13056
    v_mfma_f32_16x16x32_bf16 v[96:99], v[148:151], v[172:175], v[96:99]
    ds_read_b64_tr_b16 v[172:173], v8 offset:12288
    ds_read_b64_tr_b16 v[174:175], v8 offset:13056
    v_mfma_f32_16x16x32_bf16 v[108:111], v[148:151], v[184:187], v[108:111]
    ds_read_b64_tr_b16 v[148:149], v6 offset:18432
    v_mfma_f32_16x16x32_bf16 v[88:91], v[200:203], v[184:187], v[88:91]
    ds_read_b64_tr_b16 v[150:151], v6 offset:19200
    v_mfma_f32_16x16x32_bf16 v[100:103], v[200:203], v[208:211], v[100:103]
    ds_read_b128 v[200:203], v2 offset:7680
    v_mfma_f32_16x16x32_bf16 v[92:95], v[176:179], v[184:187], v[92:95]
    v_cvt_pk_bf16_f32 v69, v70, v71
    v_mfma_f32_16x16x32_bf16 v[104:107], v[176:179], v[208:211], v[104:107]
    ds_read_b64_tr_b16 v[176:177], v7 offset:18432
    v_mfma_f32_16x16x32_bf16 v[96:99], v[152:155], v[184:187], v[96:99]
    ds_read_b64_tr_b16 v[178:179], v7 offset:19200
    v_mfma_f32_16x16x32_bf16 v[108:111], v[152:155], v[208:211], v[108:111]
    ds_write_b64 v20, v[68:69] offset:64
    v_mfma_f32_16x16x32_bf16 v[88:91], v[180:183], v[208:211], v[88:91]
    ds_read_b64_tr_b16 v[184:185], v8 offset:18432
    v_mfma_f32_16x16x32_bf16 v[100:103], v[180:183], v[216:219], v[100:103]
    ds_read_b64_tr_b16 v[186:187], v8 offset:19200
    v_mfma_f32_16x16x32_bf16 v[92:95], v[188:191], v[208:211], v[92:95]
    v_cvt_pk_bf16_f32 v80, v80, v81
    v_mfma_f32_16x16x32_bf16 v[104:107], v[188:191], v[216:219], v[104:107]
    v_cvt_pk_bf16_f32 v81, v82, v83
    v_mfma_f32_16x16x32_bf16 v[96:99], v[156:159], v[208:211], v[96:99]
    ds_read_b64_tr_b16 v[152:153], v6 offset:24576
    v_mfma_f32_16x16x32_bf16 v[108:111], v[156:159], v[216:219], v[108:111]
    ds_read_b64_tr_b16 v[154:155], v6 offset:25344
    v_mfma_f32_16x16x32_bf16 v[88:91], v[204:207], v[216:219], v[88:91]
    ds_write_b64 v20, v[80:81] offset:3136
    s_waitcnt lgkmcnt(6)
    v_mfma_f32_16x16x32_bf16 v[100:103], v[204:207], v[220:223], v[100:103]
    ds_read_b128 v[180:183], v3 offset:8960
    v_mfma_f32_16x16x32_bf16 v[92:95], v[212:215], v[216:219], v[92:95]
    v_cvt_pk_bf16_f32 v72, v72, v73
    v_mfma_f32_16x16x32_bf16 v[104:107], v[212:215], v[220:223], v[104:107]
    ds_read_b64_tr_b16 v[188:189], v7 offset:24576
    v_mfma_f32_16x16x32_bf16 v[96:99], v[160:163], v[216:219], v[96:99]
    ds_read_b64_tr_b16 v[190:191], v7 offset:25344
    v_mfma_f32_16x16x32_bf16 v[108:111], v[160:163], v[220:223], v[108:111]
    v_cvt_pk_bf16_f32 v73, v74, v75
    v_mfma_f32_16x16x32_bf16 v[88:91], v[224:227], v[164:167], v[88:91]
    ds_write_b64 v20, v[72:73] offset:128
    v_mfma_f32_16x16x32_bf16 v[100:103], v[224:227], v[168:171], v[100:103]
    ds_read_b64_tr_b16 v[208:209], v8 offset:24576
    v_mfma_f32_16x16x32_bf16 v[92:95], v[228:231], v[164:167], v[92:95]
    ds_read_b64_tr_b16 v[210:211], v8 offset:25344
    v_mfma_f32_16x16x32_bf16 v[104:107], v[228:231], v[168:171], v[104:107]
    v_cvt_pk_bf16_f32 v84, v84, v85
    v_mfma_f32_16x16x32_bf16 v[96:99], v[236:239], v[164:167], v[96:99]
    v_cvt_pk_bf16_f32 v85, v86, v87
    v_mfma_f32_16x16x32_bf16 v[108:111], v[236:239], v[168:171], v[108:111]
    ds_write_b64 v20, v[84:85] offset:3200
    v_mfma_f32_16x16x32_bf16 v[88:91], v[240:243], v[168:171], v[88:91]
    ds_read_b128 v[156:159], v2 offset:10240
    v_mfma_f32_16x16x32_bf16 v[100:103], v[240:243], v[232:235], v[100:103]
    ds_read_b128 v[204:207], v3 offset:11520
    v_mfma_f32_16x16x32_bf16 v[92:95], v[244:247], v[168:171], v[92:95]
    v_mfma_f32_16x16x32_bf16 v[104:107], v[244:247], v[232:235], v[104:107]
    ds_read_b64_tr_b16 v[212:213], v6 offset:30720
    ds_read_b64_tr_b16 v[214:215], v6 offset:31488
    v_mfma_f32_16x16x32_bf16 v[96:99], v[192:195], v[168:171], v[96:99]
    ds_read_b128 v[216:219], v26 offset:5120
    v_mfma_f32_16x16x32_bf16 v[108:111], v[192:195], v[232:235], v[108:111]
    ds_read_b128 v[160:163], v27 offset:6400
    v_mfma_f32_16x16x32_bf16 v[88:91], v[248:251], v[232:235], v[88:91]
    ds_read_b64_tr_b16 v[220:221], v7 offset:30720
    v_mfma_f32_16x16x32_bf16 v[100:103], v[248:251], v[252:255], v[100:103]
    ds_read_b64_tr_b16 v[222:223], v7 offset:31488
    v_mfma_f32_16x16x32_bf16 v[92:95], v[196:199], v[232:235], v[92:95]
    ds_read_b64_tr_b16 v[164:165], v8 offset:30720
    v_mfma_f32_16x16x32_bf16 v[104:107], v[196:199], v[252:255], v[104:107]
    ds_read_b64_tr_b16 v[166:167], v8 offset:31488
    v_mfma_f32_16x16x32_bf16 v[96:99], v[172:175], v[232:235], v[96:99]
    ds_read_b64_tr_b16 v[168:169], v6 offset:36864
    v_mfma_f32_16x16x32_bf16 v[108:111], v[172:175], v[252:255], v[108:111]
    ds_read_b64_tr_b16 v[170:171], v6 offset:37632
    v_mfma_f32_16x16x32_bf16 v[88:91], v[148:151], v[252:255], v[88:91]
    v_mfma_f32_16x16x32_bf16 v[100:103], v[148:151], v[200:203], v[100:103]
    v_mfma_f32_16x16x32_bf16 v[92:95], v[176:179], v[252:255], v[92:95]
    v_mfma_f32_16x16x32_bf16 v[104:107], v[176:179], v[200:203], v[104:107]
    s_waitcnt lgkmcnt(4)
    v_mfma_f32_16x16x32_bf16 v[96:99], v[184:187], v[252:255], v[96:99]
    v_mfma_f32_16x16x32_bf16 v[108:111], v[184:187], v[200:203], v[108:111]
    v_mfma_f32_16x16x32_bf16 v[88:91], v[152:155], v[200:203], v[88:91]
    s_barrier
    v_mfma_f32_16x16x32_bf16 v[100:103], v[152:155], v[180:183], v[100:103]
    v_mfma_f32_16x16x32_bf16 v[92:95], v[188:191], v[200:203], v[92:95]
    v_mfma_f32_16x16x32_bf16 v[104:107], v[188:191], v[180:183], v[104:107]
    v_mfma_f32_16x16x32_bf16 v[96:99], v[208:211], v[200:203], v[96:99]
    v_mfma_f32_16x16x32_bf16 v[108:111], v[208:211], v[180:183], v[108:111]
    v_mfma_f32_16x16x32_bf16 v[112:115], v[224:227], v[232:235], v[112:115]
    v_mfma_f32_16x16x32_bf16 v[124:127], v[224:227], v[252:255], v[124:127]
    ds_read_b128 v[224:227], v26 offset:7680
    v_mfma_f32_16x16x32_bf16 v[116:119], v[228:231], v[232:235], v[116:119]
    v_cvt_pk_bf16_f32 v88, v88, v89
    v_cvt_pk_bf16_f32 v89, v90, v91
    v_mfma_f32_16x16x32_bf16 v[120:123], v[236:239], v[232:235], v[120:123]
    ds_write_b64 v20, v[88:89] offset:6144
    v_cvt_pk_bf16_f32 v100, v100, v101
    v_mfma_f32_16x16x32_bf16 v[112:115], v[240:243], v[252:255], v[112:115]
    v_cvt_pk_bf16_f32 v101, v102, v103
    ds_write_b64 v20, v[100:101] offset:9216
    v_mfma_f32_16x16x32_bf16 v[124:127], v[240:243], v[200:203], v[124:127]
    v_cvt_pk_bf16_f32 v92, v92, v93
    v_cvt_pk_bf16_f32 v93, v94, v95
    v_mfma_f32_16x16x32_bf16 v[116:119], v[244:247], v[252:255], v[116:119]
    ds_write_b64 v20, v[92:93] offset:6208
    ds_read_b64_tr_b16 v[228:229], v7 offset:36864
    v_mfma_f32_16x16x32_bf16 v[120:123], v[192:195], v[252:255], v[120:123]
    ds_read_b64_tr_b16 v[230:231], v7 offset:37632
    v_cvt_pk_bf16_f32 v104, v104, v105
    v_mfma_f32_16x16x32_bf16 v[112:115], v[248:251], v[200:203], v[112:115]
    ds_read_b64_tr_b16 v[232:233], v8 offset:36864
    ds_read_b64_tr_b16 v[234:235], v8 offset:37632
    v_mfma_f32_16x16x32_bf16 v[124:127], v[248:251], v[180:183], v[124:127]
    v_cvt_pk_bf16_f32 v105, v106, v107
    ds_read_b64_tr_b16 v[236:237], v6 offset:43008
    v_mfma_f32_16x16x32_bf16 v[116:119], v[196:199], v[200:203], v[116:119]
    ds_read_b64_tr_b16 v[238:239], v6 offset:43776
    ds_write_b64 v20, v[104:105] offset:9280
    v_mfma_f32_16x16x32_bf16 v[120:123], v[172:175], v[200:203], v[120:123]
    ds_read_b128 v[240:243], v27 offset:8960
    v_cvt_pk_bf16_f32 v96, v96, v97
    v_mfma_f32_16x16x32_bf16 v[112:115], v[148:151], v[180:183], v[112:115]
    ds_read_b64_tr_b16 v[244:245], v7 offset:43008
    ds_read_b64_tr_b16 v[246:247], v7 offset:43776
    v_mfma_f32_16x16x32_bf16 v[124:127], v[148:151], v[156:159], v[124:127]
    v_cvt_pk_bf16_f32 v97, v98, v99
    ds_read_b64_tr_b16 v[192:193], v8 offset:43008
    v_mfma_f32_16x16x32_bf16 v[116:119], v[176:179], v[180:183], v[116:119]
    ds_read_b64_tr_b16 v[194:195], v8 offset:43776
    ds_write_b64 v20, v[96:97] offset:6272
    v_mfma_f32_16x16x32_bf16 v[120:123], v[184:187], v[180:183], v[120:123]
    ds_read_b64_tr_b16 v[252:253], v6 offset:49152
    v_mfma_f32_16x16x32_bf16 v[112:115], v[152:155], v[156:159], v[112:115]
    ds_read_b64_tr_b16 v[254:255], v6 offset:49920
    v_mfma_f32_16x16x32_bf16 v[124:127], v[152:155], v[204:207], v[124:127]
    v_cvt_pk_bf16_f32 v108, v108, v109
    v_mfma_f32_16x16x32_bf16 v[116:119], v[188:191], v[156:159], v[116:119]
    ds_read_b128 v[248:251], v26 offset:10240
    v_mfma_f32_16x16x32_bf16 v[120:123], v[208:211], v[156:159], v[120:123]
    v_cvt_pk_bf16_f32 v109, v110, v111
    v_mfma_f32_16x16x32_bf16 v[112:115], v[212:215], v[216:219], v[112:115]
    ds_read_b64_tr_b16 v[196:197], v7 offset:49152
    ds_read_b64_tr_b16 v[198:199], v7 offset:49920
    v_mfma_f32_16x16x32_bf16 v[124:127], v[212:215], v[160:163], v[124:127]
    ds_write_b64 v20, v[108:109] offset:9344
    ds_read_b64_tr_b16 v[172:173], v8 offset:49152
    v_mfma_f32_16x16x32_bf16 v[116:119], v[220:223], v[216:219], v[116:119]
    ds_read_b64_tr_b16 v[174:175], v8 offset:49920
    ds_read_b64_tr_b16 v[200:201], v6 offset:55296
    s_waitcnt lgkmcnt(9)
    v_mfma_f32_16x16x32_bf16 v[120:123], v[164:167], v[216:219], v[120:123]
    ds_read_b64_tr_b16 v[202:203], v6 offset:56064
    ds_read_b128 v[148:151], v27 offset:11520
    v_mfma_f32_16x16x32_bf16 v[112:115], v[168:171], v[160:163], v[112:115]
    ds_read_b64_tr_b16 v[176:177], v7 offset:55296
    ds_read_b64_tr_b16 v[178:179], v7 offset:56064
    v_mfma_f32_16x16x32_bf16 v[124:127], v[168:171], v[224:227], v[124:127]
    ds_read_b64_tr_b16 v[180:181], v8 offset:55296
    ds_read_b64_tr_b16 v[182:183], v8 offset:56064
    v_mfma_f32_16x16x32_bf16 v[116:119], v[228:231], v[160:163], v[116:119]
    v_mfma_f32_16x16x32_bf16 v[120:123], v[232:235], v[160:163], v[120:123]
    v_mfma_f32_16x16x32_bf16 v[112:115], v[236:239], v[224:227], v[112:115]
    s_waitcnt lgkmcnt(9)
    s_barrier
    v_mfma_f32_16x16x32_bf16 v[124:127], v[236:239], v[240:243], v[124:127]
    v_mfma_f32_16x16x32_bf16 v[116:119], v[244:247], v[224:227], v[116:119]
    v_mfma_f32_16x16x32_bf16 v[120:123], v[192:195], v[224:227], v[120:123]
    v_mfma_f32_16x16x32_bf16 v[112:115], v[252:255], v[240:243], v[112:115]
    v_mfma_f32_16x16x32_bf16 v[124:127], v[252:255], v[248:251], v[124:127]
    v_mfma_f32_16x16x32_bf16 v[116:119], v[196:199], v[240:243], v[116:119]
    s_waitcnt lgkmcnt(0)
    v_mfma_f32_16x16x32_bf16 v[120:123], v[172:175], v[240:243], v[120:123]
    v_mfma_f32_16x16x32_bf16 v[112:115], v[200:203], v[248:251], v[112:115]
    v_mfma_f32_16x16x32_bf16 v[124:127], v[200:203], v[148:151], v[124:127]
    v_mfma_f32_16x16x32_bf16 v[116:119], v[176:179], v[248:251], v[116:119]
    v_mfma_f32_16x16x32_bf16 v[120:123], v[180:183], v[248:251], v[120:123]
    s_nop 7
    v_cvt_pk_bf16_f32 v112, v112, v113
    v_cvt_pk_bf16_f32 v113, v114, v115
    ds_write_b64 v20, v[112:113] offset:12288
    v_cvt_pk_bf16_f32 v124, v124, v125
    v_cvt_pk_bf16_f32 v125, v126, v127
    ds_write_b64 v20, v[124:125] offset:15360
    v_cvt_pk_bf16_f32 v116, v116, v117
    v_cvt_pk_bf16_f32 v117, v118, v119
    ds_write_b64 v20, v[116:117] offset:12352
    v_cvt_pk_bf16_f32 v120, v120, v121
    v_cvt_pk_bf16_f32 v121, v122, v123
    ds_write_b64 v20, v[120:121] offset:12416
    s_waitcnt lgkmcnt(0)
    s_barrier
    s_branch L_store
L_cls4:
    s_waitcnt lgkmcnt(0)
    v_and_b32 v15, 15, v1
    v_lshrrev_b32 v17, 4, v1
    v_bfe_u32 v18, v1, 2, 2
    v_lshl_add_u32 v18, v17, 3, v18
    v_mul_u32_u24 v18, 192, v18
    v_and_b32 v19, 3, v1
    v_lshl_add_u32 v18, v19, 3, v18
    v_add_u32 v18, 69120, v18
    v_and_b32 v19, 1, v17
    v_lshlrev_b32 v19, 5, v19
    s_lshl_b32 s20, s17, 5
    s_add_u32 s21, s20, 64
    s_add_u32 s22, s20, 128
    v_xor_b32 v6, s20, v19
    v_add_u32 v6, v6, v18
    v_xor_b32 v7, s21, v19
    v_add_u32 v7, v7, v18
    v_xor_b32 v8, s22, v19
    v_add_u32 v8, v8, v18
    s_and_b32 s3, s18, 1
    s_lshl_b32 s3, s3, 1
    v_xor_b32 v16, s3, v17
    s_mul_i32 s25, s18, 1280
    v_lshrrev_b32 v18, 1, v15
    v_and_b32 v18, 2, v18
    v_xor_b32 v18, v18, v16
    v_lshlrev_b32 v18, 4, v18
    v_lshl_add_u32 v18, v15, 6, v18
    v_add_u32 v4, s25, v18
    v_xor_b32 v5, 32, v4
    s_barrier
    ds_read_b64_tr_b16 v[196:197], v7 offset:0
    ds_read_b64_tr_b16 v[198:199], v7 offset:768
    ds_read_b128 v[148:151], v4 offset:0
    ds_read_b64_tr_b16 v[200:201], v8 offset:0
    ds_read_b64_tr_b16 v[202:203], v8 offset:768
    ds_read_b64_tr_b16 v[192:193], v6 offset:0
    ds_read_b64_tr_b16 v[194:195], v6 offset:768
    s_waitcnt lgkmcnt(4)
    v_mfma_f32_16x16x32_bf16 v[68:71], v[196:199], v[148:151], 0
    s_waitcnt lgkmcnt(2)
    v_mfma_f32_16x16x32_bf16 v[72:75], v[200:203], v[148:151], 0
    v_add_u32 v19, 1, v15
    v_lshrrev_b32 v18, 1, v19
    v_and_b32 v18, 2, v18
    v_xor_b32 v18, v18, v16
    v_lshlrev_b32 v18, 4, v18
    v_lshl_add_u32 v18, v19, 6, v18
    v_add_u32 v2, s25, v18
    v_xor_b32 v3, 32, v2
    v_lshrrev_b32 v18, 1, v17
    s_lshl_b32 s3, s17, 1
    v_add_u32 v18, s3, v18
    v_bfe_u32 v19, v15, 1, 2
    s_barrier
    ds_read_b128 v[152:155], v5 offset:1280
    ds_read_b64_tr_b16 v[188:189], v7 offset:6144
    ds_read_b64_tr_b16 v[190:191], v7 offset:6912
    ds_read_b64_tr_b16 v[204:205], v8 offset:6144
    ds_read_b64_tr_b16 v[206:207], v8 offset:6912
    s_waitcnt lgkmcnt(4)
    v_mfma_f32_16x16x32_bf16 v[76:79], v[192:195], v[152:155], 0
    ds_read_b64_tr_b16 v[208:209], v6 offset:6144
    ds_read_b64_tr_b16 v[210:211], v6 offset:6912
    v_mfma_f32_16x16x32_bf16 v[80:83], v[196:199], v[152:155], 0
    v_mfma_f32_16x16x32_bf16 v[84:87], v[200:203], v[152:155], 0
    s_waitcnt lgkmcnt(4)
    v_mfma_f32_16x16x32_bf16 v[68:71], v[188:191], v[152:155], v[68:71]
    s_waitcnt lgkmcnt(2)
    v_mfma_f32_16x16x32_bf16 v[72:75], v[204:207], v[152:155], v[72:75]
    v_xor_b32 v18, v18, v19
    v_mul_u32_u24 v20, 192, v15
    v_lshl_add_u32 v20, v18, 4, v20
    v_and_b32 v19, 1, v17
    v_lshl_add_u32 v20, v19, 3, v20
    s_mul_i32 s3, s18, 3072
    v_add_u32 v20, s3, v20
    s_mov_b32 s24, 1
    s_mov_b32 s26, 30720
    s_mov_b32 s27, 1
    s_add_u32 s23, s25, 46080
    v_add_u32 v19, 4, v15
    s_barrier
    ds_read_b128 v[156:159], v4 offset:2560
    ds_read_b64_tr_b16 v[212:213], v7 offset:12288
    ds_read_b64_tr_b16 v[214:215], v7 offset:13056
    ds_read_b64_tr_b16 v[216:217], v8 offset:12288
    ds_read_b64_tr_b16 v[218:219], v8 offset:13056
    s_waitcnt lgkmcnt(4)
    v_mfma_f32_16x16x32_bf16 v[88:91], v[192:195], v[156:159], 0
    ds_read_b64_tr_b16 v[220:221], v6 offset:12288
    ds_read_b64_tr_b16 v[222:223], v6 offset:13056
    v_mfma_f32_16x16x32_bf16 v[92:95], v[196:199], v[156:159], 0
    v_mfma_f32_16x16x32_bf16 v[96:99], v[200:203], v[156:159], 0
    v_mfma_f32_16x16x32_bf16 v[76:79], v[208:211], v[156:159], v[76:79]
    v_mfma_f32_16x16x32_bf16 v[80:83], v[188:191], v[156:159], v[80:83]
    v_mfma_f32_16x16x32_bf16 v[84:87], v[204:207], v[156:159], v[84:87]
    s_waitcnt lgkmcnt(4)
    v_mfma_f32_16x16x32_bf16 v[68:71], v[212:215], v[156:159], v[68:71]
    s_waitcnt lgkmcnt(2)
    v_mfma_f32_16x16x32_bf16 v[72:75], v[216:219], v[156:159], v[72:75]
    v_lshrrev_b32 v18, 1, v19
    v_and_b32 v18, 2, v18
    v_xor_b32 v18, v18, v16
    v_lshlrev_b32 v18, 4, v18
    v_lshl_add_u32 v18, v19, 6, v18
    v_add_u32 v26, s23, v18
    v_xor_b32 v27, 32, v26
    v_lshlrev_b32 v46, 4, v1
    v_add_u32 v47, 0, v1
    v_mul_u32_u24 v48, 5462, v47
    v_lshrrev_b32 v48, 16, v48
    v_mul_u32_u24 v49, 12, v48
    s_barrier
    ds_read_b128 v[160:163], v5 offset:3840
    ds_read_b64_tr_b16 v[224:225], v7 offset:18432
    s_waitcnt lgkmcnt(1)
    v_mfma_f32_16x16x32_bf16 v[100:103], v[192:195], v[160:163], 0
    ds_read_b64_tr_b16 v[226:227], v7 offset:19200
    ds_read_b64_tr_b16 v[228:229], v8 offset:18432
    ds_read_b64_tr_b16 v[230:231], v8 offset:19200
    v_mfma_f32_16x16x32_bf16 v[104:107], v[196:199], v[160:163], 0
    ds_read_b64_tr_b16 v[232:233], v6 offset:18432
    ds_read_b64_tr_b16 v[234:235], v6 offset:19200
    v_mfma_f32_16x16x32_bf16 v[108:111], v[200:203], v[160:163], 0
    v_mfma_f32_16x16x32_bf16 v[88:91], v[208:211], v[160:163], v[88:91]
    v_sub_u32 v49, v47, v49
    v_lshrrev_b32 v43, 2, v49
    v_bfe_u32 v50, v48, 1, 2
    v_xor_b32 v50, v50, v49
    v_and_b32 v50, 3, v50
    v_and_b32 v49, 12, v49
    v_or_b32 v49, v49, v50
    v_mul_u32_u24 v48, 192, v48
    v_lshl_add_u32 v40, v49, 4, v48
    v_add_u32 v47, 64, v1
    v_mul_u32_u24 v48, 5462, v47
    v_lshrrev_b32 v48, 16, v48
    s_barrier
    ds_read_b128 v[164:167], v4 offset:5120
    v_mfma_f32_16x16x32_bf16 v[92:95], v[188:191], v[160:163], v[92:95]
    ds_read_b64_tr_b16 v[236:237], v7 offset:24576
    ds_read_b64_tr_b16 v[238:239], v7 offset:25344
    v_mfma_f32_16x16x32_bf16 v[96:99], v[204:207], v[160:163], v[96:99]
    ds_read_b64_tr_b16 v[240:241], v8 offset:24576
    ds_read_b64_tr_b16 v[242:243], v8 offset:25344
    v_mfma_f32_16x16x32_bf16 v[76:79], v[220:223], v[160:163], v[76:79]
    ds_read_b64_tr_b16 v[244:245], v6 offset:24576
    ds_read_b64_tr_b16 v[246:247], v6 offset:25344
    v_mfma_f32_16x16x32_bf16 v[80:83], v[212:215], v[160:163], v[80:83]
    v_mfma_f32_16x16x32_bf16 v[84:87], v[216:219], v[160:163], v[84:87]
    s_waitcnt lgkmcnt(9)
    v_mfma_f32_16x16x32_bf16 v[68:71], v[224:227], v[160:163], v[68:71]
    v_mfma_f32_16x16x32_bf16 v[72:75], v[228:231], v[160:163], v[72:75]
    s_waitcnt lgkmcnt(6)
    v_mfma_f32_16x16x32_bf16 v[112:115], v[192:195], v[164:167], 0
    v_mfma_f32_16x16x32_bf16 v[116:119], v[196:199], v[164:167], 0
    v_mfma_f32_16x16x32_bf16 v[120:123], v[200:203], v[164:167], 0
    v_mfma_f32_16x16x32_bf16 v[100:103], v[208:211], v[164:167], v[100:103]
    v_mfma_f32_16x16x32_bf16 v[104:107], v[188:191], v[164:167], v[104:107]
    v_mfma_f32_16x16x32_bf16 v[108:111], v[204:207], v[164:167], v[108:111]
    v_mfma_f32_16x16x32_bf16 v[88:91], v[220:223], v[164:167], v[88:91]
    v_mul_u32_u24 v49, 12, v48
    v_sub_u32 v49, v47, v49
    v_lshrrev_b32 v44, 2, v49
    v_bfe_u32 v50, v48, 1, 2
    v_xor_b32 v50, v50, v49
    v_and_b32 v50, 3, v50
    v_and_b32 v49, 12, v49
    v_or_b32 v49, v49, v50
    v_mul_u32_u24 v48, 192, v48
    v_lshl_add_u32 v41, v49, 4, v48
    v_add_u32 v47, 128, v1
    v_mul_u32_u24 v48, 5462, v47
    s_barrier
    ds_read_b128 v[168:171], v5 offset:6400
    v_mfma_f32_16x16x32_bf16 v[92:95], v[212:215], v[164:167], v[92:95]
    v_mfma_f32_16x16x32_bf16 v[96:99], v[216:219], v[164:167], v[96:99]
    v_mfma_f32_16x16x32_bf16 v[76:79], v[232:235], v[164:167], v[76:79]
    v_mfma_f32_16x16x32_bf16 v[80:83], v[224:227], v[164:167], v[80:83]
    v_mfma_f32_16x16x32_bf16 v[84:87], v[228:231], v[164:167], v[84:87]
    s_waitcnt lgkmcnt(1)
    v_mfma_f32_16x16x32_bf16 v[68:71], v[236:239], v[164:167], v[68:71]
    v_mfma_f32_16x16x32_bf16 v[72:75], v[240:243], v[164:167], v[72:75]
    s_waitcnt lgkmcnt(0)
    v_mfma_f32_16x16x32_bf16 v[124:127], v[192:195], v[168:171], 0
    v_mfma_f32_16x16x32_bf16 v[128:131], v[196:199], v[168:171], 0
    v_mfma_f32_16x16x32_bf16 v[112:115], v[208:211], v[168:171], v[112:115]
    v_mfma_f32_16x16x32_bf16 v[116:119], v[188:191], v[168:171], v[116:119]
    v_mfma_f32_16x16x32_bf16 v[120:123], v[204:207], v[168:171], v[120:123]
    v_mfma_f32_16x16x32_bf16 v[100:103], v[220:223], v[168:171], v[100:103]
    v_mfma_f32_16x16x32_bf16 v[104:107], v[212:215], v[168:171], v[104:107]
    v_lshrrev_b32 v48, 16, v48
    v_mul_u32_u24 v49, 12, v48
    v_sub_u32 v49, v47, v49
    v_lshrrev_b32 v45, 2, v49
    v_bfe_u32 v50, v48, 1, 2
    v_xor_b32 v50, v50, v49
    v_and_b32 v50, 3, v50
    v_and_b32 v49, 12, v49
    v_or_b32 v49, v49, v50
    v_mul_u32_u24 v48, 192, v48
    v_lshl_add_u32 v42, v49, 4, v48
    s_mov_b32 s76, s8
    s_barrier
    ds_read_b128 v[172:175], v4 offset:7680
    v_mfma_f32_16x16x32_bf16 v[108:111], v[216:219], v[168:171], v[108:111]
    s_mov_b32 s77, s9
    s_mov_b32 s78, 9633792
    v_mfma_f32_16x16x32_bf16 v[88:91], v[232:235], v[168:171], v[88:91]
    s_mov_b32 s79, 0x20000
    s_mov_b32 s85, 3088
    v_mfma_f32_16x16x32_bf16 v[92:95], v[224:227], v[168:171], v[92:95]
    s_cmp_eq_u32 s14, 1
    s_cselect_b32 s85, 3330, s85
    v_mfma_f32_16x16x32_bf16 v[96:99], v[228:231], v[168:171], v[96:99]
    ds_read_b128 v[176:179], v5 offset:8960
    s_cmp_eq_u32 s14, 2
    v_mfma_f32_16x16x32_bf16 v[76:79], v[244:247], v[168:171], v[76:79]
    s_cselect_b32 s85, 25377, s85
    s_cmp_eq_u32 s14, 3
    v_mfma_f32_16x16x32_bf16 v[80:83], v[236:239], v[168:171], v[80:83]
    s_cselect_b32 s85, 2576, s85
    s_cmp_eq_u32 s14, 4
    v_mfma_f32_16x16x32_bf16 v[84:87], v[240:243], v[168:171], v[84:87]
    s_barrier
    s_cselect_b32 s85, 2818, s85
    s_waitcnt lgkmcnt(1)
    v_mfma_f32_16x16x32_bf16 v[124:127], v[208:211], v[172:175], v[124:127]
    s_and_b32 s84, s85, 15
    s_bfe_u32 s86, s85, 0x40004
    v_mfma_f32_16x16x32_bf16 v[128:131], v[188:191], v[172:175], v[128:131]
    s_lshr_b32 s85, s85, 8
    s_mov_b32 s87, 4294751828
    v_mfma_f32_16x16x32_bf16 v[112:115], v[220:223], v[172:175], v[112:115]
    s_cmp_eq_u32 s14, 1
    s_cselect_b32 s87, 4292654682, s87
    v_mfma_f32_16x16x32_bf16 v[116:119], v[212:215], v[172:175], v[116:119]
    s_cmp_eq_u32 s14, 2
    s_cselect_b32 s87, 4294751834, s87
    v_mfma_f32_16x16x32_bf16 v[120:123], v[216:219], v[172:175], v[120:123]
    ds_read_b128 v[180:183], v4 offset:10240
    s_cmp_eq_u32 s14, 3
    v_mfma_f32_16x16x32_bf16 v[100:103], v[232:235], v[172:175], v[100:103]
    s_cselect_b32 s87, 4294945108, s87
    s_cmp_eq_u32 s14, 4
    v_mfma_f32_16x16x32_bf16 v[104:107], v[224:227], v[172:175], v[104:107]
    s_cselect_b32 s87, 4294949460, s87
    s_lshl_b32 s3, s16, 2
    v_mfma_f32_16x16x32_bf16 v[108:111], v[228:231], v[172:175], v[108:111]
    s_lshr_b32 s87, s87, s3
    s_and_b32 s87, s87, 15
    v_mfma_f32_16x16x32_bf16 v[88:91], v[244:247], v[172:175], v[88:91]
    s_add_u32 s80, s15, s87
    ds_read_b128 v[184:187], v5 offset:11520
    v_mfma_f32_16x16x32_bf16 v[92:95], v[236:239], v[172:175], v[92:95]
    ds_read_b128 v[152:155], v3 offset:1280
    ds_read_b128 v[148:151], v2 offset:0
    v_mfma_f32_16x16x32_bf16 v[96:99], v[240:243], v[172:175], v[96:99]
    ds_read_b128 v[156:159], v2 offset:2560
    ds_read_b64_tr_b16 v[192:193], v6 offset:30720
    s_waitcnt lgkmcnt(6)
    v_mfma_f32_16x16x32_bf16 v[124:127], v[220:223], v[176:179], v[124:127]
    ds_read_b64_tr_b16 v[194:195], v6 offset:31488
    ds_read_b128 v[160:163], v3 offset:3840
    v_mfma_f32_16x16x32_bf16 v[128:131], v[212:215], v[176:179], v[128:131]
    ds_read_b64_tr_b16 v[196:197], v7 offset:30720
    ds_read_b64_tr_b16 v[198:199], v7 offset:31488
    v_mfma_f32_16x16x32_bf16 v[112:115], v[232:235], v[176:179], v[112:115]
    ds_read_b128 v[164:167], v2 offset:5120
    ds_read_b128 v[168:171], v3 offset:6400
    v_mfma_f32_16x16x32_bf16 v[116:119], v[224:227], v[176:179], v[116:119]
    ds_read_b128 v[172:175], v2 offset:7680
    ds_read_b64_tr_b16 v[200:201], v8 offset:30720
    ds_read_b64_tr_b16 v[202:203], v8 offset:31488
    v_mfma_f32_16x16x32_bf16 v[120:123], v[228:231], v[176:179], v[120:123]
    s_mul_i32 s80, s80, 43008
    s_mul_i32 s3, s12, 192
    s_add_u32 s80, s80, s3
    v_mfma_f32_16x16x32_bf16 v[100:103], v[244:247], v[176:179], v[100:103]
    s_mul_i32 s81, s87, 3072
    v_add_u32 v47, s81, v40
    v_mfma_f32_16x16x32_bf16 v[104:107], v[236:239], v[176:179], v[104:107]
    v_add_u32 v48, s81, v41
    v_add_u32 v49, s81, v42
    v_mfma_f32_16x16x32_bf16 v[108:111], v[240:243], v[176:179], v[108:111]
    s_cmp_eq_u32 s87, 0
    s_cselect_b32 s82, s84, 0
    s_waitcnt lgkmcnt(9)
    v_mfma_f32_16x16x32_bf16 v[124:127], v[232:235], v[180:183], v[124:127]
    s_cmp_eq_u32 s87, s85
    s_cselect_b32 s83, s86, 2
    v_mfma_f32_16x16x32_bf16 v[128:131], v[224:227], v[180:183], v[128:131]
    v_cmp_le_u32 vcc, s82, v43
    v_cmp_ge_u32 s[64:65], s83, v43
    v_mfma_f32_16x16x32_bf16 v[112:115], v[244:247], v[180:183], v[112:115]
    s_nop 0
    s_and_b64 s[64:65], s[64:65], vcc
    v_cmp_le_u32 vcc, s82, v44
    v_mfma_f32_16x16x32_bf16 v[116:119], v[236:239], v[180:183], v[116:119]
    v_cmp_ge_u32 s[66:67], s83, v44
    s_nop 0
    s_and_b64 s[66:67], s[66:67], vcc
    v_mfma_f32_16x16x32_bf16 v[120:123], v[240:243], v[180:183], v[120:123]
    v_cmp_le_u32 vcc, s82, v45
    v_cmp_ge_u32 s[68:69], s83, v45
    s_nop 0
    s_and_b64 s[68:69], s[68:69], vcc
    v_mfma_f32_16x16x32_bf16 v[124:127], v[244:247], v[184:187], v[124:127]
    v_add_u32 v6, 30720, v6
    v_add_u32 v7, 30720, v7
    v_add_u32 v8, 30720, v8
    v_mfma_f32_16x16x32_bf16 v[128:131], v[236:239], v[184:187], v[128:131]
    s_waitcnt lgkmcnt(0)
    s_waitcnt vmcnt(0)
L_loop4:
    ds_read_b64_tr_b16 v[204:205], v6 offset:6144
    s_waitcnt lgkmcnt(3)
    v_mfma_f32_16x16x32_bf16 v[76:79], v[192:195], v[152:155], v[76:79]
    ds_read_b64_tr_b16 v[206:207], v6 offset:6912
    v_mfma_f32_16x16x32_bf16 v[88:91], v[192:195], v[156:159], v[88:91]
    ds_read_b64_tr_b16 v[208:209], v7 offset:6144
    v_mfma_f32_16x16x32_bf16 v[100:103], v[192:195], v[160:163], v[100:103]
    ds_read_b64_tr_b16 v[210:211], v7 offset:6912
    v_mfma_f32_16x16x32_bf16 v[68:71], v[196:199], v[148:151], v[68:71]
    ds_read_b128 v[176:179], v3 offset:8960
    v_mfma_f32_16x16x32_bf16 v[80:83], v[196:199], v[152:155], v[80:83]
    ds_read_b128 v[180:183], v2 offset:10240
    v_mfma_f32_16x16x32_bf16 v[92:95], v[196:199], v[156:159], v[92:95]
    ds_read_b128 v[184:187], v3 offset:11520
    v_mfma_f32_16x16x32_bf16 v[104:107], v[196:199], v[160:163], v[104:107]
    s_add_u32 s24, s24, 1
    s_waitcnt lgkmcnt(7)
    v_mfma_f32_16x16x32_bf16 v[72:75], v[200:203], v[148:151], v[72:75]
    s_cmp_eq_u32 s24, 5
    v_mfma_f32_16x16x32_bf16 v[84:87], v[200:203], v[152:155], v[84:87]
    s_cselect_b32 s3, 23040, 0
    v_mfma_f32_16x16x32_bf16 v[96:99], v[200:203], v[156:159], v[96:99]
    s_cselect_b32 s24, 0, s24
    v_mfma_f32_16x16x32_bf16 v[108:111], v[200:203], v[160:163], v[108:111]
    s_add_u32 s25, s25, s3
    v_mfma_f32_16x16x32_bf16 v[112:115], v[192:195], v[164:167], v[112:115]
    v_add_u32 v17, s24, v15
    v_mfma_f32_16x16x32_bf16 v[124:127], v[192:195], v[168:171], v[124:127]
    ds_read_b64_tr_b16 v[192:193], v8 offset:6144
    v_mfma_f32_16x16x32_bf16 v[116:119], v[196:199], v[164:167], v[116:119]
    ds_read_b64_tr_b16 v[194:195], v8 offset:6912
    v_mfma_f32_16x16x32_bf16 v[128:131], v[196:199], v[168:171], v[128:131]
    ds_read_b64_tr_b16 v[196:197], v6 offset:12288
    v_mfma_f32_16x16x32_bf16 v[120:123], v[200:203], v[164:167], v[120:123]
    ds_read_b64_tr_b16 v[198:199], v6 offset:13056
    s_waitcnt lgkmcnt(4)
    v_mfma_f32_16x16x32_bf16 v[76:79], v[204:207], v[156:159], v[76:79]
    ds_read_b64_tr_b16 v[200:201], v7 offset:12288
    v_mfma_f32_16x16x32_bf16 v[88:91], v[204:207], v[160:163], v[88:91]
    ds_read_b64_tr_b16 v[202:203], v7 offset:13056
    v_mfma_f32_16x16x32_bf16 v[100:103], v[204:207], v[164:167], v[100:103]
    v_lshrrev_b32 v18, 1, v17
    v_mfma_f32_16x16x32_bf16 v[112:115], v[204:207], v[168:171], v[112:115]
    v_and_b32 v18, 2, v18
    v_mfma_f32_16x16x32_bf16 v[124:127], v[204:207], v[172:175], v[124:127]
    ds_read_b64_tr_b16 v[204:205], v8 offset:12288
    v_mfma_f32_16x16x32_bf16 v[68:71], v[208:211], v[152:155], v[68:71]
    ds_read_b64_tr_b16 v[206:207], v8 offset:13056
    v_mfma_f32_16x16x32_bf16 v[80:83], v[208:211], v[156:159], v[80:83]
    v_xor_b32 v18, v18, v16
    v_mfma_f32_16x16x32_bf16 v[92:95], v[208:211], v[160:163], v[92:95]
    v_lshlrev_b32 v18, 4, v18
    v_mfma_f32_16x16x32_bf16 v[104:107], v[208:211], v[164:167], v[104:107]
    v_lshl_add_u32 v18, v17, 6, v18
    v_mfma_f32_16x16x32_bf16 v[116:119], v[208:211], v[168:171], v[116:119]
    v_add_u32 v2, s25, v18
    v_mfma_f32_16x16x32_bf16 v[128:131], v[208:211], v[172:175], v[128:131]
    ds_read_b64_tr_b16 v[208:209], v6 offset:18432
    s_waitcnt lgkmcnt(3)
    v_mfma_f32_16x16x32_bf16 v[72:75], v[192:195], v[152:155], v[72:75]
    ds_read_b64_tr_b16 v[210:211], v6 offset:19200
    v_mfma_f32_16x16x32_bf16 v[84:87], v[192:195], v[156:159], v[84:87]
    v_xor_b32 v3, 32, v2
    v_mfma_f32_16x16x32_bf16 v[96:99], v[192:195], v[160:163], v[96:99]
    ds_read_b128 v[152:155], v3 offset:1280
    v_mfma_f32_16x16x32_bf16 v[108:111], v[192:195], v[164:167], v[108:111]
    ds_read_b128 v[148:151], v2 offset:0
    v_mfma_f32_16x16x32_bf16 v[120:123], v[192:195], v[168:171], v[120:123]
    ds_read_b64_tr_b16 v[192:193], v7 offset:18432
    v_mfma_f32_16x16x32_bf16 v[76:79], v[196:199], v[160:163], v[76:79]
    ds_read_b64_tr_b16 v[194:195], v7 offset:19200
    v_mfma_f32_16x16x32_bf16 v[88:91], v[196:199], v[164:167], v[88:91]
    v_mfma_f32_16x16x32_bf16 v[100:103], v[196:199], v[168:171], v[100:103]
    v_mfma_f32_16x16x32_bf16 v[112:115], v[196:199], v[172:175], v[112:115]
    v_mfma_f32_16x16x32_bf16 v[124:127], v[196:199], v[176:179], v[124:127]
    ds_read_b64_tr_b16 v[196:197], v8 offset:18432
    v_mfma_f32_16x16x32_bf16 v[68:71], v[200:203], v[156:159], v[68:71]
    ds_read_b64_tr_b16 v[198:199], v8 offset:19200
    v_mfma_f32_16x16x32_bf16 v[80:83], v[200:203], v[160:163], v[80:83]
    v_mfma_f32_16x16x32_bf16 v[92:95], v[200:203], v[164:167], v[92:95]
    v_mfma_f32_16x16x32_bf16 v[104:107], v[200:203], v[168:171], v[104:107]
    v_mfma_f32_16x16x32_bf16 v[116:119], v[200:203], v[172:175], v[116:119]
    s_add_u32 s26, s26, 30720
    v_mfma_f32_16x16x32_bf16 v[128:131], v[200:203], v[176:179], v[128:131]
    ds_read_b64_tr_b16 v[200:201], v6 offset:24576
    s_waitcnt lgkmcnt(3)
    v_mfma_f32_16x16x32_bf16 v[72:75], v[204:207], v[156:159], v[72:75]
    ds_read_b64_tr_b16 v[202:203], v6 offset:25344
    v_mfma_f32_16x16x32_bf16 v[84:87], v[204:207], v[160:163], v[84:87]
    s_cmp_eq_u32 s26, 92160
    v_mfma_f32_16x16x32_bf16 v[96:99], v[204:207], v[164:167], v[96:99]
    s_cselect_b32 s33, 4294875136, 0
    v_mfma_f32_16x16x32_bf16 v[108:111], v[204:207], v[168:171], v[108:111]
    s_cselect_b32 s26, 0, s26
    v_mfma_f32_16x16x32_bf16 v[120:123], v[204:207], v[172:175], v[120:123]
    ds_read_b64_tr_b16 v[204:205], v7 offset:24576
    v_mfma_f32_16x16x32_bf16 v[76:79], v[208:211], v[164:167], v[76:79]
    ds_read_b64_tr_b16 v[206:207], v7 offset:25344
    v_mfma_f32_16x16x32_bf16 v[88:91], v[208:211], v[168:171], v[88:91]
    s_add_u32 s33, s33, 30720
    v_mfma_f32_16x16x32_bf16 v[100:103], v[208:211], v[172:175], v[100:103]
    ds_read_b128 v[156:159], v2 offset:2560
    v_mfma_f32_16x16x32_bf16 v[112:115], v[208:211], v[176:179], v[112:115]
    v_mfma_f32_16x16x32_bf16 v[124:127], v[208:211], v[180:183], v[124:127]
    ds_read_b64_tr_b16 v[208:209], v8 offset:24576
    v_mfma_f32_16x16x32_bf16 v[68:71], v[192:195], v[160:163], v[68:71]
    ds_read_b64_tr_b16 v[210:211], v8 offset:25344
    v_mfma_f32_16x16x32_bf16 v[80:83], v[192:195], v[164:167], v[80:83]
    v_add_u32 v6, s33, v6
    v_mfma_f32_16x16x32_bf16 v[92:95], v[192:195], v[168:171], v[92:95]
    v_add_u32 v7, s33, v7
    v_mfma_f32_16x16x32_bf16 v[104:107], v[192:195], v[172:175], v[104:107]
    v_add_u32 v8, s33, v8
    v_mfma_f32_16x16x32_bf16 v[116:119], v[192:195], v[176:179], v[116:119]
    v_mfma_f32_16x16x32_bf16 v[128:131], v[192:195], v[180:183], v[128:131]
    s_waitcnt lgkmcnt(2)
    v_mfma_f32_16x16x32_bf16 v[72:75], v[196:199], v[160:163], v[72:75]
    s_waitcnt lgkmcnt(0)
    s_barrier
    v_mfma_f32_16x16x32_bf16 v[84:87], v[196:199], v[164:167], v[84:87]
    ds_read_b64_tr_b16 v[192:193], v6 offset:0
    v_mfma_f32_16x16x32_bf16 v[96:99], v[196:199], v[168:171], v[96:99]
    ds_read_b64_tr_b16 v[194:195], v6 offset:768
    v_mfma_f32_16x16x32_bf16 v[108:111], v[196:199], v[172:175], v[108:111]
    ds_read_b128 v[160:163], v3 offset:3840
    v_mfma_f32_16x16x32_bf16 v[120:123], v[196:199], v[176:179], v[120:123]
    ds_read_b64_tr_b16 v[196:197], v7 offset:0
    v_mfma_f32_16x16x32_bf16 v[76:79], v[200:203], v[168:171], v[76:79]
    ds_read_b64_tr_b16 v[198:199], v7 offset:768
    v_mfma_f32_16x16x32_bf16 v[88:91], v[200:203], v[172:175], v[88:91]
    v_mfma_f32_16x16x32_bf16 v[68:71], v[204:207], v[164:167], v[68:71]
    v_mfma_f32_16x16x32_bf16 v[80:83], v[204:207], v[168:171], v[80:83]
    v_mfma_f32_16x16x32_bf16 v[92:95], v[204:207], v[172:175], v[92:95]
    v_mfma_f32_16x16x32_bf16 v[72:75], v[208:211], v[164:167], v[72:75]
    ds_read_b128 v[164:167], v2 offset:5120
    v_mfma_f32_16x16x32_bf16 v[84:87], v[208:211], v[168:171], v[84:87]
    ds_read_b128 v[168:171], v3 offset:6400
    v_mfma_f32_16x16x32_bf16 v[96:99], v[208:211], v[172:175], v[96:99]
    ds_read_b128 v[172:175], v2 offset:7680
    v_mfma_f32_16x16x32_bf16 v[100:103], v[200:203], v[176:179], v[100:103]
    v_mfma_f32_16x16x32_bf16 v[112:115], v[200:203], v[180:183], v[112:115]
    v_mfma_f32_16x16x32_bf16 v[124:127], v[200:203], v[184:187], v[124:127]
    ds_read_b64_tr_b16 v[200:201], v8 offset:0
    v_mfma_f32_16x16x32_bf16 v[104:107], v[204:207], v[176:179], v[104:107]
    ds_read_b64_tr_b16 v[202:203], v8 offset:768
    v_mfma_f32_16x16x32_bf16 v[116:119], v[204:207], v[180:183], v[116:119]
    v_mfma_f32_16x16x32_bf16 v[128:131], v[204:207], v[184:187], v[128:131]
    v_mfma_f32_16x16x32_bf16 v[108:111], v[208:211], v[176:179], v[108:111]
    v_mfma_f32_16x16x32_bf16 v[120:123], v[208:211], v[180:183], v[120:123]
    ds_read_b64_tr_b16 v[204:205], v6 offset:6144
    s_waitcnt lgkmcnt(3)
    v_mfma_f32_16x16x32_bf16 v[76:79], v[192:195], v[152:155], v[76:79]
    ds_read_b64_tr_b16 v[206:207], v6 offset:6912
    v_mfma_f32_16x16x32_bf16 v[88:91], v[192:195], v[156:159], v[88:91]
    ds_read_b64_tr_b16 v[208:209], v7 offset:6144
    v_mfma_f32_16x16x32_bf16 v[100:103], v[192:195], v[160:163], v[100:103]
    ds_read_b64_tr_b16 v[210:211], v7 offset:6912
    v_mfma_f32_16x16x32_bf16 v[68:71], v[196:199], v[148:151], v[68:71]
    ds_read_b128 v[176:179], v3 offset:8960
    v_mfma_f32_16x16x32_bf16 v[80:83], v[196:199], v[152:155], v[80:83]
    ds_read_b128 v[180:183], v2 offset:10240
    v_mfma_f32_16x16x32_bf16 v[92:95], v[196:199], v[156:159], v[92:95]
    ds_read_b128 v[184:187], v3 offset:11520
    v_mfma_f32_16x16x32_bf16 v[104:107], v[196:199], v[160:163], v[104:107]
    s_add_u32 s24, s24, 1
    s_waitcnt lgkmcnt(7)
    v_mfma_f32_16x16x32_bf16 v[72:75], v[200:203], v[148:151], v[72:75]
    s_cmp_eq_u32 s24, 5
    v_mfma_f32_16x16x32_bf16 v[84:87], v[200:203], v[152:155], v[84:87]
    s_cselect_b32 s3, 23040, 0
    v_mfma_f32_16x16x32_bf16 v[96:99], v[200:203], v[156:159], v[96:99]
    s_cselect_b32 s24, 0, s24
    v_mfma_f32_16x16x32_bf16 v[108:111], v[200:203], v[160:163], v[108:111]
    s_add_u32 s25, s25, s3
    v_mfma_f32_16x16x32_bf16 v[112:115], v[192:195], v[164:167], v[112:115]
    v_add_u32 v17, s24, v15
    v_mfma_f32_16x16x32_bf16 v[124:127], v[192:195], v[168:171], v[124:127]
    ds_read_b64_tr_b16 v[192:193], v8 offset:6144
    v_mfma_f32_16x16x32_bf16 v[116:119], v[196:199], v[164:167], v[116:119]
    ds_read_b64_tr_b16 v[194:195], v8 offset:6912
    v_mfma_f32_16x16x32_bf16 v[128:131], v[196:199], v[168:171], v[128:131]
    ds_read_b64_tr_b16 v[196:197], v6 offset:12288
    v_mfma_f32_16x16x32_bf16 v[120:123], v[200:203], v[164:167], v[120:123]
    ds_read_b64_tr_b16 v[198:199], v6 offset:13056
    s_waitcnt lgkmcnt(4)
    v_mfma_f32_16x16x32_bf16 v[76:79], v[204:207], v[156:159], v[76:79]
    ds_read_b64_tr_b16 v[200:201], v7 offset:12288
    v_mfma_f32_16x16x32_bf16 v[88:91], v[204:207], v[160:163], v[88:91]
    ds_read_b64_tr_b16 v[202:203], v7 offset:13056
    v_mfma_f32_16x16x32_bf16 v[100:103], v[204:207], v[164:167], v[100:103]
    v_lshrrev_b32 v18, 1, v17
    v_mfma_f32_16x16x32_bf16 v[112:115], v[204:207], v[168:171], v[112:115]
    v_and_b32 v18, 2, v18
    v_mfma_f32_16x16x32_bf16 v[124:127], v[204:207], v[172:175], v[124:127]
    ds_read_b64_tr_b16 v[204:205], v8 offset:12288
    v_mfma_f32_16x16x32_bf16 v[68:71], v[208:211], v[152:155], v[68:71]
    ds_read_b64_tr_b16 v[206:207], v8 offset:13056
    v_mfma_f32_16x16x32_bf16 v[80:83], v[208:211], v[156:159], v[80:83]
    v_xor_b32 v18, v18, v16
    v_mfma_f32_16x16x32_bf16 v[92:95], v[208:211], v[160:163], v[92:95]
    v_lshlrev_b32 v18, 4, v18
    v_mfma_f32_16x16x32_bf16 v[104:107], v[208:211], v[164:167], v[104:107]
    v_lshl_add_u32 v18, v17, 6, v18
    v_mfma_f32_16x16x32_bf16 v[116:119], v[208:211], v[168:171], v[116:119]
    v_add_u32 v2, s25, v18
    v_mfma_f32_16x16x32_bf16 v[128:131], v[208:211], v[172:175], v[128:131]
    ds_read_b64_tr_b16 v[208:209], v6 offset:18432
    s_waitcnt lgkmcnt(3)
    v_mfma_f32_16x16x32_bf16 v[72:75], v[192:195], v[152:155], v[72:75]
    ds_read_b64_tr_b16 v[210:211], v6 offset:19200
    v_mfma_f32_16x16x32_bf16 v[84:87], v[192:195], v[156:159], v[84:87]
    v_xor_b32 v3, 32, v2
    v_mfma_f32_16x16x32_bf16 v[96:99], v[192:195], v[160:163], v[96:99]
    ds_read_b128 v[152:155], v3 offset:1280
    v_mfma_f32_16x16x32_bf16 v[108:111], v[192:195], v[164:167], v[108:111]
    ds_read_b128 v[148:151], v2 offset:0
    v_mfma_f32_16x16x32_bf16 v[120:123], v[192:195], v[168:171], v[120:123]
    ds_read_b64_tr_b16 v[192:193], v7 offset:18432
    v_mfma_f32_16x16x32_bf16 v[76:79], v[196:199], v[160:163], v[76:79]
    ds_read_b64_tr_b16 v[194:195], v7 offset:19200
    v_mfma_f32_16x16x32_bf16 v[88:91], v[196:199], v[164:167], v[88:91]
    v_mfma_f32_16x16x32_bf16 v[100:103], v[196:199], v[168:171], v[100:103]
    v_mfma_f32_16x16x32_bf16 v[112:115], v[196:199], v[172:175], v[112:115]
    v_mfma_f32_16x16x32_bf16 v[124:127], v[196:199], v[176:179], v[124:127]
    ds_read_b64_tr_b16 v[196:197], v8 offset:18432
    v_mfma_f32_16x16x32_bf16 v[68:71], v[200:203], v[156:159], v[68:71]
    ds_read_b64_tr_b16 v[198:199], v8 offset:19200
    v_mfma_f32_16x16x32_bf16 v[80:83], v[200:203], v[160:163], v[80:83]
    v_mfma_f32_16x16x32_bf16 v[92:95], v[200:203], v[164:167], v[92:95]
    v_mfma_f32_16x16x32_bf16 v[104:107], v[200:203], v[168:171], v[104:107]
    v_mfma_f32_16x16x32_bf16 v[116:119], v[200:203], v[172:175], v[116:119]
    s_add_u32 s26, s26, 30720
    v_mfma_f32_16x16x32_bf16 v[128:131], v[200:203], v[176:179], v[128:131]
    ds_read_b64_tr_b16 v[200:201], v6 offset:24576
    s_waitcnt lgkmcnt(3)
    v_mfma_f32_16x16x32_bf16 v[72:75], v[204:207], v[156:159], v[72:75]
    ds_read_b64_tr_b16 v[202:203], v6 offset:25344
    v_mfma_f32_16x16x32_bf16 v[84:87], v[204:207], v[160:163], v[84:87]
    s_cmp_eq_u32 s26, 92160
    v_mfma_f32_16x16x32_bf16 v[96:99], v[204:207], v[164:167], v[96:99]
    s_cselect_b32 s33, 4294875136, 0
    v_mfma_f32_16x16x32_bf16 v[108:111], v[204:207], v[168:171], v[108:111]
    s_cselect_b32 s26, 0, s26
    v_mfma_f32_16x16x32_bf16 v[120:123], v[204:207], v[172:175], v[120:123]
    ds_read_b64_tr_b16 v[204:205], v7 offset:24576
    v_mfma_f32_16x16x32_bf16 v[76:79], v[208:211], v[164:167], v[76:79]
    ds_read_b64_tr_b16 v[206:207], v7 offset:25344
    v_mfma_f32_16x16x32_bf16 v[88:91], v[208:211], v[168:171], v[88:91]
    s_add_u32 s33, s33, 30720
    v_mfma_f32_16x16x32_bf16 v[100:103], v[208:211], v[172:175], v[100:103]
    ds_read_b128 v[156:159], v2 offset:2560
    v_mfma_f32_16x16x32_bf16 v[112:115], v[208:211], v[176:179], v[112:115]
    v_mfma_f32_16x16x32_bf16 v[124:127], v[208:211], v[180:183], v[124:127]
    ds_read_b64_tr_b16 v[208:209], v8 offset:24576
    v_mfma_f32_16x16x32_bf16 v[68:71], v[192:195], v[160:163], v[68:71]
    ds_read_b64_tr_b16 v[210:211], v8 offset:25344
    v_mfma_f32_16x16x32_bf16 v[80:83], v[192:195], v[164:167], v[80:83]
    v_add_u32 v6, s33, v6
    v_mfma_f32_16x16x32_bf16 v[92:95], v[192:195], v[168:171], v[92:95]
    v_add_u32 v7, s33, v7
    v_mfma_f32_16x16x32_bf16 v[104:107], v[192:195], v[172:175], v[104:107]
    v_add_u32 v8, s33, v8
    v_mfma_f32_16x16x32_bf16 v[116:119], v[192:195], v[176:179], v[116:119]
    v_mfma_f32_16x16x32_bf16 v[128:131], v[192:195], v[180:183], v[128:131]
    s_waitcnt lgkmcnt(2)
    v_mfma_f32_16x16x32_bf16 v[72:75], v[196:199], v[160:163], v[72:75]
    s_waitcnt lgkmcnt(0)
    s_barrier
    v_mfma_f32_16x16x32_bf16 v[84:87], v[196:199], v[164:167], v[84:87]
    ds_read_b64_tr_b16 v[192:193], v6 offset:0
    v_mfma_f32_16x16x32_bf16 v[96:99], v[196:199], v[168:171], v[96:99]
    ds_read_b64_tr_b16 v[194:195], v6 offset:768
    v_mfma_f32_16x16x32_bf16 v[108:111], v[196:199], v[172:175], v[108:111]
    ds_read_b128 v[160:163], v3 offset:3840
    v_mfma_f32_16x16x32_bf16 v[120:123], v[196:199], v[176:179], v[120:123]
    ds_read_b64_tr_b16 v[196:197], v7 offset:0
    v_mfma_f32_16x16x32_bf16 v[76:79], v[200:203], v[168:171], v[76:79]
    ds_read_b64_tr_b16 v[198:199], v7 offset:768
    v_mfma_f32_16x16x32_bf16 v[88:91], v[200:203], v[172:175], v[88:91]
    v_mfma_f32_16x16x32_bf16 v[68:71], v[204:207], v[164:167], v[68:71]
    v_mfma_f32_16x16x32_bf16 v[80:83], v[204:207], v[168:171], v[80:83]
    v_mfma_f32_16x16x32_bf16 v[92:95], v[204:207], v[172:175], v[92:95]
    v_mfma_f32_16x16x32_bf16 v[72:75], v[208:211], v[164:167], v[72:75]
    ds_read_b128 v[164:167], v2 offset:5120
    v_mfma_f32_16x16x32_bf16 v[84:87], v[208:211], v[168:171], v[84:87]
    ds_read_b128 v[168:171], v3 offset:6400
    v_mfma_f32_16x16x32_bf16 v[96:99], v[208:211], v[172:175], v[96:99]
    ds_read_b128 v[172:175], v2 offset:7680
    v_mfma_f32_16x16x32_bf16 v[100:103], v[200:203], v[176:179], v[100:103]
    v_mfma_f32_16x16x32_bf16 v[112:115], v[200:203], v[180:183], v[112:115]
    v_mfma_f32_16x16x32_bf16 v[124:127], v[200:203], v[184:187], v[124:127]
    ds_read_b64_tr_b16 v[200:201], v8 offset:0
    v_mfma_f32_16x16x32_bf16 v[104:107], v[204:207], v[176:179], v[104:107]
    ds_read_b64_tr_b16 v[202:203], v8 offset:768
    v_mfma_f32_16x16x32_bf16 v[116:119], v[204:207], v[180:183], v[116:119]
    v_mfma_f32_16x16x32_bf16 v[128:131], v[204:207], v[184:187], v[128:131]
    v_mfma_f32_16x16x32_bf16 v[108:111], v[208:211], v[176:179], v[108:111]
    s_add_u32 s27, s27, 2
    v_mfma_f32_16x16x32_bf16 v[120:123], v[208:211], v[180:183], v[120:123]
    s_cmp_lt_u32 s27, 13
    s_cbranch_scc1 L_loop4
    ds_read_b64_tr_b16 v[176:177], v6 offset:6144
    ds_read_b64_tr_b16 v[178:179], v6 offset:6912
    s_waitcnt lgkmcnt(10)
    v_mfma_f32_16x16x32_bf16 v[76:79], v[192:195], v[152:155], v[76:79]
    ds_read_b64_tr_b16 v[180:181], v7 offset:6144
    ds_read_b64_tr_b16 v[182:183], v7 offset:6912
    v_mfma_f32_16x16x32_bf16 v[88:91], v[192:195], v[156:159], v[88:91]
    ds_read_b64_tr_b16 v[184:185], v8 offset:6144
    ds_read_b64_tr_b16 v[186:187], v8 offset:6912
    s_waitcnt lgkmcnt(11)
    v_mfma_f32_16x16x32_bf16 v[68:71], v[196:199], v[148:151], v[68:71]
    ds_read_b64_tr_b16 v[188:189], v6 offset:12288
    ds_read_b64_tr_b16 v[190:191], v6 offset:13056
    v_mfma_f32_16x16x32_bf16 v[80:83], v[196:199], v[152:155], v[80:83]
    ds_read_b64_tr_b16 v[204:205], v7 offset:12288
    ds_read_b64_tr_b16 v[206:207], v7 offset:13056
    v_mfma_f32_16x16x32_bf16 v[92:95], v[196:199], v[156:159], v[92:95]
    ds_read_b64_tr_b16 v[208:209], v8 offset:12288
    ds_read_b64_tr_b16 v[210:211], v8 offset:13056
    s_waitcnt lgkmcnt(12)
    v_mfma_f32_16x16x32_bf16 v[72:75], v[200:203], v[148:151], v[72:75]
    ds_read_b64_tr_b16 v[212:213], v6 offset:18432
    ds_read_b64_tr_b16 v[214:215], v6 offset:19200
    v_mfma_f32_16x16x32_bf16 v[84:87], v[200:203], v[152:155], v[84:87]
    ds_read_b64_tr_b16 v[216:217], v7 offset:18432
    ds_read_b64_tr_b16 v[218:219], v7 offset:19200
    v_mfma_f32_16x16x32_bf16 v[96:99], v[200:203], v[156:159], v[96:99]
    ds_read_b64_tr_b16 v[220:221], v8 offset:18432
    ds_read_b64_tr_b16 v[222:223], v8 offset:19200
    s_waitcnt lgkmcnt(15)
    v_mfma_f32_16x16x32_bf16 v[76:79], v[176:179], v[156:159], v[76:79]
    ds_read_b64_tr_b16 v[224:225], v6 offset:24576
    ds_read_b64_tr_b16 v[226:227], v6 offset:25344
    v_mfma_f32_16x16x32_bf16 v[88:91], v[176:179], v[160:163], v[88:91]
    ds_read_b64_tr_b16 v[228:229], v7 offset:24576
    ds_read_b64_tr_b16 v[230:231], v7 offset:25344
    s_waitcnt lgkmcnt(15)
    v_mfma_f32_16x16x32_bf16 v[68:71], v[180:183], v[152:155], v[68:71]
    ds_read_b64_tr_b16 v[232:233], v8 offset:24576
    ds_read_b64_tr_b16 v[234:235], v8 offset:25344
    v_mfma_f32_16x16x32_bf16 v[80:83], v[180:183], v[156:159], v[80:83]
    ds_read_b64_tr_b16 v[236:237], v6 offset:30720
    ds_read_b64_tr_b16 v[238:239], v6 offset:31488
    v_mfma_f32_16x16x32_bf16 v[92:95], v[180:183], v[160:163], v[92:95]
    ds_read_b128 v[240:243], v27 offset:1280
    ds_read_b128 v[244:247], v26 offset:2560
    v_mfma_f32_16x16x32_bf16 v[72:75], v[184:187], v[152:155], v[72:75]
    ds_read_b64_tr_b16 v[248:249], v7 offset:30720
    ds_read_b64_tr_b16 v[250:251], v7 offset:31488
    v_mfma_f32_16x16x32_bf16 v[84:87], v[184:187], v[156:159], v[84:87]
    ds_read_b128 v[252:255], v26 offset:0
    v_mfma_f32_16x16x32_bf16 v[96:99], v[184:187], v[160:163], v[96:99]
    ds_read_b64_tr_b16 v[192:193], v8 offset:30720
    s_waitcnt lgkmcnt(14)
    v_mfma_f32_16x16x32_bf16 v[76:79], v[188:191], v[160:163], v[76:79]
    ds_read_b64_tr_b16 v[194:195], v8 offset:31488
    v_mfma_f32_16x16x32_bf16 v[88:91], v[188:191], v[164:167], v[88:91]
    ds_read_b64_tr_b16 v[196:197], v6 offset:36864
    v_mfma_f32_16x16x32_bf16 v[68:71], v[204:207], v[156:159], v[68:71]
    ds_read_b64_tr_b16 v[198:199], v6 offset:37632
    v_mfma_f32_16x16x32_bf16 v[80:83], v[204:207], v[160:163], v[80:83]
    ds_read_b128 v[148:151], v27 offset:3840
    v_mfma_f32_16x16x32_bf16 v[92:95], v[204:207], v[164:167], v[92:95]
    ds_read_b64_tr_b16 v[200:201], v7 offset:36864
    v_mfma_f32_16x16x32_bf16 v[72:75], v[208:211], v[156:159], v[72:75]
    ds_read_b64_tr_b16 v[202:203], v7 offset:37632
    v_mfma_f32_16x16x32_bf16 v[84:87], v[208:211], v[160:163], v[84:87]
    ds_read_b64_tr_b16 v[176:177], v8 offset:36864
    v_mfma_f32_16x16x32_bf16 v[96:99], v[208:211], v[164:167], v[96:99]
    ds_read_b64_tr_b16 v[178:179], v8 offset:37632
    v_mfma_f32_16x16x32_bf16 v[76:79], v[212:215], v[164:167], v[76:79]
    ds_read_b64_tr_b16 v[180:181], v6 offset:43008
    v_mfma_f32_16x16x32_bf16 v[88:91], v[212:215], v[168:171], v[88:91]
    ds_read_b64_tr_b16 v[182:183], v6 offset:43776
    v_mfma_f32_16x16x32_bf16 v[68:71], v[216:219], v[160:163], v[68:71]
    ds_read_b128 v[152:155], v26 offset:5120
    v_mfma_f32_16x16x32_bf16 v[80:83], v[216:219], v[164:167], v[80:83]
    ds_read_b64_tr_b16 v[184:185], v7 offset:43008
    v_mfma_f32_16x16x32_bf16 v[92:95], v[216:219], v[168:171], v[92:95]
    ds_read_b64_tr_b16 v[186:187], v7 offset:43776
    v_mfma_f32_16x16x32_bf16 v[72:75], v[220:223], v[160:163], v[72:75]
    ds_read_b64_tr_b16 v[188:189], v8 offset:43008
    v_mfma_f32_16x16x32_bf16 v[84:87], v[220:223], v[164:167], v[84:87]
    ds_read_b64_tr_b16 v[190:191], v8 offset:43776
    v_mfma_f32_16x16x32_bf16 v[96:99], v[220:223], v[168:171], v[96:99]
    ds_read_b64_tr_b16 v[204:205], v6 offset:49152
    s_waitcnt lgkmcnt(8)
    v_mfma_f32_16x16x32_bf16 v[76:79], v[224:227], v[168:171], v[76:79]
    ds_read_b64_tr_b16 v[206:207], v6 offset:49920
    v_mfma_f32_16x16x32_bf16 v[88:91], v[224:227], v[172:175], v[88:91]
    ds_read_b128 v[156:159], v27 offset:6400
    v_mfma_f32_16x16x32_bf16 v[68:71], v[228:231], v[164:167], v[68:71]
    ds_read_b64_tr_b16 v[208:209], v7 offset:49152
    v_mfma_f32_16x16x32_bf16 v[80:83], v[228:231], v[168:171], v[80:83]
    ds_read_b64_tr_b16 v[210:211], v7 offset:49920
    v_mfma_f32_16x16x32_bf16 v[92:95], v[228:231], v[172:175], v[92:95]
    ds_read_b64_tr_b16 v[212:213], v8 offset:49152
    v_mfma_f32_16x16x32_bf16 v[72:75], v[232:235], v[164:167], v[72:75]
    ds_read_b64_tr_b16 v[214:215], v8 offset:49920
    v_mfma_f32_16x16x32_bf16 v[84:87], v[232:235], v[168:171], v[84:87]
    ds_read_b64_tr_b16 v[216:217], v6 offset:55296
    v_mfma_f32_16x16x32_bf16 v[96:99], v[232:235], v[172:175], v[96:99]
    ds_read_b64_tr_b16 v[218:219], v6 offset:56064
    v_mfma_f32_16x16x32_bf16 v[76:79], v[236:239], v[240:243], v[76:79]
    ds_read_b128 v[160:163], v26 offset:7680
    v_mfma_f32_16x16x32_bf16 v[88:91], v[236:239], v[244:247], v[88:91]
    ds_read_b64_tr_b16 v[220:221], v7 offset:55296
    v_mfma_f32_16x16x32_bf16 v[68:71], v[248:251], v[252:255], v[68:71]
    ds_read_b64_tr_b16 v[222:223], v7 offset:56064
    v_mfma_f32_16x16x32_bf16 v[80:83], v[248:251], v[240:243], v[80:83]
    ds_read_b64_tr_b16 v[224:225], v8 offset:55296
    v_mfma_f32_16x16x32_bf16 v[92:95], v[248:251], v[244:247], v[92:95]
    ds_read_b64_tr_b16 v[226:227], v8 offset:56064
    v_mfma_f32_16x16x32_bf16 v[72:75], v[192:195], v[252:255], v[72:75]
    v_mfma_f32_16x16x32_bf16 v[84:87], v[192:195], v[240:243], v[84:87]
    v_mfma_f32_16x16x32_bf16 v[96:99], v[192:195], v[244:247], v[96:99]
    v_mfma_f32_16x16x32_bf16 v[76:79], v[196:199], v[244:247], v[76:79]
    v_mfma_f32_16x16x32_bf16 v[88:91], v[196:199], v[148:151], v[88:91]
    v_mfma_f32_16x16x32_bf16 v[68:71], v[200:203], v[240:243], v[68:71]
    v_mfma_f32_16x16x32_bf16 v[80:83], v[200:203], v[244:247], v[80:83]
    ds_read_b128 v[228:231], v27 offset:8960
    v_mfma_f32_16x16x32_bf16 v[92:95], v[200:203], v[148:151], v[92:95]
    v_mfma_f32_16x16x32_bf16 v[72:75], v[176:179], v[240:243], v[72:75]
    v_mfma_f32_16x16x32_bf16 v[84:87], v[176:179], v[244:247], v[84:87]
    ds_read_b64_tr_b16 v[164:165], v6 offset:0
    ds_read_b64_tr_b16 v[166:167], v6 offset:768
    v_mfma_f32_16x16x32_bf16 v[96:99], v[176:179], v[148:151], v[96:99]
    ds_read_b128 v[168:171], v3 offset:3840
    ds_read_b64_tr_b16 v[172:173], v7 offset:0
    s_waitcnt lgkmcnt(5)
    v_mfma_f32_16x16x32_bf16 v[76:79], v[180:183], v[148:151], v[76:79]
    ds_read_b64_tr_b16 v[174:175], v7 offset:768
    ds_read_b64_tr_b16 v[232:233], v8 offset:0
    v_mfma_f32_16x16x32_bf16 v[88:91], v[180:183], v[152:155], v[88:91]
    ds_read_b64_tr_b16 v[234:235], v8 offset:768
    ds_read_b64_tr_b16 v[252:253], v6 offset:6144
    v_mfma_f32_16x16x32_bf16 v[68:71], v[184:187], v[244:247], v[68:71]
    ds_read_b64_tr_b16 v[254:255], v6 offset:6912
    ds_read_b128 v[240:243], v2 offset:5120
    v_mfma_f32_16x16x32_bf16 v[80:83], v[184:187], v[148:151], v[80:83]
    v_mfma_f32_16x16x32_bf16 v[92:95], v[184:187], v[152:155], v[92:95]
    v_mfma_f32_16x16x32_bf16 v[72:75], v[188:191], v[244:247], v[72:75]
    ds_read_b64_tr_b16 v[244:245], v7 offset:6144
    ds_read_b64_tr_b16 v[246:247], v7 offset:6912
    v_mfma_f32_16x16x32_bf16 v[84:87], v[188:191], v[148:151], v[84:87]
    v_mfma_f32_16x16x32_bf16 v[96:99], v[188:191], v[152:155], v[96:99]
    v_mfma_f32_16x16x32_bf16 v[76:79], v[204:207], v[152:155], v[76:79]
    v_mfma_f32_16x16x32_bf16 v[88:91], v[204:207], v[156:159], v[88:91]
    v_mfma_f32_16x16x32_bf16 v[68:71], v[208:211], v[148:151], v[68:71]
    v_mfma_f32_16x16x32_bf16 v[80:83], v[208:211], v[152:155], v[80:83]
    v_mfma_f32_16x16x32_bf16 v[92:95], v[208:211], v[156:159], v[92:95]
    v_mfma_f32_16x16x32_bf16 v[72:75], v[212:215], v[148:151], v[72:75]
    v_mfma_f32_16x16x32_bf16 v[84:87], v[212:215], v[152:155], v[84:87]
    v_mfma_f32_16x16x32_bf16 v[96:99], v[212:215], v[156:159], v[96:99]
    v_mfma_f32_16x16x32_bf16 v[76:79], v[216:219], v[156:159], v[76:79]
    v_mfma_f32_16x16x32_bf16 v[88:91], v[216:219], v[160:163], v[88:91]
    v_mfma_f32_16x16x32_bf16 v[68:71], v[220:223], v[152:155], v[68:71]
    v_mfma_f32_16x16x32_bf16 v[80:83], v[220:223], v[156:159], v[80:83]
    v_mfma_f32_16x16x32_bf16 v[92:95], v[220:223], v[160:163], v[92:95]
    v_mfma_f32_16x16x32_bf16 v[72:75], v[224:227], v[152:155], v[72:75]
    v_mfma_f32_16x16x32_bf16 v[84:87], v[224:227], v[156:159], v[84:87]
    v_mfma_f32_16x16x32_bf16 v[96:99], v[224:227], v[160:163], v[96:99]
    v_mfma_f32_16x16x32_bf16 v[100:103], v[236:239], v[148:151], v[100:103]
    v_cvt_pk_bf16_f32 v76, v76, v77
    v_cvt_pk_bf16_f32 v77, v78, v79
    v_mfma_f32_16x16x32_bf16 v[104:107], v[248:251], v[148:151], v[104:107]
    ds_write_b64 v20, v[76:77] offset:3072
    ds_read_b64_tr_b16 v[236:237], v8 offset:6144
    v_mfma_f32_16x16x32_bf16 v[108:111], v[192:195], v[148:151], v[108:111]
    ds_read_b64_tr_b16 v[238:239], v8 offset:6912
    v_cvt_pk_bf16_f32 v88, v88, v89
    v_mfma_f32_16x16x32_bf16 v[100:103], v[196:199], v[152:155], v[100:103]
    ds_read_b64_tr_b16 v[248:249], v6 offset:12288
    ds_read_b64_tr_b16 v[250:251], v6 offset:13056
    v_mfma_f32_16x16x32_bf16 v[104:107], v[200:203], v[152:155], v[104:107]
    ds_read_b128 v[148:151], v3 offset:6400
    v_cvt_pk_bf16_f32 v89, v90, v91
    v_mfma_f32_16x16x32_bf16 v[108:111], v[176:179], v[152:155], v[108:111]
    ds_read_b64_tr_b16 v[192:193], v7 offset:12288
    ds_read_b64_tr_b16 v[194:195], v7 offset:13056
    v_mfma_f32_16x16x32_bf16 v[100:103], v[180:183], v[156:159], v[100:103]
    ds_write_b64 v20, v[88:89] offset:6144
    ds_read_b64_tr_b16 v[196:197], v8 offset:12288
    v_mfma_f32_16x16x32_bf16 v[104:107], v[184:187], v[156:159], v[104:107]
    ds_read_b64_tr_b16 v[198:199], v8 offset:13056
    v_cvt_pk_bf16_f32 v68, v68, v69
    v_mfma_f32_16x16x32_bf16 v[108:111], v[188:191], v[156:159], v[108:111]
    ds_read_b64_tr_b16 v[200:201], v6 offset:18432
    ds_read_b64_tr_b16 v[202:203], v6 offset:19200
    v_mfma_f32_16x16x32_bf16 v[100:103], v[204:207], v[160:163], v[100:103]
    ds_read_b128 v[152:155], v2 offset:7680
    v_cvt_pk_bf16_f32 v69, v70, v71
    v_mfma_f32_16x16x32_bf16 v[104:107], v[208:211], v[160:163], v[104:107]
    ds_read_b64_tr_b16 v[176:177], v7 offset:18432
    ds_read_b64_tr_b16 v[178:179], v7 offset:19200
    v_mfma_f32_16x16x32_bf16 v[108:111], v[212:215], v[160:163], v[108:111]
    ds_write_b64 v20, v[68:69] offset:64
    ds_read_b64_tr_b16 v[180:181], v8 offset:18432
    s_waitcnt lgkmcnt(13)
    v_mfma_f32_16x16x32_bf16 v[100:103], v[216:219], v[228:231], v[100:103]
    ds_read_b64_tr_b16 v[182:183], v8 offset:19200
    v_cvt_pk_bf16_f32 v80, v80, v81
    v_mfma_f32_16x16x32_bf16 v[104:107], v[220:223], v[228:231], v[104:107]
    ds_read_b64_tr_b16 v[184:185], v6 offset:24576
    ds_read_b64_tr_b16 v[186:187], v6 offset:25344
    v_mfma_f32_16x16x32_bf16 v[108:111], v[224:227], v[228:231], v[108:111]
    ds_read_b128 v[156:159], v3 offset:8960
    v_cvt_pk_bf16_f32 v81, v82, v83
    v_mfma_f32_16x16x32_bf16 v[100:103], v[164:167], v[168:171], v[100:103]
    ds_read_b64_tr_b16 v[188:189], v7 offset:24576
    ds_read_b64_tr_b16 v[190:191], v7 offset:25344
    v_mfma_f32_16x16x32_bf16 v[104:107], v[172:175], v[168:171], v[104:107]
    ds_write_b64 v20, v[80:81] offset:3136
    ds_read_b64_tr_b16 v[204:205], v8 offset:24576
    v_mfma_f32_16x16x32_bf16 v[108:111], v[232:235], v[168:171], v[108:111]
    ds_read_b64_tr_b16 v[206:207], v8 offset:25344
    v_cvt_pk_bf16_f32 v92, v92, v93
    v_mfma_f32_16x16x32_bf16 v[100:103], v[252:255], v[240:243], v[100:103]
    v_cvt_pk_bf16_f32 v93, v94, v95
    ds_write_b64 v20, v[92:93] offset:6208
    v_mfma_f32_16x16x32_bf16 v[104:107], v[244:247], v[240:243], v[104:107]
    v_cvt_pk_bf16_f32 v72, v72, v73
    v_cvt_pk_bf16_f32 v73, v74, v75
    v_mfma_f32_16x16x32_bf16 v[108:111], v[236:239], v[240:243], v[108:111]
    ds_write_b64 v20, v[72:73] offset:128
    v_cvt_pk_bf16_f32 v84, v84, v85
    s_waitcnt lgkmcnt(10)
    v_mfma_f32_16x16x32_bf16 v[100:103], v[248:251], v[148:151], v[100:103]
    v_cvt_pk_bf16_f32 v85, v86, v87
    ds_write_b64 v20, v[84:85] offset:3200
    v_mfma_f32_16x16x32_bf16 v[104:107], v[192:195], v[148:151], v[104:107]
    v_cvt_pk_bf16_f32 v96, v96, v97
    v_mfma_f32_16x16x32_bf16 v[108:111], v[196:199], v[148:151], v[108:111]
    v_cvt_pk_bf16_f32 v97, v98, v99
    v_mfma_f32_16x16x32_bf16 v[100:103], v[200:203], v[152:155], v[100:103]
    ds_write_b64 v20, v[96:97] offset:6272
    v_mfma_f32_16x16x32_bf16 v[104:107], v[176:179], v[152:155], v[104:107]
    ds_read_b128 v[208:211], v2 offset:10240
    v_mfma_f32_16x16x32_bf16 v[108:111], v[180:183], v[152:155], v[108:111]
    ds_read_b128 v[160:163], v3 offset:11520
    s_waitcnt lgkmcnt(5)
    v_mfma_f32_16x16x32_bf16 v[100:103], v[184:187], v[156:159], v[100:103]
    ds_read_b64_tr_b16 v[212:213], v6 offset:30720
    v_mfma_f32_16x16x32_bf16 v[104:107], v[188:191], v[156:159], v[104:107]
    ds_read_b64_tr_b16 v[214:215], v6 offset:31488
    v_mfma_f32_16x16x32_bf16 v[108:111], v[204:207], v[156:159], v[108:111]
    ds_read_b128 v[216:219], v26 offset:5120
    v_mfma_f32_16x16x32_bf16 v[112:115], v[164:167], v[240:243], v[112:115]
    ds_read_b128 v[220:223], v27 offset:6400
    v_mfma_f32_16x16x32_bf16 v[124:127], v[164:167], v[148:151], v[124:127]
    ds_read_b64_tr_b16 v[224:225], v7 offset:30720
    v_mfma_f32_16x16x32_bf16 v[116:119], v[172:175], v[240:243], v[116:119]
    ds_read_b64_tr_b16 v[226:227], v7 offset:31488
    v_mfma_f32_16x16x32_bf16 v[128:131], v[172:175], v[148:151], v[128:131]
    ds_read_b64_tr_b16 v[228:229], v8 offset:30720
    v_mfma_f32_16x16x32_bf16 v[120:123], v[232:235], v[240:243], v[120:123]
    s_waitcnt lgkmcnt(9)
    s_barrier
    ds_read_b64_tr_b16 v[230:231], v8 offset:31488
    v_mfma_f32_16x16x32_bf16 v[112:115], v[252:255], v[148:151], v[112:115]
    ds_read_b64_tr_b16 v[168:169], v6 offset:36864
    v_mfma_f32_16x16x32_bf16 v[124:127], v[252:255], v[152:155], v[124:127]
    ds_read_b64_tr_b16 v[170:171], v6 offset:37632
    v_mfma_f32_16x16x32_bf16 v[116:119], v[244:247], v[148:151], v[116:119]
    ds_read_b128 v[164:167], v26 offset:7680
    v_mfma_f32_16x16x32_bf16 v[128:131], v[244:247], v[152:155], v[128:131]
    ds_read_b64_tr_b16 v[172:173], v7 offset:36864
    v_mfma_f32_16x16x32_bf16 v[120:123], v[236:239], v[148:151], v[120:123]
    ds_read_b64_tr_b16 v[174:175], v7 offset:37632
    v_mfma_f32_16x16x32_bf16 v[112:115], v[248:251], v[152:155], v[112:115]
    ds_read_b64_tr_b16 v[232:233], v8 offset:36864
    v_mfma_f32_16x16x32_bf16 v[124:127], v[248:251], v[156:159], v[124:127]
    ds_read_b64_tr_b16 v[234:235], v8 offset:37632
    v_mfma_f32_16x16x32_bf16 v[116:119], v[192:195], v[152:155], v[116:119]
    ds_read_b64_tr_b16 v[240:241], v6 offset:43008
    v_mfma_f32_16x16x32_bf16 v[128:131], v[192:195], v[156:159], v[128:131]
    ds_read_b64_tr_b16 v[242:243], v6 offset:43776
    v_mfma_f32_16x16x32_bf16 v[120:123], v[196:199], v[152:155], v[120:123]
    ds_read_b128 v[252:255], v27 offset:8960
    v_mfma_f32_16x16x32_bf16 v[112:115], v[200:203], v[156:159], v[112:115]
    v_cvt_pk_bf16_f32 v100, v100, v101
    s_waitcnt lgkmcnt(7)
    v_mfma_f32_16x16x32_bf16 v[124:127], v[200:203], v[208:211], v[124:127]
    ds_read_b64_tr_b16 v[244:245], v7 offset:43008
    v_mfma_f32_16x16x32_bf16 v[116:119], v[176:179], v[156:159], v[116:119]
    ds_read_b64_tr_b16 v[246:247], v7 offset:43776
    v_mfma_f32_16x16x32_bf16 v[128:131], v[176:179], v[208:211], v[128:131]
    v_cvt_pk_bf16_f32 v101, v102, v103
    v_mfma_f32_16x16x32_bf16 v[120:123], v[180:183], v[156:159], v[120:123]
    ds_write_b64 v20, v[100:101] offset:9216
    v_mfma_f32_16x16x32_bf16 v[112:115], v[184:187], v[208:211], v[112:115]
    ds_read_b64_tr_b16 v[148:149], v8 offset:43008
    v_mfma_f32_16x16x32_bf16 v[124:127], v[184:187], v[160:163], v[124:127]
    ds_read_b64_tr_b16 v[150:151], v8 offset:43776
    v_mfma_f32_16x16x32_bf16 v[116:119], v[188:191], v[208:211], v[116:119]
    v_cvt_pk_bf16_f32 v104, v104, v105
    v_mfma_f32_16x16x32_bf16 v[128:131], v[188:191], v[160:163], v[128:131]
    ds_read_b64_tr_b16 v[236:237], v6 offset:49152
    v_mfma_f32_16x16x32_bf16 v[120:123], v[204:207], v[208:211], v[120:123]
    ds_read_b64_tr_b16 v[238:239], v6 offset:49920
    v_mfma_f32_16x16x32_bf16 v[112:115], v[212:215], v[216:219], v[112:115]
    v_cvt_pk_bf16_f32 v105, v106, v107
    v_mfma_f32_16x16x32_bf16 v[124:127], v[212:215], v[220:223], v[124:127]
    ds_read_b128 v[248:251], v26 offset:10240
    v_mfma_f32_16x16x32_bf16 v[116:119], v[224:227], v[216:219], v[116:119]
    ds_write_b64 v20, v[104:105] offset:9280
    v_mfma_f32_16x16x32_bf16 v[128:131], v[224:227], v[220:223], v[128:131]
    ds_read_b64_tr_b16 v[192:193], v7 offset:49152
    ds_read_b64_tr_b16 v[194:195], v7 offset:49920
    v_mfma_f32_16x16x32_bf16 v[120:123], v[228:231], v[216:219], v[120:123]
    v_cvt_pk_bf16_f32 v108, v108, v109
    v_cvt_pk_bf16_f32 v109, v110, v111
    v_mfma_f32_16x16x32_bf16 v[112:115], v[168:171], v[220:223], v[112:115]
    ds_read_b64_tr_b16 v[152:153], v8 offset:49152
    ds_read_b64_tr_b16 v[154:155], v8 offset:49920
    v_mfma_f32_16x16x32_bf16 v[124:127], v[168:171], v[164:167], v[124:127]
    ds_write_b64 v20, v[108:109] offset:9344
    ds_read_b64_tr_b16 v[196:197], v6 offset:55296
    s_waitcnt lgkmcnt(9)
    v_mfma_f32_16x16x32_bf16 v[116:119], v[172:175], v[220:223], v[116:119]
    ds_read_b64_tr_b16 v[198:199], v6 offset:56064
    ds_read_b128 v[200:203], v27 offset:11520
    v_mfma_f32_16x16x32_bf16 v[128:131], v[172:175], v[164:167], v[128:131]
    ds_read_b64_tr_b16 v[176:177], v7 offset:55296
    ds_read_b64_tr_b16 v[178:179], v7 offset:56064
    v_mfma_f32_16x16x32_bf16 v[120:123], v[232:235], v[220:223], v[120:123]
    ds_read_b64_tr_b16 v[156:157], v8 offset:55296
    v_mfma_f32_16x16x32_bf16 v[112:115], v[240:243], v[164:167], v[112:115]
    ds_read_b64_tr_b16 v[158:159], v8 offset:56064
    v_mfma_f32_16x16x32_bf16 v[124:127], v[240:243], v[252:255], v[124:127]
    v_mfma_f32_16x16x32_bf16 v[116:119], v[244:247], v[164:167], v[116:119]
    v_mfma_f32_16x16x32_bf16 v[128:131], v[244:247], v[252:255], v[128:131]
    s_waitcnt lgkmcnt(7)
    s_barrier
    v_mfma_f32_16x16x32_bf16 v[120:123], v[148:151], v[164:167], v[120:123]
    v_mfma_f32_16x16x32_bf16 v[112:115], v[236:239], v[252:255], v[112:115]
    v_mfma_f32_16x16x32_bf16 v[124:127], v[236:239], v[248:251], v[124:127]
    v_mfma_f32_16x16x32_bf16 v[116:119], v[192:195], v[252:255], v[116:119]
    v_mfma_f32_16x16x32_bf16 v[128:131], v[192:195], v[248:251], v[128:131]
    v_mfma_f32_16x16x32_bf16 v[120:123], v[152:155], v[252:255], v[120:123]
    s_waitcnt lgkmcnt(0)
    v_mfma_f32_16x16x32_bf16 v[112:115], v[196:199], v[248:251], v[112:115]
    v_mfma_f32_16x16x32_bf16 v[124:127], v[196:199], v[200:203], v[124:127]
    v_mfma_f32_16x16x32_bf16 v[116:119], v[176:179], v[248:251], v[116:119]
    v_mfma_f32_16x16x32_bf16 v[128:131], v[176:179], v[200:203], v[128:131]
    v_mfma_f32_16x16x32_bf16 v[120:123], v[156:159], v[248:251], v[120:123]
    s_nop 7
    v_cvt_pk_bf16_f32 v112, v112, v113
    v_cvt_pk_bf16_f32 v113, v114, v115
    ds_write_b64 v20, v[112:113] offset:12288
    v_cvt_pk_bf16_f32 v124, v124, v125
    v_cvt_pk_bf16_f32 v125, v126, v127
    ds_write_b64 v20, v[124:125] offset:15360
    v_cvt_pk_bf16_f32 v116, v116, v117
    v_cvt_pk_bf16_f32 v117, v118, v119
    ds_write_b64 v20, v[116:117] offset:12352
    v_cvt_pk_bf16_f32 v128, v128, v129
    v_cvt_pk_bf16_f32 v129, v130, v131
    ds_write_b64 v20, v[128:129] offset:15424
    v_cvt_pk_bf16_f32 v120, v120, v121
    v_cvt_pk_bf16_f32 v121, v122, v123
    ds_write_b64 v20, v[120:121] offset:12416
    s_waitcnt lgkmcnt(0)
    s_barrier
    s_branch L_store
L_cls5:
    s_waitcnt lgkmcnt(0)
    v_and_b32 v15, 15, v1
    v_lshrrev_b32 v17, 4, v1
    v_bfe_u32 v18, v1, 2, 2
    v_lshl_add_u32 v18, v17, 3, v18
    v_mul_u32_u24 v18, 192, v18
    v_and_b32 v19, 3, v1
    v_lshl_add_u32 v18, v19, 3, v18
    v_add_u32 v18, 69120, v18
    v_and_b32 v19, 1, v17
    v_lshlrev_b32 v19, 5, v19
    s_lshl_b32 s20, s17, 5
    s_add_u32 s21, s20, 64
    s_add_u32 s22, s20, 128
    v_xor_b32 v6, s20, v19
    v_add_u32 v6, v6, v18
    v_xor_b32 v7, s21, v19
    v_add_u32 v7, v7, v18
    v_xor_b32 v8, s22, v19
    v_add_u32 v8, v8, v18
    s_and_b32 s3, s18, 1
    s_lshl_b32 s3, s3, 1
    v_xor_b32 v16, s3, v17
    s_mul_i32 s25, s18, 1280
    v_lshrrev_b32 v18, 1, v15
    v_and_b32 v18, 2, v18
    v_xor_b32 v18, v18, v16
    v_lshlrev_b32 v18, 4, v18
    v_lshl_add_u32 v18, v15, 6, v18
    v_add_u32 v4, s25, v18
    v_xor_b32 v5, 32, v4
    s_barrier
    ds_read_b64_tr_b16 v[200:201], v8 offset:0
    ds_read_b64_tr_b16 v[202:203], v8 offset:768
    ds_read_b128 v[148:151], v4 offset:0
    ds_read_b64_tr_b16 v[192:193], v6 offset:0
    ds_read_b64_tr_b16 v[194:195], v6 offset:768
    ds_read_b64_tr_b16 v[196:197], v7 offset:0
    ds_read_b64_tr_b16 v[198:199], v7 offset:768
    s_waitcnt lgkmcnt(4)
    v_mfma_f32_16x16x32_bf16 v[72:75], v[200:203], v[148:151], 0
    v_add_u32 v19, 1, v15
    v_lshrrev_b32 v18, 1, v19
    v_and_b32 v18, 2, v18
    v_xor_b32 v18, v18, v16
    v_lshlrev_b32 v18, 4, v18
    v_lshl_add_u32 v18, v19, 6, v18
    v_add_u32 v2, s25, v18
    v_xor_b32 v3, 32, v2
    v_lshrrev_b32 v18, 1, v17
    s_lshl_b32 s3, s17, 1
    v_add_u32 v18, s3, v18
    v_bfe_u32 v19, v15, 1, 2
    s_barrier
    ds_read_b128 v[152:155], v5 offset:1280
    ds_read_b64_tr_b16 v[188:189], v8 offset:6144
    ds_read_b64_tr_b16 v[190:191], v8 offset:6912
    ds_read_b64_tr_b16 v[204:205], v6 offset:6144
    ds_read_b64_tr_b16 v[206:207], v6 offset:6912
    s_waitcnt lgkmcnt(4)
    v_mfma_f32_16x16x32_bf16 v[76:79], v[192:195], v[152:155], 0
    ds_read_b64_tr_b16 v[208:209], v7 offset:6144
    ds_read_b64_tr_b16 v[210:211], v7 offset:6912
    v_mfma_f32_16x16x32_bf16 v[80:83], v[196:199], v[152:155], 0
    v_mfma_f32_16x16x32_bf16 v[84:87], v[200:203], v[152:155], 0
    s_waitcnt lgkmcnt(4)
    v_mfma_f32_16x16x32_bf16 v[72:75], v[188:191], v[152:155], v[72:75]
    v_xor_b32 v18, v18, v19
    v_mul_u32_u24 v20, 192, v15
    v_lshl_add_u32 v20, v18, 4, v20
    v_and_b32 v19, 1, v17
    v_lshl_add_u32 v20, v19, 3, v20
    s_mul_i32 s3, s18, 3072
    v_add_u32 v20, s3, v20
    s_mov_b32 s24, 1
    s_mov_b32 s26, 30720
    s_mov_b32 s27, 1
    s_add_u32 s23, s25, 46080
    v_add_u32 v19, 4, v15
    s_barrier
    ds_read_b128 v[156:159], v4 offset:2560
    ds_read_b64_tr_b16 v[212:213], v8 offset:12288
    ds_read_b64_tr_b16 v[214:215], v8 offset:13056
    s_waitcnt lgkmcnt(2)
    v_mfma_f32_16x16x32_bf16 v[88:91], v[192:195], v[156:159], 0
    ds_read_b64_tr_b16 v[216:217], v6 offset:12288
    ds_read_b64_tr_b16 v[218:219], v6 offset:13056
    v_mfma_f32_16x16x32_bf16 v[92:95], v[196:199], v[156:159], 0
    ds_read_b64_tr_b16 v[220:221], v7 offset:12288
    ds_read_b64_tr_b16 v[222:223], v7 offset:13056
    v_mfma_f32_16x16x32_bf16 v[96:99], v[200:203], v[156:159], 0
    v_mfma_f32_16x16x32_bf16 v[76:79], v[204:207], v[156:159], v[76:79]
    v_mfma_f32_16x16x32_bf16 v[80:83], v[208:211], v[156:159], v[80:83]
    v_mfma_f32_16x16x32_bf16 v[84:87], v[188:191], v[156:159], v[84:87]
    s_waitcnt lgkmcnt(4)
    v_mfma_f32_16x16x32_bf16 v[72:75], v[212:215], v[156:159], v[72:75]
    v_lshrrev_b32 v18, 1, v19
    v_and_b32 v18, 2, v18
    v_xor_b32 v18, v18, v16
    v_lshlrev_b32 v18, 4, v18
    v_lshl_add_u32 v18, v19, 6, v18
    v_add_u32 v26, s23, v18
    v_xor_b32 v27, 32, v26
    v_lshlrev_b32 v46, 4, v1
    v_add_u32 v47, 0, v1
    v_mul_u32_u24 v48, 5462, v47
    v_lshrrev_b32 v48, 16, v48
    v_mul_u32_u24 v49, 12, v48
    s_barrier
    ds_read_b128 v[160:163], v5 offset:3840
    ds_read_b64_tr_b16 v[224:225], v8 offset:18432
    s_waitcnt lgkmcnt(1)
    v_mfma_f32_16x16x32_bf16 v[100:103], v[192:195], v[160:163], 0
    ds_read_b64_tr_b16 v[226:227], v8 offset:19200
    ds_read_b64_tr_b16 v[228:229], v6 offset:18432
    v_mfma_f32_16x16x32_bf16 v[104:107], v[196:199], v[160:163], 0
    ds_read_b64_tr_b16 v[230:231], v6 offset:19200
    ds_read_b64_tr_b16 v[232:233], v7 offset:18432
    v_mfma_f32_16x16x32_bf16 v[108:111], v[200:203], v[160:163], 0
    v_sub_u32 v49, v47, v49
    v_lshrrev_b32 v43, 2, v49
    v_bfe_u32 v50, v48, 1, 2
    v_xor_b32 v50, v50, v49
    v_and_b32 v50, 3, v50
    v_and_b32 v49, 12, v49
    v_or_b32 v49, v49, v50
    v_mul_u32_u24 v48, 192, v48
    v_lshl_add_u32 v40, v49, 4, v48
    v_add_u32 v47, 64, v1
    v_mul_u32_u24 v48, 5462, v47
    v_lshrrev_b32 v48, 16, v48
    s_barrier
    ds_read_b128 v[164:167], v4 offset:5120
    v_mfma_f32_16x16x32_bf16 v[88:91], v[204:207], v[160:163], v[88:91]
    ds_read_b64_tr_b16 v[234:235], v7 offset:19200
    ds_read_b64_tr_b16 v[236:237], v8 offset:24576
    v_mfma_f32_16x16x32_bf16 v[92:95], v[208:211], v[160:163], v[92:95]
    ds_read_b64_tr_b16 v[238:239], v8 offset:25344
    ds_read_b64_tr_b16 v[240:241], v6 offset:24576
    v_mfma_f32_16x16x32_bf16 v[96:99], v[188:191], v[160:163], v[96:99]
    ds_read_b64_tr_b16 v[242:243], v6 offset:25344
    ds_read_b64_tr_b16 v[244:245], v7 offset:24576
    v_mfma_f32_16x16x32_bf16 v[76:79], v[216:219], v[160:163], v[76:79]
    ds_read_b64_tr_b16 v[246:247], v7 offset:25344
    v_mfma_f32_16x16x32_bf16 v[80:83], v[220:223], v[160:163], v[80:83]
    v_mfma_f32_16x16x32_bf16 v[84:87], v[212:215], v[160:163], v[84:87]
    s_waitcnt lgkmcnt(10)
    v_mfma_f32_16x16x32_bf16 v[72:75], v[224:227], v[160:163], v[72:75]
    s_waitcnt lgkmcnt(7)
    v_mfma_f32_16x16x32_bf16 v[112:115], v[192:195], v[164:167], 0
    v_mfma_f32_16x16x32_bf16 v[116:119], v[196:199], v[164:167], 0
    v_mfma_f32_16x16x32_bf16 v[120:123], v[200:203], v[164:167], 0
    v_mfma_f32_16x16x32_bf16 v[100:103], v[204:207], v[164:167], v[100:103]
    v_mfma_f32_16x16x32_bf16 v[104:107], v[208:211], v[164:167], v[104:107]
    v_mfma_f32_16x16x32_bf16 v[108:111], v[188:191], v[164:167], v[108:111]
    v_mul_u32_u24 v49, 12, v48
    v_sub_u32 v49, v47, v49
    v_lshrrev_b32 v44, 2, v49
    v_bfe_u32 v50, v48, 1, 2
    v_xor_b32 v50, v50, v49
    v_and_b32 v50, 3, v50
    v_and_b32 v49, 12, v49
    v_or_b32 v49, v49, v50
    v_mul_u32_u24 v48, 192, v48
    v_lshl_add_u32 v41, v49, 4, v48
    v_add_u32 v47, 128, v1
    v_mul_u32_u24 v48, 5462, v47
    s_barrier
    ds_read_b128 v[168:171], v5 offset:6400
    v_mfma_f32_16x16x32_bf16 v[88:91], v[216:219], v[164:167], v[88:91]
    v_mfma_f32_16x16x32_bf16 v[92:95], v[220:223], v[164:167], v[92:95]
    v_mfma_f32_16x16x32_bf16 v[96:99], v[212:215], v[164:167], v[96:99]
    v_mfma_f32_16x16x32_bf16 v[76:79], v[228:231], v[164:167], v[76:79]
    s_waitcnt lgkmcnt(1)
    v_mfma_f32_16x16x32_bf16 v[80:83], v[232:235], v[164:167], v[80:83]
    v_mfma_f32_16x16x32_bf16 v[84:87], v[224:227], v[164:167], v[84:87]
    v_mfma_f32_16x16x32_bf16 v[72:75], v[236:239], v[164:167], v[72:75]
    s_waitcnt lgkmcnt(0)
    v_mfma_f32_16x16x32_bf16 v[124:127], v[192:195], v[168:171], 0
    v_mfma_f32_16x16x32_bf16 v[128:131], v[196:199], v[168:171], 0
    v_mfma_f32_16x16x32_bf16 v[132:135], v[200:203], v[168:171], 0
    v_mfma_f32_16x16x32_bf16 v[112:115], v[204:207], v[168:171], v[112:115]
    v_mfma_f32_16x16x32_bf16 v[116:119], v[208:211], v[168:171], v[116:119]
    v_mfma_f32_16x16x32_bf16 v[120:123], v[188:191], v[168:171], v[120:123]
    v_mfma_f32_16x16x32_bf16 v[100:103], v[216:219], v[168:171], v[100:103]
    v_mfma_f32_16x16x32_bf16 v[104:107], v[220:223], v[168:171], v[104:107]
    v_lshrrev_b32 v48, 16, v48
    v_mul_u32_u24 v49, 12, v48
    v_sub_u32 v49, v47, v49
    v_lshrrev_b32 v45, 2, v49
    v_bfe_u32 v50, v48, 1, 2
    v_xor_b32 v50, v50, v49
    v_and_b32 v50, 3, v50
    v_and_b32 v49, 12, v49
    v_or_b32 v49, v49, v50
    v_mul_u32_u24 v48, 192, v48
    v_lshl_add_u32 v42, v49, 4, v48
    s_mov_b32 s76, s8
    s_barrier
    ds_read_b128 v[172:175], v4 offset:7680
    v_mfma_f32_16x16x32_bf16 v[108:111], v[212:215], v[168:171], v[108:111]
    s_mov_b32 s77, s9
    s_mov_b32 s78, 9633792
    v_mfma_f32_16x16x32_bf16 v[88:91], v[228:231], v[168:171], v[88:91]
    s_mov_b32 s79, 0x20000
    s_mov_b32 s85, 3088
    v_mfma_f32_16x16x32_bf16 v[92:95], v[232:235], v[168:171], v[92:95]
    s_cmp_eq_u32 s14, 1
    s_cselect_b32 s85, 3330, s85
    v_mfma_f32_16x16x32_bf16 v[96:99], v[224:227], v[168:171], v[96:99]
    s_cmp_eq_u32 s14, 2
    ds_read_b128 v[176:179], v5 offset:8960
    v_mfma_f32_16x16x32_bf16 v[76:79], v[240:243], v[168:171], v[76:79]
    s_cselect_b32 s85, 25377, s85
    s_cmp_eq_u32 s14, 3
    v_mfma_f32_16x16x32_bf16 v[80:83], v[244:247], v[168:171], v[80:83]
    s_cselect_b32 s85, 2576, s85
    s_cmp_eq_u32 s14, 4
    v_mfma_f32_16x16x32_bf16 v[84:87], v[236:239], v[168:171], v[84:87]
    s_cselect_b32 s85, 2818, s85
    s_and_b32 s84, s85, 15
    s_waitcnt lgkmcnt(1)
    v_mfma_f32_16x16x32_bf16 v[124:127], v[204:207], v[172:175], v[124:127]
    s_bfe_u32 s86, s85, 0x40004
    s_lshr_b32 s85, s85, 8
    v_mfma_f32_16x16x32_bf16 v[128:131], v[208:211], v[172:175], v[128:131]
    s_mov_b32 s87, 4294751828
    s_cmp_eq_u32 s14, 1
    v_mfma_f32_16x16x32_bf16 v[132:135], v[188:191], v[172:175], v[132:135]
    s_cselect_b32 s87, 4292654682, s87
    s_cmp_eq_u32 s14, 2
    v_mfma_f32_16x16x32_bf16 v[112:115], v[216:219], v[172:175], v[112:115]
    s_barrier
    s_cselect_b32 s87, 4294751834, s87
    v_mfma_f32_16x16x32_bf16 v[116:119], v[220:223], v[172:175], v[116:119]
    ds_read_b128 v[180:183], v4 offset:10240
    s_cmp_eq_u32 s14, 3
    v_mfma_f32_16x16x32_bf16 v[120:123], v[212:215], v[172:175], v[120:123]
    s_cselect_b32 s87, 4294945108, s87
    s_cmp_eq_u32 s14, 4
    v_mfma_f32_16x16x32_bf16 v[100:103], v[228:231], v[172:175], v[100:103]
    s_cselect_b32 s87, 4294949460, s87
    s_lshl_b32 s3, s16, 2
    v_mfma_f32_16x16x32_bf16 v[104:107], v[232:235], v[172:175], v[104:107]
    s_lshr_b32 s87, s87, s3
    s_and_b32 s87, s87, 15
    v_mfma_f32_16x16x32_bf16 v[108:111], v[224:227], v[172:175], v[108:111]
    s_add_u32 s80, s15, s87
    s_mul_i32 s80, s80, 43008
    v_mfma_f32_16x16x32_bf16 v[88:91], v[240:243], v[172:175], v[88:91]
    ds_read_b128 v[184:187], v5 offset:11520
    s_mul_i32 s3, s12, 192
    v_mfma_f32_16x16x32_bf16 v[92:95], v[244:247], v[172:175], v[92:95]
    s_add_u32 s80, s80, s3
    ds_read_b128 v[152:155], v3 offset:1280
    v_mfma_f32_16x16x32_bf16 v[96:99], v[236:239], v[172:175], v[96:99]
    ds_read_b128 v[148:151], v2 offset:0
    ds_read_b128 v[156:159], v2 offset:2560
    s_waitcnt lgkmcnt(5)
    v_mfma_f32_16x16x32_bf16 v[124:127], v[216:219], v[176:179], v[124:127]
    ds_read_b128 v[160:163], v3 offset:3840
    ds_read_b64_tr_b16 v[192:193], v6 offset:30720
    v_mfma_f32_16x16x32_bf16 v[128:131], v[220:223], v[176:179], v[128:131]
    ds_read_b64_tr_b16 v[194:195], v6 offset:31488
    ds_read_b64_tr_b16 v[196:197], v7 offset:30720
    v_mfma_f32_16x16x32_bf16 v[132:135], v[212:215], v[176:179], v[132:135]
    ds_read_b64_tr_b16 v[198:199], v7 offset:31488
    ds_read_b128 v[164:167], v2 offset:5120
    v_mfma_f32_16x16x32_bf16 v[112:115], v[228:231], v[176:179], v[112:115]
    ds_read_b128 v[168:171], v3 offset:6400
    ds_read_b128 v[172:175], v2 offset:7680
    v_mfma_f32_16x16x32_bf16 v[116:119], v[232:235], v[176:179], v[116:119]
    ds_read_b64_tr_b16 v[200:201], v8 offset:30720
    ds_read_b64_tr_b16 v[202:203], v8 offset:31488
    v_mfma_f32_16x16x32_bf16 v[120:123], v[224:227], v[176:179], v[120:123]
    s_mul_i32 s81, s87, 3072
    v_add_u32 v47, s81, v40
    v_mfma_f32_16x16x32_bf16 v[100:103], v[240:243], v[176:179], v[100:103]
    v_add_u32 v48, s81, v41
    v_add_u32 v49, s81, v42
    v_mfma_f32_16x16x32_bf16 v[104:107], v[244:247], v[176:179], v[104:107]
    s_cmp_eq_u32 s87, 0
    s_cselect_b32 s82, s84, 0
    v_mfma_f32_16x16x32_bf16 v[108:111], v[236:239], v[176:179], v[108:111]
    s_cmp_eq_u32 s87, s85
    s_cselect_b32 s83, s86, 2
    s_waitcnt lgkmcnt(8)
    v_mfma_f32_16x16x32_bf16 v[124:127], v[228:231], v[180:183], v[124:127]
    v_cmp_le_u32 vcc, s82, v43
    v_cmp_ge_u32 s[64:65], s83, v43
    v_mfma_f32_16x16x32_bf16 v[128:131], v[232:235], v[180:183], v[128:131]
    s_nop 0
    s_and_b64 s[64:65], s[64:65], vcc
    v_mfma_f32_16x16x32_bf16 v[132:135], v[224:227], v[180:183], v[132:135]
    v_cmp_le_u32 vcc, s82, v44
    v_cmp_ge_u32 s[66:67], s83, v44
    v_mfma_f32_16x16x32_bf16 v[112:115], v[240:243], v[180:183], v[112:115]
    s_nop 0
    s_and_b64 s[66:67], s[66:67], vcc
    v_mfma_f32_16x16x32_bf16 v[116:119], v[244:247], v[180:183], v[116:119]
    v_cmp_le_u32 vcc, s82, v45
    v_cmp_ge_u32 s[68:69], s83, v45
    s_nop 0
    v_mfma_f32_16x16x32_bf16 v[120:123], v[236:239], v[180:183], v[120:123]
    s_and_b64 s[68:69], s[68:69], vcc
    v_add_u32 v6, 30720, v6
    v_add_u32 v7, 30720, v7
    v_mfma_f32_16x16x32_bf16 v[124:127], v[240:243], v[184:187], v[124:127]
    v_add_u32 v8, 30720, v8
    v_mfma_f32_16x16x32_bf16 v[128:131], v[244:247], v[184:187], v[128:131]
    v_mfma_f32_16x16x32_bf16 v[132:135], v[236:239], v[184:187], v[132:135]
    s_waitcnt lgkmcnt(0)
    s_waitcnt vmcnt(0)
L_loop5:
    ds_read_b64_tr_b16 v[204:205], v6 offset:6144
    s_waitcnt lgkmcnt(3)
    v_mfma_f32_16x16x32_bf16 v[76:79], v[192:195], v[152:155], v[76:79]
    ds_read_b64_tr_b16 v[206:207], v6 offset:6912
    v_mfma_f32_16x16x32_bf16 v[88:91], v[192:195], v[156:159], v[88:91]
    ds_read_b64_tr_b16 v[208:209], v7 offset:6144
    v_mfma_f32_16x16x32_bf16 v[100:103], v[192:195], v[160:163], v[100:103]
    ds_read_b64_tr_b16 v[210:211], v7 offset:6912
    v_mfma_f32_16x16x32_bf16 v[80:83], v[196:199], v[152:155], v[80:83]
    ds_read_b128 v[176:179], v3 offset:8960
    v_mfma_f32_16x16x32_bf16 v[92:95], v[196:199], v[156:159], v[92:95]
    ds_read_b128 v[180:183], v2 offset:10240
    v_mfma_f32_16x16x32_bf16 v[104:107], v[196:199], v[160:163], v[104:107]
    ds_read_b128 v[184:187], v3 offset:11520
    s_waitcnt lgkmcnt(7)
    v_mfma_f32_16x16x32_bf16 v[72:75], v[200:203], v[148:151], v[72:75]
    s_add_u32 s24, s24, 1
    v_mfma_f32_16x16x32_bf16 v[84:87], v[200:203], v[152:155], v[84:87]
    s_cmp_eq_u32 s24, 5
    v_mfma_f32_16x16x32_bf16 v[96:99], v[200:203], v[156:159], v[96:99]
    s_cselect_b32 s3, 23040, 0
    v_mfma_f32_16x16x32_bf16 v[108:111], v[200:203], v[160:163], v[108:111]
    s_cselect_b32 s24, 0, s24
    v_mfma_f32_16x16x32_bf16 v[112:115], v[192:195], v[164:167], v[112:115]
    s_add_u32 s25, s25, s3
    v_mfma_f32_16x16x32_bf16 v[124:127], v[192:195], v[168:171], v[124:127]
    ds_read_b64_tr_b16 v[192:193], v8 offset:6144
    v_mfma_f32_16x16x32_bf16 v[116:119], v[196:199], v[164:167], v[116:119]
    ds_read_b64_tr_b16 v[194:195], v8 offset:6912
    v_mfma_f32_16x16x32_bf16 v[128:131], v[196:199], v[168:171], v[128:131]
    ds_read_b64_tr_b16 v[196:197], v6 offset:12288
    v_mfma_f32_16x16x32_bf16 v[120:123], v[200:203], v[164:167], v[120:123]
    ds_read_b64_tr_b16 v[198:199], v6 offset:13056
    v_mfma_f32_16x16x32_bf16 v[132:135], v[200:203], v[168:171], v[132:135]
    ds_read_b64_tr_b16 v[200:201], v7 offset:12288
    s_waitcnt lgkmcnt(5)
    v_mfma_f32_16x16x32_bf16 v[76:79], v[204:207], v[156:159], v[76:79]
    ds_read_b64_tr_b16 v[202:203], v7 offset:13056
    v_mfma_f32_16x16x32_bf16 v[88:91], v[204:207], v[160:163], v[88:91]
    v_add_u32 v17, s24, v15
    v_mfma_f32_16x16x32_bf16 v[100:103], v[204:207], v[164:167], v[100:103]
    v_lshrrev_b32 v18, 1, v17
    v_mfma_f32_16x16x32_bf16 v[112:115], v[204:207], v[168:171], v[112:115]
    v_and_b32 v18, 2, v18
    v_mfma_f32_16x16x32_bf16 v[124:127], v[204:207], v[172:175], v[124:127]
    ds_read_b64_tr_b16 v[204:205], v8 offset:12288
    v_mfma_f32_16x16x32_bf16 v[80:83], v[208:211], v[156:159], v[80:83]
    ds_read_b64_tr_b16 v[206:207], v8 offset:13056
    v_mfma_f32_16x16x32_bf16 v[92:95], v[208:211], v[160:163], v[92:95]
    v_xor_b32 v18, v18, v16
    v_mfma_f32_16x16x32_bf16 v[104:107], v[208:211], v[164:167], v[104:107]
    v_lshlrev_b32 v18, 4, v18
    v_mfma_f32_16x16x32_bf16 v[116:119], v[208:211], v[168:171], v[116:119]
    v_lshl_add_u32 v18, v17, 6, v18
    v_mfma_f32_16x16x32_bf16 v[128:131], v[208:211], v[172:175], v[128:131]
    ds_read_b64_tr_b16 v[208:209], v6 offset:18432
    s_waitcnt lgkmcnt(3)
    v_mfma_f32_16x16x32_bf16 v[72:75], v[192:195], v[152:155], v[72:75]
    ds_read_b64_tr_b16 v[210:211], v6 offset:19200
    v_mfma_f32_16x16x32_bf16 v[84:87], v[192:195], v[156:159], v[84:87]
    v_add_u32 v2, s25, v18
    v_mfma_f32_16x16x32_bf16 v[96:99], v[192:195], v[160:163], v[96:99]
    v_xor_b32 v3, 32, v2
    v_mfma_f32_16x16x32_bf16 v[108:111], v[192:195], v[164:167], v[108:111]
    ds_read_b128 v[152:155], v3 offset:1280
    v_mfma_f32_16x16x32_bf16 v[120:123], v[192:195], v[168:171], v[120:123]
    ds_read_b128 v[148:151], v2 offset:0
    v_mfma_f32_16x16x32_bf16 v[132:135], v[192:195], v[172:175], v[132:135]
    ds_read_b64_tr_b16 v[192:193], v7 offset:18432
    v_mfma_f32_16x16x32_bf16 v[76:79], v[196:199], v[160:163], v[76:79]
    ds_read_b64_tr_b16 v[194:195], v7 offset:19200
    v_mfma_f32_16x16x32_bf16 v[88:91], v[196:199], v[164:167], v[88:91]
    v_mfma_f32_16x16x32_bf16 v[100:103], v[196:199], v[168:171], v[100:103]
    v_mfma_f32_16x16x32_bf16 v[112:115], v[196:199], v[172:175], v[112:115]
    v_mfma_f32_16x16x32_bf16 v[124:127], v[196:199], v[176:179], v[124:127]
    ds_read_b64_tr_b16 v[196:197], v8 offset:18432
    v_mfma_f32_16x16x32_bf16 v[80:83], v[200:203], v[160:163], v[80:83]
    ds_read_b64_tr_b16 v[198:199], v8 offset:19200
    v_mfma_f32_16x16x32_bf16 v[92:95], v[200:203], v[164:167], v[92:95]
    v_mfma_f32_16x16x32_bf16 v[104:107], v[200:203], v[168:171], v[104:107]
    v_mfma_f32_16x16x32_bf16 v[116:119], v[200:203], v[172:175], v[116:119]
    v_mfma_f32_16x16x32_bf16 v[128:131], v[200:203], v[176:179], v[128:131]
    ds_read_b64_tr_b16 v[200:201], v6 offset:24576
    s_waitcnt lgkmcnt(3)
    v_mfma_f32_16x16x32_bf16 v[72:75], v[204:207], v[156:159], v[72:75]
    ds_read_b64_tr_b16 v[202:203], v6 offset:25344
    v_mfma_f32_16x16x32_bf16 v[84:87], v[204:207], v[160:163], v[84:87]
    s_add_u32 s26, s26, 30720
    v_mfma_f32_16x16x32_bf16 v[96:99], v[204:207], v[164:167], v[96:99]
    s_cmp_eq_u32 s26, 92160
    v_mfma_f32_16x16x32_bf16 v[108:111], v[204:207], v[168:171], v[108:111]
    s_cselect_b32 s33, 4294875136, 0
    v_mfma_f32_16x16x32_bf16 v[120:123], v[204:207], v[172:175], v[120:123]
    s_cselect_b32 s26, 0, s26
    v_mfma_f32_16x16x32_bf16 v[132:135], v[204:207], v[176:179], v[132:135]
    ds_read_b64_tr_b16 v[204:205], v7 offset:24576
    v_mfma_f32_16x16x32_bf16 v[76:79], v[208:211], v[164:167], v[76:79]
    ds_read_b64_tr_b16 v[206:207], v7 offset:25344
    v_mfma_f32_16x16x32_bf16 v[88:91], v[208:211], v[168:171], v[88:91]
    s_add_u32 s33, s33, 30720
    v_mfma_f32_16x16x32_bf16 v[100:103], v[208:211], v[172:175], v[100:103]
    ds_read_b128 v[156:159], v2 offset:2560
    v_mfma_f32_16x16x32_bf16 v[112:115], v[208:211], v[176:179], v[112:115]
    v_mfma_f32_16x16x32_bf16 v[124:127], v[208:211], v[180:183], v[124:127]
    ds_read_b64_tr_b16 v[208:209], v8 offset:24576
    v_mfma_f32_16x16x32_bf16 v[80:83], v[192:195], v[164:167], v[80:83]
    ds_read_b64_tr_b16 v[210:211], v8 offset:25344
    v_mfma_f32_16x16x32_bf16 v[92:95], v[192:195], v[168:171], v[92:95]
    v_add_u32 v6, s33, v6
    v_mfma_f32_16x16x32_bf16 v[104:107], v[192:195], v[172:175], v[104:107]
    v_add_u32 v7, s33, v7
    v_mfma_f32_16x16x32_bf16 v[116:119], v[192:195], v[176:179], v[116:119]
    v_add_u32 v8, s33, v8
    v_mfma_f32_16x16x32_bf16 v[128:131], v[192:195], v[180:183], v[128:131]
    s_waitcnt lgkmcnt(3)
    v_mfma_f32_16x16x32_bf16 v[72:75], v[196:199], v[160:163], v[72:75]
    ds_read_b128 v[160:163], v3 offset:3840
    v_mfma_f32_16x16x32_bf16 v[84:87], v[196:199], v[164:167], v[84:87]
    s_waitcnt lgkmcnt(1)
    s_barrier
    v_mfma_f32_16x16x32_bf16 v[96:99], v[196:199], v[168:171], v[96:99]
    ds_read_b64_tr_b16 v[192:193], v6 offset:0
    v_mfma_f32_16x16x32_bf16 v[108:111], v[196:199], v[172:175], v[108:111]
    ds_read_b64_tr_b16 v[194:195], v6 offset:768
    v_mfma_f32_16x16x32_bf16 v[120:123], v[196:199], v[176:179], v[120:123]
    v_mfma_f32_16x16x32_bf16 v[132:135], v[196:199], v[180:183], v[132:135]
    ds_read_b64_tr_b16 v[196:197], v7 offset:0
    v_mfma_f32_16x16x32_bf16 v[76:79], v[200:203], v[168:171], v[76:79]
    ds_read_b64_tr_b16 v[198:199], v7 offset:768
    v_mfma_f32_16x16x32_bf16 v[88:91], v[200:203], v[172:175], v[88:91]
    v_mfma_f32_16x16x32_bf16 v[80:83], v[204:207], v[168:171], v[80:83]
    v_mfma_f32_16x16x32_bf16 v[92:95], v[204:207], v[172:175], v[92:95]
    v_mfma_f32_16x16x32_bf16 v[72:75], v[208:211], v[164:167], v[72:75]
    ds_read_b128 v[164:167], v2 offset:5120
    v_mfma_f32_16x16x32_bf16 v[84:87], v[208:211], v[168:171], v[84:87]
    ds_read_b128 v[168:171], v3 offset:6400
    v_mfma_f32_16x16x32_bf16 v[96:99], v[208:211], v[172:175], v[96:99]
    ds_read_b128 v[172:175], v2 offset:7680
    v_mfma_f32_16x16x32_bf16 v[100:103], v[200:203], v[176:179], v[100:103]
    v_mfma_f32_16x16x32_bf16 v[112:115], v[200:203], v[180:183], v[112:115]
    v_mfma_f32_16x16x32_bf16 v[124:127], v[200:203], v[184:187], v[124:127]
    ds_read_b64_tr_b16 v[200:201], v8 offset:0
    v_mfma_f32_16x16x32_bf16 v[104:107], v[204:207], v[176:179], v[104:107]
    ds_read_b64_tr_b16 v[202:203], v8 offset:768
    v_mfma_f32_16x16x32_bf16 v[116:119], v[204:207], v[180:183], v[116:119]
    v_mfma_f32_16x16x32_bf16 v[128:131], v[204:207], v[184:187], v[128:131]
    v_mfma_f32_16x16x32_bf16 v[108:111], v[208:211], v[176:179], v[108:111]
    v_mfma_f32_16x16x32_bf16 v[120:123], v[208:211], v[180:183], v[120:123]
    v_mfma_f32_16x16x32_bf16 v[132:135], v[208:211], v[184:187], v[132:135]
    ds_read_b64_tr_b16 v[204:205], v6 offset:6144
    s_waitcnt lgkmcnt(3)
    v_mfma_f32_16x16x32_bf16 v[76:79], v[192:195], v[152:155], v[76:79]
    ds_read_b64_tr_b16 v[206:207], v6 offset:6912
    v_mfma_f32_16x16x32_bf16 v[88:91], v[192:195], v[156:159], v[88:91]
    ds_read_b64_tr_b16 v[208:209], v7 offset:6144
    v_mfma_f32_16x16x32_bf16 v[100:103], v[192:195], v[160:163], v[100:103]
    ds_read_b64_tr_b16 v[210:211], v7 offset:6912
    v_mfma_f32_16x16x32_bf16 v[80:83], v[196:199], v[152:155], v[80:83]
    ds_read_b128 v[176:179], v3 offset:8960
    v_mfma_f32_16x16x32_bf16 v[92:95], v[196:199], v[156:159], v[92:95]
    ds_read_b128 v[180:183], v2 offset:10240
    v_mfma_f32_16x16x32_bf16 v[104:107], v[196:199], v[160:163], v[104:107]
    ds_read_b128 v[184:187], v3 offset:11520
    s_waitcnt lgkmcnt(7)
    v_mfma_f32_16x16x32_bf16 v[72:75], v[200:203], v[148:151], v[72:75]
    s_add_u32 s24, s24, 1
    v_mfma_f32_16x16x32_bf16 v[84:87], v[200:203], v[152:155], v[84:87]
    s_cmp_eq_u32 s24, 5
    v_mfma_f32_16x16x32_bf16 v[96:99], v[200:203], v[156:159], v[96:99]
    s_cselect_b32 s3, 23040, 0
    v_mfma_f32_16x16x32_bf16 v[108:111], v[200:203], v[160:163], v[108:111]
    s_cselect_b32 s24, 0, s24
    v_mfma_f32_16x16x32_bf16 v[112:115], v[192:195], v[164:167], v[112:115]
    s_add_u32 s25, s25, s3
    v_mfma_f32_16x16x32_bf16 v[124:127], v[192:195], v[168:171], v[124:127]
    ds_read_b64_tr_b16 v[192:193], v8 offset:6144
    v_mfma_f32_16x16x32_bf16 v[116:119], v[196:199], v[164:167], v[116:119]
    ds_read_b64_tr_b16 v[194:195], v8 offset:6912
    v_mfma_f32_16x16x32_bf16 v[128:131], v[196:199], v[168:171], v[128:131]
    ds_read_b64_tr_b16 v[196:197], v6 offset:12288
    v_mfma_f32_16x16x32_bf16 v[120:123], v[200:203], v[164:167], v[120:123]
    ds_read_b64_tr_b16 v[198:199], v6 offset:13056
    v_mfma_f32_16x16x32_bf16 v[132:135], v[200:203], v[168:171], v[132:135]
    ds_read_b64_tr_b16 v[200:201], v7 offset:12288
    s_waitcnt lgkmcnt(5)
    v_mfma_f32_16x16x32_bf16 v[76:79], v[204:207], v[156:159], v[76:79]
    ds_read_b64_tr_b16 v[202:203], v7 offset:13056
    v_mfma_f32_16x16x32_bf16 v[88:91], v[204:207], v[160:163], v[88:91]
    v_add_u32 v17, s24, v15
    v_mfma_f32_16x16x32_bf16 v[100:103], v[204:207], v[164:167], v[100:103]
    v_lshrrev_b32 v18, 1, v17
    v_mfma_f32_16x16x32_bf16 v[112:115], v[204:207], v[168:171], v[112:115]
    v_and_b32 v18, 2, v18
    v_mfma_f32_16x16x32_bf16 v[124:127], v[204:207], v[172:175], v[124:127]
    ds_read_b64_tr_b16 v[204:205], v8 offset:12288
    v_mfma_f32_16x16x32_bf16 v[80:83], v[208:211], v[156:159], v[80:83]
    ds_read_b64_tr_b16 v[206:207], v8 offset:13056
    v_mfma_f32_16x16x32_bf16 v[92:95], v[208:211], v[160:163], v[92:95]
    v_xor_b32 v18, v18, v16
    v_mfma_f32_16x16x32_bf16 v[104:107], v[208:211], v[164:167], v[104:107]
    v_lshlrev_b32 v18, 4, v18
    v_mfma_f32_16x16x32_bf16 v[116:119], v[208:211], v[168:171], v[116:119]
    v_lshl_add_u32 v18, v17, 6, v18
    v_mfma_f32_16x16x32_bf16 v[128:131], v[208:211], v[172:175], v[128:131]
    ds_read_b64_tr_b16 v[208:209], v6 offset:18432
    s_waitcnt lgkmcnt(3)
    v_mfma_f32_16x16x32_bf16 v[72:75], v[192:195], v[152:155], v[72:75]
    ds_read_b64_tr_b16 v[210:211], v6 offset:19200
    v_mfma_f32_16x16x32_bf16 v[84:87], v[192:195], v[156:159], v[84:87]
    v_add_u32 v2, s25, v18
    v_mfma_f32_16x16x32_bf16 v[96:99], v[192:195], v[160:163], v[96:99]
    v_xor_b32 v3, 32, v2
    v_mfma_f32_16x16x32_bf16 v[108:111], v[192:195], v[164:167], v[108:111]
    ds_read_b128 v[152:155], v3 offset:1280
    v_mfma_f32_16x16x32_bf16 v[120:123], v[192:195], v[168:171], v[120:123]
    ds_read_b128 v[148:151], v2 offset:0
    v_mfma_f32_16x16x32_bf16 v[132:135], v[192:195], v[172:175], v[132:135]
    ds_read_b64_tr_b16 v[192:193], v7 offset:18432
    v_mfma_f32_16x16x32_bf16 v[76:79], v[196:199], v[160:163], v[76:79]
    ds_read_b64_tr_b16 v[194:195], v7 offset:19200
    v_mfma_f32_16x16x32_bf16 v[88:91], v[196:199], v[164:167], v[88:91]
    v_mfma_f32_16x16x32_bf16 v[100:103], v[196:199], v[168:171], v[100:103]
    v_mfma_f32_16x16x32_bf16 v[112:115], v[196:199], v[172:175], v[112:115]
    v_mfma_f32_16x16x32_bf16 v[124:127], v[196:199], v[176:179], v[124:127]
    ds_read_b64_tr_b16 v[196:197], v8 offset:18432
    v_mfma_f32_16x16x32_bf16 v[80:83], v[200:203], v[160:163], v[80:83]
    ds_read_b64_tr_b16 v[198:199], v8 offset:19200
    v_mfma_f32_16x16x32_bf16 v[92:95], v[200:203], v[164:167], v[92:95]
    v_mfma_f32_16x16x32_bf16 v[104:107], v[200:203], v[168:171], v[104:107]
    v_mfma_f32_16x16x32_bf16 v[116:119], v[200:203], v[172:175], v[116:119]
    v_mfma_f32_16x16x32_bf16 v[128:131], v[200:203], v[176:179], v[128:131]
    ds_read_b64_tr_b16 v[200:201], v6 offset:24576
    s_waitcnt lgkmcnt(3)
    v_mfma_f32_16x16x32_bf16 v[72:75], v[204:207], v[156:159], v[72:75]
    ds_read_b64_tr_b16 v[202:203], v6 offset:25344
    v_mfma_f32_16x16x32_bf16 v[84:87], v[204:207], v[160:163], v[84:87]
    s_add_u32 s26, s26, 30720
    v_mfma_f32_16x16x32_bf16 v[96:99], v[204:207], v[164:167], v[96:99]
    s_cmp_eq_u32 s26, 92160
    v_mfma_f32_16x16x32_bf16 v[108:111], v[204:207], v[168:171], v[108:111]
    s_cselect_b32 s33, 4294875136, 0
    v_mfma_f32_16x16x32_bf16 v[120:123], v[204:207], v[172:175], v[120:123]
    s_cselect_b32 s26, 0, s26
    v_mfma_f32_16x16x32_bf16 v[132:135], v[204:207], v[176:179], v[132:135]
    ds_read_b64_tr_b16 v[204:205], v7 offset:24576
    v_mfma_f32_16x16x32_bf16 v[76:79], v[208:211], v[164:167], v[76:79]
    ds_read_b64_tr_b16 v[206:207], v7 offset:25344
    v_mfma_f32_16x16x32_bf16 v[88:91], v[208:211], v[168:171], v[88:91]
    s_add_u32 s33, s33, 30720
    v_mfma_f32_16x16x32_bf16 v[100:103], v[208:211], v[172:175], v[100:103]
    ds_read_b128 v[156:159], v2 offset:2560
    v_mfma_f32_16x16x32_bf16 v[112:115], v[208:211], v[176:179], v[112:115]
    v_mfma_f32_16x16x32_bf16 v[124:127], v[208:211], v[180:183], v[124:127]
    ds_read_b64_tr_b16 v[208:209], v8 offset:24576
    v_mfma_f32_16x16x32_bf16 v[80:83], v[192:195], v[164:167], v[80:83]
    ds_read_b64_tr_b16 v[210:211], v8 offset:25344
    v_mfma_f32_16x16x32_bf16 v[92:95], v[192:195], v[168:171], v[92:95]
    v_add_u32 v6, s33, v6
    v_mfma_f32_16x16x32_bf16 v[104:107], v[192:195], v[172:175], v[104:107]
    v_add_u32 v7, s33, v7
    v_mfma_f32_16x16x32_bf16 v[116:119], v[192:195], v[176:179], v[116:119]
    v_add_u32 v8, s33, v8
    v_mfma_f32_16x16x32_bf16 v[128:131], v[192:195], v[180:183], v[128:131]
    s_waitcnt lgkmcnt(3)
    v_mfma_f32_16x16x32_bf16 v[72:75], v[196:199], v[160:163], v[72:75]
    ds_read_b128 v[160:163], v3 offset:3840
    v_mfma_f32_16x16x32_bf16 v[84:87], v[196:199], v[164:167], v[84:87]
    s_waitcnt lgkmcnt(1)
    s_barrier
    v_mfma_f32_16x16x32_bf16 v[96:99], v[196:199], v[168:171], v[96:99]
    ds_read_b64_tr_b16 v[192:193], v6 offset:0
    v_mfma_f32_16x16x32_bf16 v[108:111], v[196:199], v[172:175], v[108:111]
    ds_read_b64_tr_b16 v[194:195], v6 offset:768
    v_mfma_f32_16x16x32_bf16 v[120:123], v[196:199], v[176:179], v[120:123]
    v_mfma_f32_16x16x32_bf16 v[132:135], v[196:199], v[180:183], v[132:135]
    ds_read_b64_tr_b16 v[196:197], v7 offset:0
    v_mfma_f32_16x16x32_bf16 v[76:79], v[200:203], v[168:171], v[76:79]
    ds_read_b64_tr_b16 v[198:199], v7 offset:768
    v_mfma_f32_16x16x32_bf16 v[88:91], v[200:203], v[172:175], v[88:91]
    v_mfma_f32_16x16x32_bf16 v[80:83], v[204:207], v[168:171], v[80:83]
    v_mfma_f32_16x16x32_bf16 v[92:95], v[204:207], v[172:175], v[92:95]
    v_mfma_f32_16x16x32_bf16 v[72:75], v[208:211], v[164:167], v[72:75]
    ds_read_b128 v[164:167], v2 offset:5120
    v_mfma_f32_16x16x32_bf16 v[84:87], v[208:211], v[168:171], v[84:87]
    ds_read_b128 v[168:171], v3 offset:6400
    v_mfma_f32_16x16x32_bf16 v[96:99], v[208:211], v[172:175], v[96:99]
    ds_read_b128 v[172:175], v2 offset:7680
    v_mfma_f32_16x16x32_bf16 v[100:103], v[200:203], v[176:179], v[100:103]
    v_mfma_f32_16x16x32_bf16 v[112:115], v[200:203], v[180:183], v[112:115]
    v_mfma_f32_16x16x32_bf16 v[124:127], v[200:203], v[184:187], v[124:127]
    ds_read_b64_tr_b16 v[200:201], v8 offset:0
    v_mfma_f32_16x16x32_bf16 v[104:107], v[204:207], v[176:179], v[104:107]
    ds_read_b64_tr_b16 v[202:203], v8 offset:768
    v_mfma_f32_16x16x32_bf16 v[116:119], v[204:207], v[180:183], v[116:119]
    v_mfma_f32_16x16x32_bf16 v[128:131], v[204:207], v[184:187], v[128:131]
    v_mfma_f32_16x16x32_bf16 v[108:111], v[208:211], v[176:179], v[108:111]
    v_mfma_f32_16x16x32_bf16 v[120:123], v[208:211], v[180:183], v[120:123]
    s_add_u32 s27, s27, 2
    v_mfma_f32_16x16x32_bf16 v[132:135], v[208:211], v[184:187], v[132:135]
    s_cmp_lt_u32 s27, 13
    s_cbranch_scc1 L_loop5
    ds_read_b64_tr_b16 v[176:177], v6 offset:6144
    ds_read_b64_tr_b16 v[178:179], v6 offset:6912
    ds_read_b64_tr_b16 v[180:181], v7 offset:6144
    s_waitcnt lgkmcnt(10)
    v_mfma_f32_16x16x32_bf16 v[76:79], v[192:195], v[152:155], v[76:79]
    ds_read_b64_tr_b16 v[182:183], v7 offset:6912
    ds_read_b64_tr_b16 v[184:185], v8 offset:6144
    v_mfma_f32_16x16x32_bf16 v[88:91], v[192:195], v[156:159], v[88:91]
    ds_read_b64_tr_b16 v[186:187], v8 offset:6912
    ds_read_b64_tr_b16 v[188:189], v6 offset:12288
    s_waitcnt lgkmcnt(12)
    v_mfma_f32_16x16x32_bf16 v[80:83], v[196:199], v[152:155], v[80:83]
    ds_read_b64_tr_b16 v[190:191], v6 offset:13056
    ds_read_b64_tr_b16 v[204:205], v7 offset:12288
    v_mfma_f32_16x16x32_bf16 v[92:95], v[196:199], v[156:159], v[92:95]
    ds_read_b64_tr_b16 v[206:207], v7 offset:13056
    ds_read_b64_tr_b16 v[208:209], v8 offset:12288
    s_waitcnt lgkmcnt(11)
    v_mfma_f32_16x16x32_bf16 v[72:75], v[200:203], v[148:151], v[72:75]
    ds_read_b64_tr_b16 v[210:211], v8 offset:13056
    ds_read_b64_tr_b16 v[212:213], v6 offset:18432
    v_mfma_f32_16x16x32_bf16 v[84:87], v[200:203], v[152:155], v[84:87]
    ds_read_b64_tr_b16 v[214:215], v6 offset:19200
    ds_read_b64_tr_b16 v[216:217], v7 offset:18432
    v_mfma_f32_16x16x32_bf16 v[96:99], v[200:203], v[156:159], v[96:99]
    ds_read_b64_tr_b16 v[218:219], v7 offset:19200
    ds_read_b64_tr_b16 v[220:221], v8 offset:18432
    s_waitcnt lgkmcnt(15)
    v_mfma_f32_16x16x32_bf16 v[76:79], v[176:179], v[156:159], v[76:79]
    ds_read_b64_tr_b16 v[222:223], v8 offset:19200
    ds_read_b64_tr_b16 v[224:225], v6 offset:24576
    v_mfma_f32_16x16x32_bf16 v[88:91], v[176:179], v[160:163], v[88:91]
    ds_read_b64_tr_b16 v[226:227], v6 offset:25344
    ds_read_b64_tr_b16 v[228:229], v7 offset:24576
    s_waitcnt lgkmcnt(15)
    v_mfma_f32_16x16x32_bf16 v[80:83], v[180:183], v[156:159], v[80:83]
    ds_read_b64_tr_b16 v[230:231], v7 offset:25344
    ds_read_b64_tr_b16 v[232:233], v8 offset:24576
    v_mfma_f32_16x16x32_bf16 v[92:95], v[180:183], v[160:163], v[92:95]
    ds_read_b64_tr_b16 v[234:235], v8 offset:25344
    ds_read_b64_tr_b16 v[236:237], v6 offset:30720
    v_mfma_f32_16x16x32_bf16 v[72:75], v[184:187], v[152:155], v[72:75]
    ds_read_b64_tr_b16 v[238:239], v6 offset:31488
    v_mfma_f32_16x16x32_bf16 v[84:87], v[184:187], v[156:159], v[84:87]
    ds_read_b128 v[240:243], v27 offset:1280
    v_mfma_f32_16x16x32_bf16 v[96:99], v[184:187], v[160:163], v[96:99]
    ds_read_b128 v[244:247], v26 offset:2560
    s_waitcnt lgkmcnt(13)
    v_mfma_f32_16x16x32_bf16 v[76:79], v[188:191], v[160:163], v[76:79]
    ds_read_b64_tr_b16 v[248:249], v7 offset:30720
    v_mfma_f32_16x16x32_bf16 v[88:91], v[188:191], v[164:167], v[88:91]
    ds_read_b64_tr_b16 v[250:251], v7 offset:31488
    v_mfma_f32_16x16x32_bf16 v[80:83], v[204:207], v[160:163], v[80:83]
    ds_read_b64_tr_b16 v[252:253], v8 offset:30720
    v_mfma_f32_16x16x32_bf16 v[92:95], v[204:207], v[164:167], v[92:95]
    ds_read_b64_tr_b16 v[254:255], v8 offset:31488
    v_mfma_f32_16x16x32_bf16 v[72:75], v[208:211], v[156:159], v[72:75]
    ds_read_b128 v[192:195], v26 offset:0
    v_mfma_f32_16x16x32_bf16 v[84:87], v[208:211], v[160:163], v[84:87]
    ds_read_b64_tr_b16 v[196:197], v6 offset:36864
    v_mfma_f32_16x16x32_bf16 v[96:99], v[208:211], v[164:167], v[96:99]
    ds_read_b64_tr_b16 v[198:199], v6 offset:37632
    v_mfma_f32_16x16x32_bf16 v[76:79], v[212:215], v[164:167], v[76:79]
    ds_read_b128 v[148:151], v27 offset:3840
    v_mfma_f32_16x16x32_bf16 v[88:91], v[212:215], v[168:171], v[88:91]
    ds_read_b64_tr_b16 v[200:201], v7 offset:36864
    s_waitcnt lgkmcnt(8)
    v_mfma_f32_16x16x32_bf16 v[80:83], v[216:219], v[164:167], v[80:83]
    ds_read_b64_tr_b16 v[202:203], v7 offset:37632
    v_mfma_f32_16x16x32_bf16 v[92:95], v[216:219], v[168:171], v[92:95]
    ds_read_b64_tr_b16 v[176:177], v8 offset:36864
    v_mfma_f32_16x16x32_bf16 v[72:75], v[220:223], v[160:163], v[72:75]
    ds_read_b64_tr_b16 v[178:179], v8 offset:37632
    v_mfma_f32_16x16x32_bf16 v[84:87], v[220:223], v[164:167], v[84:87]
    ds_read_b64_tr_b16 v[180:181], v6 offset:43008
    v_mfma_f32_16x16x32_bf16 v[96:99], v[220:223], v[168:171], v[96:99]
    ds_read_b64_tr_b16 v[182:183], v6 offset:43776
    v_mfma_f32_16x16x32_bf16 v[76:79], v[224:227], v[168:171], v[76:79]
    ds_read_b128 v[152:155], v26 offset:5120
    v_mfma_f32_16x16x32_bf16 v[88:91], v[224:227], v[172:175], v[88:91]
    ds_read_b64_tr_b16 v[184:185], v7 offset:43008
    v_mfma_f32_16x16x32_bf16 v[80:83], v[228:231], v[168:171], v[80:83]
    ds_read_b64_tr_b16 v[186:187], v7 offset:43776
    v_mfma_f32_16x16x32_bf16 v[92:95], v[228:231], v[172:175], v[92:95]
    ds_read_b64_tr_b16 v[188:189], v8 offset:43008
    v_mfma_f32_16x16x32_bf16 v[72:75], v[232:235], v[164:167], v[72:75]
    ds_read_b64_tr_b16 v[190:191], v8 offset:43776
    v_mfma_f32_16x16x32_bf16 v[84:87], v[232:235], v[168:171], v[84:87]
    ds_read_b64_tr_b16 v[204:205], v6 offset:49152
    v_mfma_f32_16x16x32_bf16 v[96:99], v[232:235], v[172:175], v[96:99]
    ds_read_b64_tr_b16 v[206:207], v6 offset:49920
    v_mfma_f32_16x16x32_bf16 v[76:79], v[236:239], v[240:243], v[76:79]
    ds_read_b128 v[156:159], v27 offset:6400
    v_mfma_f32_16x16x32_bf16 v[88:91], v[236:239], v[244:247], v[88:91]
    ds_read_b64_tr_b16 v[208:209], v7 offset:49152
    s_waitcnt lgkmcnt(8)
    v_mfma_f32_16x16x32_bf16 v[80:83], v[248:251], v[240:243], v[80:83]
    ds_read_b64_tr_b16 v[210:211], v7 offset:49920
    v_mfma_f32_16x16x32_bf16 v[92:95], v[248:251], v[244:247], v[92:95]
    ds_read_b64_tr_b16 v[212:213], v8 offset:49152
    v_mfma_f32_16x16x32_bf16 v[72:75], v[252:255], v[192:195], v[72:75]
    ds_read_b64_tr_b16 v[214:215], v8 offset:49920
    v_mfma_f32_16x16x32_bf16 v[84:87], v[252:255], v[240:243], v[84:87]
    ds_read_b64_tr_b16 v[216:217], v6 offset:55296
    v_mfma_f32_16x16x32_bf16 v[96:99], v[252:255], v[244:247], v[96:99]
    ds_read_b64_tr_b16 v[218:219], v6 offset:56064
    v_mfma_f32_16x16x32_bf16 v[76:79], v[196:199], v[244:247], v[76:79]
    ds_read_b128 v[160:163], v26 offset:7680
    v_mfma_f32_16x16x32_bf16 v[88:91], v[196:199], v[148:151], v[88:91]
    ds_read_b64_tr_b16 v[220:221], v7 offset:55296
    v_mfma_f32_16x16x32_bf16 v[80:83], v[200:203], v[244:247], v[80:83]
    ds_read_b64_tr_b16 v[222:223], v7 offset:56064
    v_mfma_f32_16x16x32_bf16 v[92:95], v[200:203], v[148:151], v[92:95]
    ds_read_b64_tr_b16 v[224:225], v8 offset:55296
    v_mfma_f32_16x16x32_bf16 v[72:75], v[176:179], v[240:243], v[72:75]
    ds_read_b64_tr_b16 v[226:227], v8 offset:56064
    v_mfma_f32_16x16x32_bf16 v[84:87], v[176:179], v[244:247], v[84:87]
    ds_read_b128 v[228:231], v27 offset:8960
    v_mfma_f32_16x16x32_bf16 v[96:99], v[176:179], v[148:151], v[96:99]
    ds_read_b64_tr_b16 v[164:165], v6 offset:0
    v_mfma_f32_16x16x32_bf16 v[76:79], v[180:183], v[148:151], v[76:79]
    ds_read_b64_tr_b16 v[166:167], v6 offset:768
    v_mfma_f32_16x16x32_bf16 v[88:91], v[180:183], v[152:155], v[88:91]
    ds_read_b128 v[168:171], v3 offset:3840
    s_waitcnt lgkmcnt(8)
    v_mfma_f32_16x16x32_bf16 v[80:83], v[184:187], v[148:151], v[80:83]
    ds_read_b64_tr_b16 v[172:173], v7 offset:0
    v_mfma_f32_16x16x32_bf16 v[92:95], v[184:187], v[152:155], v[92:95]
    ds_read_b64_tr_b16 v[174:175], v7 offset:768
    v_mfma_f32_16x16x32_bf16 v[72:75], v[188:191], v[244:247], v[72:75]
    ds_read_b64_tr_b16 v[232:233], v8 offset:0
    v_mfma_f32_16x16x32_bf16 v[84:87], v[188:191], v[148:151], v[84:87]
    ds_read_b64_tr_b16 v[234:235], v8 offset:768
    v_mfma_f32_16x16x32_bf16 v[96:99], v[188:191], v[152:155], v[96:99]
    ds_read_b64_tr_b16 v[192:193], v6 offset:6144
    v_mfma_f32_16x16x32_bf16 v[76:79], v[204:207], v[152:155], v[76:79]
    ds_read_b64_tr_b16 v[194:195], v6 offset:6912
    v_mfma_f32_16x16x32_bf16 v[88:91], v[204:207], v[156:159], v[88:91]
    ds_read_b128 v[240:243], v2 offset:5120
    v_mfma_f32_16x16x32_bf16 v[80:83], v[208:211], v[152:155], v[80:83]
    ds_read_b64_tr_b16 v[244:245], v7 offset:6144
    v_mfma_f32_16x16x32_bf16 v[92:95], v[208:211], v[156:159], v[92:95]
    ds_read_b64_tr_b16 v[246:247], v7 offset:6912
    v_mfma_f32_16x16x32_bf16 v[72:75], v[212:215], v[148:151], v[72:75]
    v_mfma_f32_16x16x32_bf16 v[84:87], v[212:215], v[152:155], v[84:87]
    v_mfma_f32_16x16x32_bf16 v[96:99], v[212:215], v[156:159], v[96:99]
    v_mfma_f32_16x16x32_bf16 v[76:79], v[216:219], v[156:159], v[76:79]
    v_mfma_f32_16x16x32_bf16 v[88:91], v[216:219], v[160:163], v[88:91]
    s_waitcnt lgkmcnt(3)
    v_mfma_f32_16x16x32_bf16 v[80:83], v[220:223], v[156:159], v[80:83]
    v_mfma_f32_16x16x32_bf16 v[92:95], v[220:223], v[160:163], v[92:95]
    v_mfma_f32_16x16x32_bf16 v[72:75], v[224:227], v[152:155], v[72:75]
    v_mfma_f32_16x16x32_bf16 v[84:87], v[224:227], v[156:159], v[84:87]
    v_mfma_f32_16x16x32_bf16 v[96:99], v[224:227], v[160:163], v[96:99]
    v_mfma_f32_16x16x32_bf16 v[100:103], v[236:239], v[148:151], v[100:103]
    ds_read_b64_tr_b16 v[236:237], v8 offset:6144
    ds_read_b64_tr_b16 v[238:239], v8 offset:6912
    v_mfma_f32_16x16x32_bf16 v[104:107], v[248:251], v[148:151], v[104:107]
    ds_read_b64_tr_b16 v[248:249], v6 offset:12288
    ds_read_b64_tr_b16 v[250:251], v6 offset:13056
    v_mfma_f32_16x16x32_bf16 v[108:111], v[252:255], v[148:151], v[108:111]
    ds_read_b128 v[148:151], v3 offset:6400
    ds_read_b64_tr_b16 v[252:253], v7 offset:12288
    v_mfma_f32_16x16x32_bf16 v[100:103], v[196:199], v[152:155], v[100:103]
    ds_read_b64_tr_b16 v[254:255], v7 offset:13056
    ds_read_b64_tr_b16 v[196:197], v8 offset:12288
    v_mfma_f32_16x16x32_bf16 v[104:107], v[200:203], v[152:155], v[104:107]
    ds_read_b64_tr_b16 v[198:199], v8 offset:13056
    ds_read_b64_tr_b16 v[200:201], v6 offset:18432
    v_mfma_f32_16x16x32_bf16 v[108:111], v[176:179], v[152:155], v[108:111]
    ds_read_b64_tr_b16 v[202:203], v6 offset:19200
    ds_read_b128 v[152:155], v2 offset:7680
    v_mfma_f32_16x16x32_bf16 v[100:103], v[180:183], v[156:159], v[100:103]
    ds_read_b64_tr_b16 v[176:177], v7 offset:18432
    ds_read_b64_tr_b16 v[178:179], v7 offset:19200
    v_mfma_f32_16x16x32_bf16 v[104:107], v[184:187], v[156:159], v[104:107]
    ds_read_b64_tr_b16 v[180:181], v8 offset:18432
    ds_read_b64_tr_b16 v[182:183], v8 offset:19200
    v_mfma_f32_16x16x32_bf16 v[108:111], v[188:191], v[156:159], v[108:111]
    ds_read_b64_tr_b16 v[184:185], v6 offset:24576
    ds_read_b64_tr_b16 v[186:187], v6 offset:25344
    v_mfma_f32_16x16x32_bf16 v[100:103], v[204:207], v[160:163], v[100:103]
    ds_read_b128 v[156:159], v3 offset:8960
    ds_read_b64_tr_b16 v[188:189], v7 offset:24576
    v_mfma_f32_16x16x32_bf16 v[104:107], v[208:211], v[160:163], v[104:107]
    ds_read_b64_tr_b16 v[190:191], v7 offset:25344
    v_mfma_f32_16x16x32_bf16 v[108:111], v[212:215], v[160:163], v[108:111]
    ds_read_b64_tr_b16 v[204:205], v8 offset:24576
    v_mfma_f32_16x16x32_bf16 v[100:103], v[216:219], v[228:231], v[100:103]
    ds_read_b64_tr_b16 v[206:207], v8 offset:25344
    v_mfma_f32_16x16x32_bf16 v[104:107], v[220:223], v[228:231], v[104:107]
    v_cvt_pk_bf16_f32 v76, v76, v77
    v_mfma_f32_16x16x32_bf16 v[108:111], v[224:227], v[228:231], v[108:111]
    v_cvt_pk_bf16_f32 v77, v78, v79
    v_mfma_f32_16x16x32_bf16 v[100:103], v[164:167], v[168:171], v[100:103]
    ds_write_b64 v20, v[76:77] offset:3072
    v_mfma_f32_16x16x32_bf16 v[104:107], v[172:175], v[168:171], v[104:107]
    v_cvt_pk_bf16_f32 v88, v88, v89
    v_mfma_f32_16x16x32_bf16 v[108:111], v[232:235], v[168:171], v[108:111]
    v_cvt_pk_bf16_f32 v89, v90, v91
    s_waitcnt lgkmcnt(4)
    v_mfma_f32_16x16x32_bf16 v[100:103], v[192:195], v[240:243], v[100:103]
    ds_write_b64 v20, v[88:89] offset:6144
    v_mfma_f32_16x16x32_bf16 v[104:107], v[244:247], v[240:243], v[104:107]
    v_cvt_pk_bf16_f32 v80, v80, v81
    v_mfma_f32_16x16x32_bf16 v[108:111], v[236:239], v[240:243], v[108:111]
    v_cvt_pk_bf16_f32 v81, v82, v83
    v_mfma_f32_16x16x32_bf16 v[100:103], v[248:251], v[148:151], v[100:103]
    ds_write_b64 v20, v[80:81] offset:3136
    v_mfma_f32_16x16x32_bf16 v[104:107], v[252:255], v[148:151], v[104:107]
    v_cvt_pk_bf16_f32 v92, v92, v93
    v_mfma_f32_16x16x32_bf16 v[108:111], v[196:199], v[148:151], v[108:111]
    v_cvt_pk_bf16_f32 v93, v94, v95
    v_mfma_f32_16x16x32_bf16 v[100:103], v[200:203], v[152:155], v[100:103]
    ds_write_b64 v20, v[92:93] offset:6208
    v_mfma_f32_16x16x32_bf16 v[104:107], v[176:179], v[152:155], v[104:107]
    v_cvt_pk_bf16_f32 v72, v72, v73
    v_mfma_f32_16x16x32_bf16 v[108:111], v[180:183], v[152:155], v[108:111]
    v_cvt_pk_bf16_f32 v73, v74, v75
    v_mfma_f32_16x16x32_bf16 v[100:103], v[184:187], v[156:159], v[100:103]
    ds_write_b64 v20, v[72:73] offset:128
    s_waitcnt lgkmcnt(3)
    v_mfma_f32_16x16x32_bf16 v[104:107], v[188:191], v[156:159], v[104:107]
    v_cvt_pk_bf16_f32 v84, v84, v85
    v_mfma_f32_16x16x32_bf16 v[108:111], v[204:207], v[156:159], v[108:111]
    v_cvt_pk_bf16_f32 v85, v86, v87
    v_mfma_f32_16x16x32_bf16 v[112:115], v[164:167], v[240:243], v[112:115]
    ds_write_b64 v20, v[84:85] offset:3200
    v_mfma_f32_16x16x32_bf16 v[124:127], v[164:167], v[148:151], v[124:127]
    v_cvt_pk_bf16_f32 v96, v96, v97
    v_mfma_f32_16x16x32_bf16 v[116:119], v[172:175], v[240:243], v[116:119]
    ds_read_b128 v[208:211], v2 offset:10240
    v_mfma_f32_16x16x32_bf16 v[128:131], v[172:175], v[148:151], v[128:131]
    v_cvt_pk_bf16_f32 v97, v98, v99
    v_mfma_f32_16x16x32_bf16 v[120:123], v[232:235], v[240:243], v[120:123]
    ds_write_b64 v20, v[96:97] offset:6272
    v_mfma_f32_16x16x32_bf16 v[132:135], v[232:235], v[148:151], v[132:135]
    ds_read_b128 v[160:163], v3 offset:11520
    v_mfma_f32_16x16x32_bf16 v[112:115], v[192:195], v[148:151], v[112:115]
    ds_read_b64_tr_b16 v[212:213], v6 offset:30720
    v_mfma_f32_16x16x32_bf16 v[124:127], v[192:195], v[152:155], v[124:127]
    ds_read_b64_tr_b16 v[214:215], v6 offset:31488
    v_mfma_f32_16x16x32_bf16 v[116:119], v[244:247], v[148:151], v[116:119]
    ds_read_b128 v[216:219], v26 offset:5120
    v_mfma_f32_16x16x32_bf16 v[128:131], v[244:247], v[152:155], v[128:131]
    ds_read_b128 v[220:223], v27 offset:6400
    v_mfma_f32_16x16x32_bf16 v[120:123], v[236:239], v[148:151], v[120:123]
    ds_read_b64_tr_b16 v[224:225], v7 offset:30720
    v_mfma_f32_16x16x32_bf16 v[132:135], v[236:239], v[152:155], v[132:135]
    ds_read_b64_tr_b16 v[226:227], v7 offset:31488
    v_mfma_f32_16x16x32_bf16 v[112:115], v[248:251], v[152:155], v[112:115]
    ds_read_b64_tr_b16 v[228:229], v8 offset:30720
    v_mfma_f32_16x16x32_bf16 v[124:127], v[248:251], v[156:159], v[124:127]
    ds_read_b64_tr_b16 v[230:231], v8 offset:31488
    v_mfma_f32_16x16x32_bf16 v[116:119], v[252:255], v[152:155], v[116:119]
    s_waitcnt lgkmcnt(9)
    s_barrier
    ds_read_b64_tr_b16 v[168:169], v6 offset:36864
    v_mfma_f32_16x16x32_bf16 v[128:131], v[252:255], v[156:159], v[128:131]
    ds_read_b64_tr_b16 v[170:171], v6 offset:37632
    v_mfma_f32_16x16x32_bf16 v[120:123], v[196:199], v[152:155], v[120:123]
    ds_read_b128 v[164:167], v26 offset:7680
    v_mfma_f32_16x16x32_bf16 v[132:135], v[196:199], v[156:159], v[132:135]
    ds_read_b64_tr_b16 v[172:173], v7 offset:36864
    v_mfma_f32_16x16x32_bf16 v[112:115], v[200:203], v[156:159], v[112:115]
    ds_read_b64_tr_b16 v[174:175], v7 offset:37632
    v_mfma_f32_16x16x32_bf16 v[124:127], v[200:203], v[208:211], v[124:127]
    ds_read_b64_tr_b16 v[240:241], v8 offset:36864
    v_mfma_f32_16x16x32_bf16 v[116:119], v[176:179], v[156:159], v[116:119]
    ds_read_b64_tr_b16 v[242:243], v8 offset:37632
    v_mfma_f32_16x16x32_bf16 v[128:131], v[176:179], v[208:211], v[128:131]
    ds_read_b64_tr_b16 v[232:233], v6 offset:43008
    v_mfma_f32_16x16x32_bf16 v[120:123], v[180:183], v[156:159], v[120:123]
    ds_read_b64_tr_b16 v[234:235], v6 offset:43776
    v_mfma_f32_16x16x32_bf16 v[132:135], v[180:183], v[208:211], v[132:135]
    ds_read_b128 v[192:195], v27 offset:8960
    v_mfma_f32_16x16x32_bf16 v[112:115], v[184:187], v[208:211], v[112:115]
    ds_read_b64_tr_b16 v[244:245], v7 offset:43008
    s_waitcnt lgkmcnt(8)
    v_mfma_f32_16x16x32_bf16 v[124:127], v[184:187], v[160:163], v[124:127]
    ds_read_b64_tr_b16 v[246:247], v7 offset:43776
    v_mfma_f32_16x16x32_bf16 v[116:119], v[188:191], v[208:211], v[116:119]
    ds_read_b64_tr_b16 v[148:149], v8 offset:43008
    v_mfma_f32_16x16x32_bf16 v[128:131], v[188:191], v[160:163], v[128:131]
    ds_read_b64_tr_b16 v[150:151], v8 offset:43776
    v_mfma_f32_16x16x32_bf16 v[120:123], v[204:207], v[208:211], v[120:123]
    v_cvt_pk_bf16_f32 v100, v100, v101
    v_mfma_f32_16x16x32_bf16 v[132:135], v[204:207], v[160:163], v[132:135]
    v_cvt_pk_bf16_f32 v101, v102, v103
    v_mfma_f32_16x16x32_bf16 v[112:115], v[212:215], v[216:219], v[112:115]
    ds_read_b64_tr_b16 v[236:237], v6 offset:49152
    v_mfma_f32_16x16x32_bf16 v[124:127], v[212:215], v[220:223], v[124:127]
    ds_read_b64_tr_b16 v[238:239], v6 offset:49920
    v_mfma_f32_16x16x32_bf16 v[116:119], v[224:227], v[216:219], v[116:119]
    ds_write_b64 v20, v[100:101] offset:9216
    v_mfma_f32_16x16x32_bf16 v[128:131], v[224:227], v[220:223], v[128:131]
    ds_read_b128 v[248:251], v26 offset:10240
    v_mfma_f32_16x16x32_bf16 v[120:123], v[228:231], v[216:219], v[120:123]
    v_cvt_pk_bf16_f32 v104, v104, v105
    v_mfma_f32_16x16x32_bf16 v[132:135], v[228:231], v[220:223], v[132:135]
    ds_read_b64_tr_b16 v[252:253], v7 offset:49152
    v_mfma_f32_16x16x32_bf16 v[112:115], v[168:171], v[220:223], v[112:115]
    ds_read_b64_tr_b16 v[254:255], v7 offset:49920
    v_cvt_pk_bf16_f32 v105, v106, v107
    v_mfma_f32_16x16x32_bf16 v[124:127], v[168:171], v[164:167], v[124:127]
    ds_write_b64 v20, v[104:105] offset:9280
    s_waitcnt lgkmcnt(7)
    v_mfma_f32_16x16x32_bf16 v[116:119], v[172:175], v[220:223], v[116:119]
    ds_read_b64_tr_b16 v[152:153], v8 offset:49152
    ds_read_b64_tr_b16 v[154:155], v8 offset:49920
    v_mfma_f32_16x16x32_bf16 v[128:131], v[172:175], v[164:167], v[128:131]
    v_cvt_pk_bf16_f32 v108, v108, v109
    v_cvt_pk_bf16_f32 v109, v110, v111
    v_mfma_f32_16x16x32_bf16 v[120:123], v[240:243], v[220:223], v[120:123]
    ds_read_b64_tr_b16 v[196:197], v6 offset:55296
    ds_read_b64_tr_b16 v[198:199], v6 offset:56064
    v_mfma_f32_16x16x32_bf16 v[132:135], v[240:243], v[164:167], v[132:135]
    ds_write_b64 v20, v[108:109] offset:9344
    ds_read_b128 v[200:203], v27 offset:11520
    v_mfma_f32_16x16x32_bf16 v[112:115], v[232:235], v[164:167], v[112:115]
    ds_read_b64_tr_b16 v[176:177], v7 offset:55296
    ds_read_b64_tr_b16 v[178:179], v7 offset:56064
    v_mfma_f32_16x16x32_bf16 v[124:127], v[232:235], v[192:195], v[124:127]
    ds_read_b64_tr_b16 v[156:157], v8 offset:55296
    v_mfma_f32_16x16x32_bf16 v[116:119], v[244:247], v[164:167], v[116:119]
    ds_read_b64_tr_b16 v[158:159], v8 offset:56064
    v_mfma_f32_16x16x32_bf16 v[128:131], v[244:247], v[192:195], v[128:131]
    v_mfma_f32_16x16x32_bf16 v[120:123], v[148:151], v[164:167], v[120:123]
    v_mfma_f32_16x16x32_bf16 v[132:135], v[148:151], v[192:195], v[132:135]
    s_waitcnt lgkmcnt(8)
    v_mfma_f32_16x16x32_bf16 v[112:115], v[236:239], v[192:195], v[112:115]
    s_waitcnt lgkmcnt(5)
    s_barrier
    v_mfma_f32_16x16x32_bf16 v[124:127], v[236:239], v[248:251], v[124:127]
    v_mfma_f32_16x16x32_bf16 v[116:119], v[252:255], v[192:195], v[116:119]
    v_mfma_f32_16x16x32_bf16 v[128:131], v[252:255], v[248:251], v[128:131]
    v_mfma_f32_16x16x32_bf16 v[120:123], v[152:155], v[192:195], v[120:123]
    v_mfma_f32_16x16x32_bf16 v[132:135], v[152:155], v[248:251], v[132:135]
    v_mfma_f32_16x16x32_bf16 v[112:115], v[196:199], v[248:251], v[112:115]
    s_waitcnt lgkmcnt(0)
    v_mfma_f32_16x16x32_bf16 v[124:127], v[196:199], v[200:203], v[124:127]
    v_mfma_f32_16x16x32_bf16 v[116:119], v[176:179], v[248:251], v[116:119]
    v_mfma_f32_16x16x32_bf16 v[128:131], v[176:179], v[200:203], v[128:131]
    v_mfma_f32_16x16x32_bf16 v[120:123], v[156:159], v[248:251], v[120:123]
    v_mfma_f32_16x16x32_bf16 v[132:135], v[156:159], v[200:203], v[132:135]
    s_nop 7
    v_cvt_pk_bf16_f32 v112, v112, v113
    v_cvt_pk_bf16_f32 v113, v114, v115
    ds_write_b64 v20, v[112:113] offset:12288
    v_cvt_pk_bf16_f32 v124, v124, v125
    v_cvt_pk_bf16_f32 v125, v126, v127
    ds_write_b64 v20, v[124:125] offset:15360
    v_cvt_pk_bf16_f32 v116, v116, v117
    v_cvt_pk_bf16_f32 v117, v118, v119
    ds_write_b64 v20, v[116:117] offset:12352
    v_cvt_pk_bf16_f32 v128, v128, v129
    v_cvt_pk_bf16_f32 v129, v130, v131
    ds_write_b64 v20, v[128:129] offset:15424
    v_cvt_pk_bf16_f32 v120, v120, v121
    v_cvt_pk_bf16_f32 v121, v122, v123
    ds_write_b64 v20, v[120:121] offset:12416
    v_cvt_pk_bf16_f32 v132, v132, v133
    v_cvt_pk_bf16_f32 v133, v134, v135
    ds_write_b64 v20, v[132:133] offset:15488
    s_waitcnt lgkmcnt(0)
    s_barrier
    s_branch L_store
L_store:
    s_cmp_eq_u32 s87, 15
    s_cbranch_scc1 L_latedone
    ds_read_b128 v[52:55], v47
    ds_read_b128 v[56:59], v48
    ds_read_b128 v[60:63], v49
    s_mov_b64 exec, s[64:65]
    s_waitcnt lgkmcnt(2)
    buffer_store_dwordx4 v[52:55], v46, s[76:79], s80 offen offset:0 sc1
    s_mov_b64 exec, s[66:67]
    s_waitcnt lgkmcnt(1)
    buffer_store_dwordx4 v[56:59], v46, s[76:79], s80 offen offset:1024 sc1
    s_mov_b64 exec, s[68:69]
    s_waitcnt lgkmcnt(0)
    buffer_store_dwordx4 v[60:63], v46, s[76:79], s80 offen offset:2048 sc1
    s_mov_b64 exec, -1
L_latedone:
    s_endpgm
L_exit:
    s_endpgm

.section .rodata,"a"
.p2align 6
.amdhsa_kernel standalone__fft_conv__vision_kernel
  .amdhsa_next_free_vgpr 256
  .amdhsa_next_free_sgpr 96
  .amdhsa_accum_offset 256
  .amdhsa_group_segment_fixed_size 0
  .amdhsa_kernarg_size 40
  .amdhsa_user_sgpr_count 2
  .amdhsa_user_sgpr_kernarg_segment_ptr 1
  .amdhsa_system_sgpr_workgroup_id_x 1
.end_amdhsa_kernel
```
